```python
import torch

def _softmax(x, axis=-1):
    return torch.softmax(x, dim=axis)
def _gelu(x):
    return torch.nn.functional.gelu(x, approximate="tanh")
def _silu(x):
    return torch.nn.functional.silu(x)
def _sigmoid(x):
    return torch.sigmoid(x)
def _layernorm(x, axis=-1, eps=1e-5):
    m = x.mean(dim=axis, keepdim=True)
    v = x.var(dim=axis, keepdim=True, unbiased=False)
    return (x - m) / torch.sqrt(v + eps)
def _scatter_add(tgt, idx, src, axis=0):
    return tgt.clone().index_add_(axis, idx, src)
def _segment_sum(src, seg, n):
    out = torch.zeros((n,) + src.shape[1:], dtype=src.dtype)
    return out.index_add_(0, seg, src)
def _pad(x, pw):
    flat = tuple(v for pair in reversed(pw) for v in pair)
    return torch.nn.functional.pad(x, flat)

kernel_name = 'interleave_layers__linear_kernel_hedgehog__spectral_fnet__prompt'

def setup_inputs():

    _w = (lambda a: (lambda t: t.to(torch.bfloat16) if t.is_floating_point() else t)(torch.as_tensor(a)))
    def _A_setup():
        B, S, D, H = 1, 2048, 576, 32
        Dh = D // H
        return {
            "x": _w((lambda *s: torch.randn(*s, dtype=torch.bfloat16) * 0.4)(B, S, D)),
            "wqkv": _w((lambda *s: torch.randn(*s, dtype=torch.bfloat16) * 1.6)(D, 3 * D)),
            "w_phi": _w((lambda *s: torch.randn(*s, dtype=torch.bfloat16) * 1.6)(H, Dh, Dh) * (Dh ** -0.5)),
            "wo": _w((lambda *s: torch.randn(*s, dtype=torch.bfloat16) * 1.6)(D, D)),
        }
    _A_in = _A_setup()

    def _B_setup():
        B, S, D = 1, 2048, 576
        ns = torch.arange(S)[:, None] * torch.arange(S)[None, :]
        nd = torch.arange(D)[:, None] * torch.arange(D)[None, :]
        Ws_re = torch.cos(-2.0 * torch.pi * ns / S).to(float)
        Ws_im = torch.sin(-2.0 * torch.pi * ns / S).to(float)
        Wd_re = torch.cos(-2.0 * torch.pi * nd / D).to(float)
        Wd_im = torch.sin(-2.0 * torch.pi * nd / D).to(float)
        return {
            "x": _w((lambda *s: torch.randn(*s, dtype=torch.bfloat16) * 0.4)(B, S, D)),
            "dft_seq_re": _w(Ws_re),
            "dft_seq_im": _w(Ws_im),
            "dft_hid_re": _w(Wd_re),
            "dft_hid_im": _w(Wd_im),
        }
    _B_in = _B_setup()

    return {
        "A_x": _A_in["x"],
        "A_wqkv": _A_in["wqkv"],
        "A_w_phi": _A_in["w_phi"],
        "A_wo": _A_in["wo"],
        "B_x": _B_in["x"],
        "B_dft_seq_re": _B_in["dft_seq_re"],
        "B_dft_seq_im": _B_in["dft_seq_im"],
        "B_dft_hid_re": _B_in["dft_hid_re"],
        "B_dft_hid_im": _B_in["dft_hid_im"],
    }

def reference(A_x, A_wqkv, A_w_phi, A_wo, B_x, B_dft_seq_re, B_dft_seq_im, B_dft_hid_re, B_dft_hid_im):
    def _A_ref(x, wqkv, w_phi, wo):
        B, S, D = x.shape
        H = 32; Dh = D // H
        qkv = (lambda x, *d: x.permute(*d))((x @ wqkv).reshape(B, S, 3, H, Dh), 2, 0, 3, 1, 4)
        q, k, v = qkv[0], qkv[1], qkv[2]
        pq = torch.einsum("bhsd,hdf->bhsf", q, w_phi)
        pk = torch.einsum("bhsd,hdf->bhsf", k, w_phi)
        phi_q = torch.concatenate([_softmax(pq, axis=-1), _softmax(-pq, axis=-1)], axis=-1)
        phi_k = torch.concatenate([_softmax(pk, axis=-1), _softmax(-pk, axis=-1)], axis=-1)
        kv = torch.einsum("bhsf,bhsd->bhfd", phi_k, v)
        z  = torch.einsum("bhsf->bhf", phi_k)
        num = torch.einsum("bhqf,bhfd->bhqd", phi_q, kv)
        den = torch.einsum("bhqf,bhf->bhq", phi_q, z)[..., None] + 1e-6
        o = num / den
        return (lambda x, *d: x.permute(*d))(o, 0, 2, 1, 3).reshape(B, S, D) @ wo

    def _B_ref(x, dft_seq_re, dft_seq_im, dft_hid_re, dft_hid_im):
        a = torch.einsum("bsd,ed->bse", x, dft_hid_re)
        b = torch.einsum("bsd,ed->bse", x, dft_hid_im)
        y = torch.einsum("ts,bse->bte", dft_seq_re, a) - torch.einsum("ts,bse->bte", dft_seq_im, b)
        return y

    x = A_x
    x = x + _A_ref(_layernorm(x, axis=-1), A_wqkv, A_w_phi, A_wo)
    x = x + _B_ref(_layernorm(x, axis=-1), B_dft_seq_re, B_dft_seq_im, B_dft_hid_re, B_dft_hid_im)
    x = x + _A_ref(_layernorm(x, axis=-1), A_wqkv, A_w_phi, A_wo)
    x = x + _B_ref(_layernorm(x, axis=-1), B_dft_seq_re, B_dft_seq_im, B_dft_hid_re, B_dft_hid_im)
    return x
```

```asm
; @launch kernel=ln1_kernel grid=(1201,1,1) block=(256,1,1) lds=0
; @launch kernel=g1_kernel grid=(216,1,1) block=(256,1,1) lds=122880
; @launch kernel=kv_kernel grid=(256,1,1) block=(256,1,1) lds=47392
; @launch kernel=o_kernel grid=(256,1,1) block=(256,1,1) lds=4192
; @launch kernel=g2a_kernel grid=(192,1,1) block=(256,1,1) lds=81920
; @launch kernel=ln2_kernel grid=(512,1,1) block=(256,1,1) lds=0
; @launch kernel=g3_kernel grid=(192,1,1) block=(256,1,1) lds=114688
; @launch kernel=g4_kernel grid=(256,1,1) block=(256,1,1) lds=114688
; @launch kernel=ln3_kernel grid=(512,1,1) block=(256,1,1) lds=0
; @launch kernel=g1_kernel grid=(216,1,1) block=(256,1,1) lds=122880
; @launch kernel=kv_kernel grid=(256,1,1) block=(256,1,1) lds=47392
; @launch kernel=o_kernel grid=(256,1,1) block=(256,1,1) lds=4192
; @launch kernel=g2b_kernel grid=(192,1,1) block=(256,1,1) lds=81920
; @launch kernel=ln4_kernel grid=(512,1,1) block=(256,1,1) lds=0
; @launch kernel=g3_kernel grid=(192,1,1) block=(256,1,1) lds=114688
; @launch kernel=g4_kernel grid=(256,1,1) block=(256,1,1) lds=114688
; @launch kernel=fin_kernel grid=(512,1,1) block=(256,1,1) lds=0
.amdgcn_target "amdgcn-amd-amdhsa--gfx950"
.text
.globl ln1_kernel
.p2align 8
.type ln1_kernel,@function
ln1_kernel:
    s_cmp_lt_u32 s2, 512
    s_cbranch_scc1 ln1_kernel_ln
    s_sub_u32 s2, s2, 512
    s_load_dwordx2 s[4:5], s[0:1], 8
    s_load_dwordx2 s[6:7], s[0:1], 24
    s_load_dwordx2 s[8:9], s[0:1], 16
    s_load_dwordx2 s[10:11], s[0:1], 88
    s_cmp_ge_u32 s2, 689
    s_cbranch_scc1 prep_end
    s_waitcnt lgkmcnt(0)
    s_cmp_ge_u32 s2, 648
    s_cbranch_scc1 prep_t3
    s_cmp_ge_u32 s2, 486
    s_cbranch_scc1 prep_t2
    s_mov_b32 s12, s4
    s_mov_b32 s13, s5
    s_mov_b32 s14, 0x1e6000
    s_mov_b32 s15, 0x00020000
    s_add_u32 s16, s10, 0x1b00000
    s_addc_u32 s17, s11, 0
    s_mov_b32 s18, 0x1e6000
    s_mov_b32 s19, 0x00020000
    s_sub_u32 s20, s2, 0
    s_lshl_b32 s20, s20, 8
    v_add_u32 v1, s20, v0
    s_mov_b32 s21, 0x25ed0a
    v_mul_hi_u32 v2, v1, s21
    s_mov_b32 s22, 1728
    v_mul_lo_u32 v3, v2, s22
    v_sub_u32 v3, v1, v3
    v_cmp_gt_u32 vcc, 72, v2
    s_and_saveexec_b64 s[24:25], vcc
    s_cbranch_execz prep_end
    s_mov_b32 s23, 27648
    v_mul_lo_u32 v4, v2, s23
    v_lshl_add_u32 v4, v3, 1, v4
    buffer_load_ushort v8, v4, s[12:15], 0 offen offset:0
    v_add_u32 v4, 3456, v4
    buffer_load_ushort v9, v4, s[12:15], 0 offen
    v_add_u32 v4, 3456, v4
    buffer_load_ushort v10, v4, s[12:15], 0 offen
    v_add_u32 v4, 3456, v4
    buffer_load_ushort v11, v4, s[12:15], 0 offen
    v_add_u32 v4, 3456, v4
    buffer_load_ushort v12, v4, s[12:15], 0 offen
    v_add_u32 v4, 3456, v4
    buffer_load_ushort v13, v4, s[12:15], 0 offen
    v_add_u32 v4, 3456, v4
    buffer_load_ushort v14, v4, s[12:15], 0 offen
    v_add_u32 v4, 3456, v4
    buffer_load_ushort v15, v4, s[12:15], 0 offen
    s_mov_b32 s23, 1152
    v_mul_lo_u32 v5, v3, s23
    v_lshl_add_u32 v5, v2, 4, v5
    s_waitcnt vmcnt(0)
    v_lshl_or_b32 v16, v9, 16, v8
    v_lshl_or_b32 v17, v11, 16, v10
    v_lshl_or_b32 v18, v13, 16, v12
    v_lshl_or_b32 v19, v15, 16, v14
    buffer_store_dwordx4 v[16:19], v5, s[16:19], 0 offen
    s_branch prep_end
prep_t2:
    s_mov_b32 s12, s6
    s_mov_b32 s13, s7
    s_mov_b32 s14, 0xa2000
    s_mov_b32 s15, 0x00020000
    s_add_u32 s16, s10, 0x1cf0000
    s_addc_u32 s17, s11, 0
    s_mov_b32 s18, 0xa2000
    s_mov_b32 s19, 0x00020000
    s_sub_u32 s20, s2, 486
    s_lshl_b32 s20, s20, 8
    v_add_u32 v1, s20, v0
    s_mov_b32 s21, 0x71c71d
    v_mul_hi_u32 v2, v1, s21
    s_mov_b32 s22, 576
    v_mul_lo_u32 v3, v2, s22
    v_sub_u32 v3, v1, v3
    v_cmp_gt_u32 vcc, 72, v2
    s_and_saveexec_b64 s[24:25], vcc
    s_cbranch_execz prep_end
    s_mov_b32 s23, 9216
    v_mul_lo_u32 v4, v2, s23
    v_lshl_add_u32 v4, v3, 1, v4
    buffer_load_ushort v8, v4, s[12:15], 0 offen offset:0
    v_add_u32 v4, 1152, v4
    buffer_load_ushort v9, v4, s[12:15], 0 offen
    v_add_u32 v4, 1152, v4
    buffer_load_ushort v10, v4, s[12:15], 0 offen
    v_add_u32 v4, 1152, v4
    buffer_load_ushort v11, v4, s[12:15], 0 offen
    v_add_u32 v4, 1152, v4
    buffer_load_ushort v12, v4, s[12:15], 0 offen
    v_add_u32 v4, 1152, v4
    buffer_load_ushort v13, v4, s[12:15], 0 offen
    v_add_u32 v4, 1152, v4
    buffer_load_ushort v14, v4, s[12:15], 0 offen
    v_add_u32 v4, 1152, v4
    buffer_load_ushort v15, v4, s[12:15], 0 offen
    s_mov_b32 s23, 1152
    v_mul_lo_u32 v5, v3, s23
    v_lshl_add_u32 v5, v2, 4, v5
    s_waitcnt vmcnt(0)
    v_lshl_or_b32 v16, v9, 16, v8
    v_lshl_or_b32 v17, v11, 16, v10
    v_lshl_or_b32 v18, v13, 16, v12
    v_lshl_or_b32 v19, v15, 16, v14
    buffer_store_dwordx4 v[16:19], v5, s[16:19], 0 offen
    s_branch prep_end
prep_t3:
    s_mov_b32 s12, s8
    s_mov_b32 s13, s9
    s_mov_b32 s14, 0x5100
    s_mov_b32 s15, 0x00020000
    s_add_u32 s16, s10, 0x1da0000
    s_addc_u32 s17, s11, 0
    s_mov_b32 s18, 0xa800
    s_mov_b32 s19, 0x00020000
    s_sub_u32 s20, s2, 648
    s_lshl_b32 s20, s20, 8
    v_add_u32 v1, s20, v0
    v_cmp_gt_u32 vcc, 10368, v1
    s_and_saveexec_b64 s[24:25], vcc
    s_cbranch_execz prep_end
    s_mov_b32 s21, 0xca4588
    v_mul_hi_u32 v2, v1, s21
    s_mov_b32 s22, 324
    v_mul_lo_u32 v3, v2, s22
    v_sub_u32 v3, v1, v3
    v_lshlrev_b32 v4, 1, v1
    buffer_load_ushort v8, v4, s[12:15], 0 offen
    s_mov_b32 s22, 1344
    v_mul_lo_u32 v5, v2, s22
    v_lshl_add_u32 v5, v3, 2, v5
    s_waitcnt vmcnt(0)
    v_lshlrev_b32 v8, 16, v8
    buffer_store_dword v8, v5, s[16:19], 0 offen
prep_end:
    s_branch ln1_kernel_end
ln1_kernel_ln:
    s_load_dwordx2 s[4:5], s[0:1], 0
    s_load_dwordx2 s[6:7], s[0:1], 88
    s_load_dwordx2 s[8:9], s[0:1], 72
    v_lshrrev_b32 v1, 6, v0
    v_and_b32 v2, 63, v0
    s_nop 0
    v_readfirstlane_b32 s3, v1
    s_lshl_b32 s10, s2, 2
    s_add_u32 s10, s10, s3
    s_cmp_ge_u32 s10, 2048
    s_cbranch_scc1 ln1_kernel_end
    s_waitcnt lgkmcnt(0)
    s_mov_b32 s12, s4
    s_mov_b32 s13, s5
    s_mov_b32 s14, 0x240000
    s_mov_b32 s15, 0x00020000
    s_mov_b32 s16, s6
    s_mov_b32 s17, s7
    s_mov_b32 s18, 0x240000
    s_mov_b32 s19, 0x00020000
    s_mul_i32 s11, s10, 1152
    v_lshlrev_b32 v3, 4, v2
    v_cmp_gt_u32 s[32:33], 8, v2
    v_mov_b32 v12, 0
    v_mov_b32 v13, 0
    v_mov_b32 v14, 0
    v_mov_b32 v15, 0
    v_mov_b32 v16, 0
    v_mov_b32 v17, 0
    v_mov_b32 v18, 0
    v_mov_b32 v19, 0
    buffer_load_dwordx4 v[4:7], v3, s[12:15], s11 offen
    s_mov_b64 exec, s[32:33]
    buffer_load_dwordx4 v[12:15], v3, s[12:15], s11 offen offset:1024
    s_mov_b64 exec, -1
    s_waitcnt vmcnt(0)
    v_lshlrev_b32 v20, 16, v4
    v_and_b32 v21, 0xffff0000, v4
    v_lshlrev_b32 v22, 16, v5
    v_and_b32 v23, 0xffff0000, v5
    v_lshlrev_b32 v24, 16, v6
    v_and_b32 v25, 0xffff0000, v6
    v_lshlrev_b32 v26, 16, v7
    v_and_b32 v27, 0xffff0000, v7
    v_lshlrev_b32 v28, 16, v12
    v_and_b32 v29, 0xffff0000, v12
    v_lshlrev_b32 v30, 16, v13
    v_and_b32 v31, 0xffff0000, v13
    v_lshlrev_b32 v32, 16, v14
    v_and_b32 v33, 0xffff0000, v14
    v_lshlrev_b32 v34, 16, v15
    v_and_b32 v35, 0xffff0000, v15
    v_add_f32 v36, v20, v21
    v_add_f32 v36, v36, v22
    v_add_f32 v36, v36, v23
    v_add_f32 v36, v36, v24
    v_add_f32 v36, v36, v25
    v_add_f32 v36, v36, v26
    v_add_f32 v36, v36, v27
    v_add_f32 v36, v36, v28
    v_add_f32 v36, v36, v29
    v_add_f32 v36, v36, v30
    v_add_f32 v36, v36, v31
    v_add_f32 v36, v36, v32
    v_add_f32 v36, v36, v33
    v_add_f32 v36, v36, v34
    v_add_f32 v36, v36, v35
    s_nop 1
    v_add_f32_dpp v36, v36, v36 row_shr:1 row_mask:0xf bank_mask:0xf
    s_nop 1
    v_add_f32_dpp v36, v36, v36 row_shr:2 row_mask:0xf bank_mask:0xf
    s_nop 1
    v_add_f32_dpp v36, v36, v36 row_shr:4 row_mask:0xf bank_mask:0xf
    s_nop 1
    v_add_f32_dpp v36, v36, v36 row_shr:8 row_mask:0xf bank_mask:0xf
    s_nop 1
    v_add_f32_dpp v36, v36, v36 row_bcast:15 row_mask:0xa bank_mask:0xf
    s_nop 1
    v_add_f32_dpp v36, v36, v36 row_bcast:31 row_mask:0xc bank_mask:0xf
    s_nop 0
    v_readlane_b32 s34, v36, 63
    s_nop 1
    v_mov_b32 v37, s34
    v_mul_f32 v37, 0x3ae38e39, v37
    v_sub_f32 v38, v20, v37
    v_mul_f32 v36, v38, v38
    v_sub_f32 v38, v21, v37
    v_fmac_f32 v36, v38, v38
    v_sub_f32 v38, v22, v37
    v_fmac_f32 v36, v38, v38
    v_sub_f32 v38, v23, v37
    v_fmac_f32 v36, v38, v38
    v_sub_f32 v38, v24, v37
    v_fmac_f32 v36, v38, v38
    v_sub_f32 v38, v25, v37
    v_fmac_f32 v36, v38, v38
    v_sub_f32 v38, v26, v37
    v_fmac_f32 v36, v38, v38
    v_sub_f32 v38, v27, v37
    v_fmac_f32 v36, v38, v38
    s_mov_b64 exec, s[32:33]
    v_sub_f32 v38, v28, v37
    v_fmac_f32 v36, v38, v38
    v_sub_f32 v38, v29, v37
    v_fmac_f32 v36, v38, v38
    v_sub_f32 v38, v30, v37
    v_fmac_f32 v36, v38, v38
    v_sub_f32 v38, v31, v37
    v_fmac_f32 v36, v38, v38
    v_sub_f32 v38, v32, v37
    v_fmac_f32 v36, v38, v38
    v_sub_f32 v38, v33, v37
    v_fmac_f32 v36, v38, v38
    v_sub_f32 v38, v34, v37
    v_fmac_f32 v36, v38, v38
    v_sub_f32 v38, v35, v37
    v_fmac_f32 v36, v38, v38
    s_mov_b64 exec, -1
    s_nop 1
    v_add_f32_dpp v36, v36, v36 row_shr:1 row_mask:0xf bank_mask:0xf
    s_nop 1
    v_add_f32_dpp v36, v36, v36 row_shr:2 row_mask:0xf bank_mask:0xf
    s_nop 1
    v_add_f32_dpp v36, v36, v36 row_shr:4 row_mask:0xf bank_mask:0xf
    s_nop 1
    v_add_f32_dpp v36, v36, v36 row_shr:8 row_mask:0xf bank_mask:0xf
    s_nop 1
    v_add_f32_dpp v36, v36, v36 row_bcast:15 row_mask:0xa bank_mask:0xf
    s_nop 1
    v_add_f32_dpp v36, v36, v36 row_bcast:31 row_mask:0xc bank_mask:0xf
    s_nop 0
    v_readlane_b32 s34, v36, 63
    s_nop 1
    v_mov_b32 v38, s34
    v_mul_f32 v38, 0x3ae38e39, v38
    v_cvt_pk_bf16_f32 v39, v37, v38
    v_lshlrev_b32 v37, 16, v39
    v_and_b32 v38, 0xffff0000, v39
    v_add_f32 v38, 0x3727c5ac, v38
    v_cvt_pk_bf16_f32 v39, v38, v38
    v_lshlrev_b32 v38, 16, v39
    v_sqrt_f32 v38, v38
    s_nop 0
    v_cvt_pk_bf16_f32 v39, v38, v38
    v_lshlrev_b32 v38, 16, v39
    v_rcp_f32 v39, v38
    s_nop 0
    v_sub_f32 v40, v20, v37
    v_sub_f32 v41, v21, v37
    v_cvt_pk_bf16_f32 v42, v40, v41
    v_lshlrev_b32 v40, 16, v42
    v_and_b32 v41, 0xffff0000, v42
    v_mul_f32 v42, v40, v39
    v_mul_f32 v43, v41, v39
    v_fma_f32 v44, -v42, v38, v40
    v_fma_f32 v45, -v43, v38, v41
    v_fma_f32 v42, v44, v39, v42
    v_fma_f32 v43, v45, v39, v43
    v_cvt_pk_bf16_f32 v4, v42, v43
    v_sub_f32 v40, v22, v37
    v_sub_f32 v41, v23, v37
    v_cvt_pk_bf16_f32 v42, v40, v41
    v_lshlrev_b32 v40, 16, v42
    v_and_b32 v41, 0xffff0000, v42
    v_mul_f32 v42, v40, v39
    v_mul_f32 v43, v41, v39
    v_fma_f32 v44, -v42, v38, v40
    v_fma_f32 v45, -v43, v38, v41
    v_fma_f32 v42, v44, v39, v42
    v_fma_f32 v43, v45, v39, v43
    v_cvt_pk_bf16_f32 v5, v42, v43
    v_sub_f32 v40, v24, v37
    v_sub_f32 v41, v25, v37
    v_cvt_pk_bf16_f32 v42, v40, v41
    v_lshlrev_b32 v40, 16, v42
    v_and_b32 v41, 0xffff0000, v42
    v_mul_f32 v42, v40, v39
    v_mul_f32 v43, v41, v39
    v_fma_f32 v44, -v42, v38, v40
    v_fma_f32 v45, -v43, v38, v41
    v_fma_f32 v42, v44, v39, v42
    v_fma_f32 v43, v45, v39, v43
    v_cvt_pk_bf16_f32 v6, v42, v43
    v_sub_f32 v40, v26, v37
    v_sub_f32 v41, v27, v37
    v_cvt_pk_bf16_f32 v42, v40, v41
    v_lshlrev_b32 v40, 16, v42
    v_and_b32 v41, 0xffff0000, v42
    v_mul_f32 v42, v40, v39
    v_mul_f32 v43, v41, v39
    v_fma_f32 v44, -v42, v38, v40
    v_fma_f32 v45, -v43, v38, v41
    v_fma_f32 v42, v44, v39, v42
    v_fma_f32 v43, v45, v39, v43
    v_cvt_pk_bf16_f32 v7, v42, v43
    v_sub_f32 v40, v28, v37
    v_sub_f32 v41, v29, v37
    v_cvt_pk_bf16_f32 v42, v40, v41
    v_lshlrev_b32 v40, 16, v42
    v_and_b32 v41, 0xffff0000, v42
    v_mul_f32 v42, v40, v39
    v_mul_f32 v43, v41, v39
    v_fma_f32 v44, -v42, v38, v40
    v_fma_f32 v45, -v43, v38, v41
    v_fma_f32 v42, v44, v39, v42
    v_fma_f32 v43, v45, v39, v43
    v_cvt_pk_bf16_f32 v12, v42, v43
    v_sub_f32 v40, v30, v37
    v_sub_f32 v41, v31, v37
    v_cvt_pk_bf16_f32 v42, v40, v41
    v_lshlrev_b32 v40, 16, v42
    v_and_b32 v41, 0xffff0000, v42
    v_mul_f32 v42, v40, v39
    v_mul_f32 v43, v41, v39
    v_fma_f32 v44, -v42, v38, v40
    v_fma_f32 v45, -v43, v38, v41
    v_fma_f32 v42, v44, v39, v42
    v_fma_f32 v43, v45, v39, v43
    v_cvt_pk_bf16_f32 v13, v42, v43
    v_sub_f32 v40, v32, v37
    v_sub_f32 v41, v33, v37
    v_cvt_pk_bf16_f32 v42, v40, v41
    v_lshlrev_b32 v40, 16, v42
    v_and_b32 v41, 0xffff0000, v42
    v_mul_f32 v42, v40, v39
    v_mul_f32 v43, v41, v39
    v_fma_f32 v44, -v42, v38, v40
    v_fma_f32 v45, -v43, v38, v41
    v_fma_f32 v42, v44, v39, v42
    v_fma_f32 v43, v45, v39, v43
    v_cvt_pk_bf16_f32 v14, v42, v43
    v_sub_f32 v40, v34, v37
    v_sub_f32 v41, v35, v37
    v_cvt_pk_bf16_f32 v42, v40, v41
    v_lshlrev_b32 v40, 16, v42
    v_and_b32 v41, 0xffff0000, v42
    v_mul_f32 v42, v40, v39
    v_mul_f32 v43, v41, v39
    v_fma_f32 v44, -v42, v38, v40
    v_fma_f32 v45, -v43, v38, v41
    v_fma_f32 v42, v44, v39, v42
    v_fma_f32 v43, v45, v39, v43
    v_cvt_pk_bf16_f32 v15, v42, v43
    buffer_store_dwordx4 v[4:7], v3, s[16:19], s11 offen
    s_mov_b64 exec, s[32:33]
    buffer_store_dwordx4 v[12:15], v3, s[16:19], s11 offen offset:1024
    s_mov_b64 exec, -1
ln1_kernel_end:
    s_endpgm
.section .rodata,"a"
.p2align 6
.amdhsa_kernel ln1_kernel
  .amdhsa_next_free_vgpr 64
  .amdhsa_next_free_sgpr 102
  .amdhsa_accum_offset 64
  .amdhsa_group_segment_fixed_size 0
  .amdhsa_kernarg_size 96
  .amdhsa_user_sgpr_count 2
  .amdhsa_user_sgpr_kernarg_segment_ptr 1
  .amdhsa_system_sgpr_workgroup_id_x 1
.end_amdhsa_kernel
.text
.globl g1_kernel
.p2align 8
.type g1_kernel,@function
g1_kernel:
    s_cmp_ge_u32 s2, 216
    s_cbranch_scc1 g1_kernel_end
    s_load_dwordx2 s[4:5], s[0:1], 88
    s_load_dwordx2 s[6:7], s[0:1], 88
    s_load_dwordx2 s[64:65], s[0:1], 88
    v_and_b32 v1, 63, v0
    v_lshrrev_b32 v4, 6, v0
    s_nop 0
    v_readfirstlane_b32 s24, v4
    s_lshl_b32 s25, s24, 10
    s_waitcnt lgkmcnt(0)
    s_and_b32 s27, s2, 7
    s_lshr_b32 s26, s2, 3
    s_add_u32 s8, s4, 0x1b00000
    s_addc_u32 s9, s5, 0
    s_mov_b32 s10, 0x1e6000
    s_mov_b32 s11, 0x00020000
    s_mov_b32 s12, s6
    s_mov_b32 s13, s7
    s_mov_b32 s14, 0x240000
    s_mov_b32 s15, 0x00020000
    s_add_u32 s16, s64, 0x240000
    s_addc_u32 s17, s65, 0
    s_mov_b32 s18, 0x6c0000
    s_mov_b32 s19, 0x00020000
    v_lshrrev_b32 v4, 3, v1
    v_and_b32 v5, 7, v1
    v_xor_b32 v5, v5, v4
    v_lshlrev_b32 v5, 4, v5
    s_mov_b32 s28, 1152
    v_mul_lo_u32 v2, v4, s28
    v_add_u32 v2, v2, v5
    s_mov_b32 s28, 1152
    v_mul_lo_u32 v3, v4, s28
    v_add_u32 v3, v3, v5
    s_add_u32 s28, s24, 0
    s_lshl_b32 s29, s28, 3
    s_mul_i32 s30, s26, 64
    s_add_u32 s29, s29, s30
    s_mul_i32 s29, s29, 1152
    s_mov_b32 s32, s29
    s_add_u32 s28, s24, 4
    s_lshl_b32 s29, s28, 3
    s_mul_i32 s30, s26, 64
    s_add_u32 s29, s29, s30
    s_mul_i32 s29, s29, 1152
    s_mov_b32 s33, s29
    s_add_u32 s28, s24, 0
    s_lshl_b32 s29, s28, 3
    s_mul_i32 s30, s27, 256
    s_add_u32 s29, s29, s30
    s_mul_i32 s29, s29, 1152
    s_mov_b32 s48, s29
    s_add_u32 s28, s24, 4
    s_lshl_b32 s29, s28, 3
    s_mul_i32 s30, s27, 256
    s_add_u32 s29, s29, s30
    s_mul_i32 s29, s29, 1152
    s_mov_b32 s49, s29
    s_add_u32 s28, s24, 8
    s_lshl_b32 s29, s28, 3
    s_mul_i32 s30, s27, 256
    s_add_u32 s29, s29, s30
    s_mul_i32 s29, s29, 1152
    s_mov_b32 s50, s29
    s_add_u32 s28, s24, 12
    s_lshl_b32 s29, s28, 3
    s_mul_i32 s30, s27, 256
    s_add_u32 s29, s29, s30
    s_mul_i32 s29, s29, 1152
    s_mov_b32 s51, s29
    s_add_u32 s28, s24, 16
    s_lshl_b32 s29, s28, 3
    s_mul_i32 s30, s27, 256
    s_add_u32 s29, s29, s30
    s_mul_i32 s29, s29, 1152
    s_mov_b32 s52, s29
    s_add_u32 s28, s24, 20
    s_lshl_b32 s29, s28, 3
    s_mul_i32 s30, s27, 256
    s_add_u32 s29, s29, s30
    s_mul_i32 s29, s29, 1152
    s_mov_b32 s53, s29
    s_add_u32 s28, s24, 24
    s_lshl_b32 s29, s28, 3
    s_mul_i32 s30, s27, 256
    s_add_u32 s29, s29, s30
    s_mul_i32 s29, s29, 1152
    s_mov_b32 s54, s29
    s_add_u32 s28, s24, 28
    s_lshl_b32 s29, s28, 3
    s_mul_i32 s30, s27, 256
    s_add_u32 s29, s29, s30
    s_mul_i32 s29, s29, 1152
    s_mov_b32 s55, s29
    s_and_b32 s28, s24, 0
    s_lshr_b32 s29, s24, 0
    s_mul_i32 s28, s28, 8192
    s_mul_i32 s29, s29, 8192
    v_and_b32 v4, 15, v1
    v_lshlrev_b32 v4, 7, v4
    v_lshrrev_b32 v5, 4, v1
    v_and_b32 v6, 7, v1
    v_xor_b32 v5, v5, v6
    v_lshl_add_u32 v4, v5, 4, v4
    v_add_u32 v6, s28, v4
    v_xor_b32 v7, 64, v6
    v_add_u32 v8, 0x10000, v6
    v_add_u32 v9, 0x10000, v7
    v_add_u32 v10, s29, v4
    v_xor_b32 v11, 64, v10
    v_add_u32 v12, 0x10000, v10
    v_add_u32 v13, 0x10000, v11
    v_mov_b32 v16, 0
    v_mov_b32 v17, 0
    v_mov_b32 v18, 0
    v_mov_b32 v19, 0
    v_mov_b32 v20, 0
    v_mov_b32 v21, 0
    v_mov_b32 v22, 0
    v_mov_b32 v23, 0
    v_mov_b32 v24, 0
    v_mov_b32 v25, 0
    v_mov_b32 v26, 0
    v_mov_b32 v27, 0
    v_mov_b32 v28, 0
    v_mov_b32 v29, 0
    v_mov_b32 v30, 0
    v_mov_b32 v31, 0
    v_mov_b32 v32, 0
    v_mov_b32 v33, 0
    v_mov_b32 v34, 0
    v_mov_b32 v35, 0
    v_mov_b32 v36, 0
    v_mov_b32 v37, 0
    v_mov_b32 v38, 0
    v_mov_b32 v39, 0
    v_mov_b32 v40, 0
    v_mov_b32 v41, 0
    v_mov_b32 v42, 0
    v_mov_b32 v43, 0
    v_mov_b32 v44, 0
    v_mov_b32 v45, 0
    v_mov_b32 v46, 0
    v_mov_b32 v47, 0
    v_mov_b32 v48, 0
    v_mov_b32 v49, 0
    v_mov_b32 v50, 0
    v_mov_b32 v51, 0
    v_mov_b32 v52, 0
    v_mov_b32 v53, 0
    v_mov_b32 v54, 0
    v_mov_b32 v55, 0
    v_mov_b32 v56, 0
    v_mov_b32 v57, 0
    v_mov_b32 v58, 0
    v_mov_b32 v59, 0
    v_mov_b32 v60, 0
    v_mov_b32 v61, 0
    v_mov_b32 v62, 0
    v_mov_b32 v63, 0
    v_mov_b32 v64, 0
    v_mov_b32 v65, 0
    v_mov_b32 v66, 0
    v_mov_b32 v67, 0
    v_mov_b32 v68, 0
    v_mov_b32 v69, 0
    v_mov_b32 v70, 0
    v_mov_b32 v71, 0
    v_mov_b32 v72, 0
    v_mov_b32 v73, 0
    v_mov_b32 v74, 0
    v_mov_b32 v75, 0
    v_mov_b32 v76, 0
    v_mov_b32 v77, 0
    v_mov_b32 v78, 0
    v_mov_b32 v79, 0
    s_add_u32 m0, s25, 0
    s_nop 0
    buffer_load_dwordx4 v2, s[8:11], s32 offen lds
    s_add_u32 m0, s25, 4096
    s_nop 0
    buffer_load_dwordx4 v2, s[8:11], s33 offen lds
    s_add_u32 m0, s25, 8192
    s_nop 0
    buffer_load_dwordx4 v3, s[12:15], s48 offen lds
    s_add_u32 m0, s25, 12288
    s_nop 0
    buffer_load_dwordx4 v3, s[12:15], s49 offen lds
    s_add_u32 m0, s25, 16384
    s_nop 0
    buffer_load_dwordx4 v3, s[12:15], s50 offen lds
    s_add_u32 m0, s25, 20480
    s_nop 0
    buffer_load_dwordx4 v3, s[12:15], s51 offen lds
    s_add_u32 m0, s25, 24576
    s_nop 0
    buffer_load_dwordx4 v3, s[12:15], s52 offen lds
    s_add_u32 m0, s25, 28672
    s_nop 0
    buffer_load_dwordx4 v3, s[12:15], s53 offen lds
    s_add_u32 m0, s25, 32768
    s_nop 0
    buffer_load_dwordx4 v3, s[12:15], s54 offen lds
    s_add_u32 m0, s25, 36864
    s_nop 0
    buffer_load_dwordx4 v3, s[12:15], s55 offen lds
    s_add_u32 s8, s8, 128
    s_addc_u32 s9, s9, 0
    s_add_u32 s12, s12, 128
    s_addc_u32 s13, s13, 0
    s_add_u32 m0, s25, 40960
    s_nop 0
    buffer_load_dwordx4 v2, s[8:11], s32 offen lds
    s_add_u32 m0, s25, 45056
    s_nop 0
    buffer_load_dwordx4 v2, s[8:11], s33 offen lds
    s_add_u32 m0, s25, 49152
    s_nop 0
    buffer_load_dwordx4 v3, s[12:15], s48 offen lds
    s_add_u32 m0, s25, 53248
    s_nop 0
    buffer_load_dwordx4 v3, s[12:15], s49 offen lds
    s_add_u32 m0, s25, 57344
    s_nop 0
    buffer_load_dwordx4 v3, s[12:15], s50 offen lds
    s_add_u32 m0, s25, 61440
    s_nop 0
    buffer_load_dwordx4 v3, s[12:15], s51 offen lds
    s_add_u32 m0, s25, 65536
    s_nop 0
    buffer_load_dwordx4 v3, s[12:15], s52 offen lds
    s_add_u32 m0, s25, 69632
    s_nop 0
    buffer_load_dwordx4 v3, s[12:15], s53 offen lds
    s_add_u32 m0, s25, 73728
    s_nop 0
    buffer_load_dwordx4 v3, s[12:15], s54 offen lds
    s_add_u32 m0, s25, 77824
    s_nop 0
    buffer_load_dwordx4 v3, s[12:15], s55 offen lds
    s_add_u32 s8, s8, 128
    s_addc_u32 s9, s9, 0
    s_add_u32 s12, s12, 128
    s_addc_u32 s13, s13, 0
    s_add_u32 m0, s25, 81920
    s_nop 0
    buffer_load_dwordx4 v2, s[8:11], s32 offen lds
    s_add_u32 m0, s25, 86016
    s_nop 0
    buffer_load_dwordx4 v2, s[8:11], s33 offen lds
    s_add_u32 m0, s25, 90112
    s_nop 0
    buffer_load_dwordx4 v3, s[12:15], s48 offen lds
    s_add_u32 m0, s25, 94208
    s_nop 0
    buffer_load_dwordx4 v3, s[12:15], s49 offen lds
    s_add_u32 m0, s25, 98304
    s_nop 0
    buffer_load_dwordx4 v3, s[12:15], s50 offen lds
    s_add_u32 m0, s25, 102400
    s_nop 0
    buffer_load_dwordx4 v3, s[12:15], s51 offen lds
    s_add_u32 m0, s25, 106496
    s_nop 0
    buffer_load_dwordx4 v3, s[12:15], s52 offen lds
    s_add_u32 m0, s25, 110592
    s_nop 0
    buffer_load_dwordx4 v3, s[12:15], s53 offen lds
    s_add_u32 m0, s25, 114688
    s_nop 0
    buffer_load_dwordx4 v3, s[12:15], s54 offen lds
    s_add_u32 m0, s25, 118784
    s_nop 0
    buffer_load_dwordx4 v3, s[12:15], s55 offen lds
    s_add_u32 s8, s8, 128
    s_addc_u32 s9, s9, 0
    s_add_u32 s12, s12, 128
    s_addc_u32 s13, s13, 0
    s_waitcnt vmcnt(20)
    s_barrier
    ds_read_b128 v[80:83], v6 offset:0
    ds_read_b128 v[84:87], v6 offset:2048
    ds_read_b128 v[88:91], v6 offset:4096
    ds_read_b128 v[92:95], v6 offset:6144
    ds_read_b128 v[96:99], v10 offset:8192
    ds_read_b128 v[100:103], v10 offset:10240
    ds_read_b128 v[104:107], v10 offset:12288
    ds_read_b128 v[108:111], v10 offset:14336
    ds_read_b128 v[112:115], v7 offset:0
    ds_read_b128 v[116:119], v7 offset:2048
    ds_read_b128 v[120:123], v7 offset:4096
    ds_read_b128 v[124:127], v7 offset:6144
    ds_read_b128 v[128:131], v11 offset:8192
    ds_read_b128 v[132:135], v11 offset:10240
    ds_read_b128 v[136:139], v11 offset:12288
    ds_read_b128 v[140:143], v11 offset:14336
    s_waitcnt lgkmcnt(8)
    v_mfma_f32_16x16x32_bf16 v[16:19], v[80:83], v[96:99], v[16:19]
    v_mfma_f32_16x16x32_bf16 v[20:23], v[80:83], v[100:103], v[20:23]
    v_mfma_f32_16x16x32_bf16 v[24:27], v[80:83], v[104:107], v[24:27]
    v_mfma_f32_16x16x32_bf16 v[28:31], v[80:83], v[108:111], v[28:31]
    v_mfma_f32_16x16x32_bf16 v[32:35], v[84:87], v[96:99], v[32:35]
    v_mfma_f32_16x16x32_bf16 v[36:39], v[84:87], v[100:103], v[36:39]
    v_mfma_f32_16x16x32_bf16 v[40:43], v[84:87], v[104:107], v[40:43]
    v_mfma_f32_16x16x32_bf16 v[44:47], v[84:87], v[108:111], v[44:47]
    v_mfma_f32_16x16x32_bf16 v[48:51], v[88:91], v[96:99], v[48:51]
    v_mfma_f32_16x16x32_bf16 v[52:55], v[88:91], v[100:103], v[52:55]
    v_mfma_f32_16x16x32_bf16 v[56:59], v[88:91], v[104:107], v[56:59]
    v_mfma_f32_16x16x32_bf16 v[60:63], v[88:91], v[108:111], v[60:63]
    v_mfma_f32_16x16x32_bf16 v[64:67], v[92:95], v[96:99], v[64:67]
    v_mfma_f32_16x16x32_bf16 v[68:71], v[92:95], v[100:103], v[68:71]
    v_mfma_f32_16x16x32_bf16 v[72:75], v[92:95], v[104:107], v[72:75]
    v_mfma_f32_16x16x32_bf16 v[76:79], v[92:95], v[108:111], v[76:79]
    s_waitcnt lgkmcnt(0)
    s_waitcnt vmcnt(10)
    s_barrier
    ds_read_b128 v[80:83], v6 offset:40960
    ds_read_b128 v[84:87], v6 offset:43008
    ds_read_b128 v[88:91], v6 offset:45056
    ds_read_b128 v[92:95], v6 offset:47104
    ds_read_b128 v[96:99], v10 offset:49152
    ds_read_b128 v[100:103], v10 offset:51200
    ds_read_b128 v[104:107], v10 offset:53248
    ds_read_b128 v[108:111], v10 offset:55296
    s_add_u32 m0, s25, 0
    s_nop 0
    buffer_load_dwordx4 v2, s[8:11], s32 offen lds
    v_mfma_f32_16x16x32_bf16 v[16:19], v[112:115], v[128:131], v[16:19]
    s_add_u32 m0, s25, 4096
    s_nop 0
    buffer_load_dwordx4 v2, s[8:11], s33 offen lds
    v_mfma_f32_16x16x32_bf16 v[20:23], v[112:115], v[132:135], v[20:23]
    s_add_u32 m0, s25, 8192
    s_nop 0
    buffer_load_dwordx4 v3, s[12:15], s48 offen lds
    v_mfma_f32_16x16x32_bf16 v[24:27], v[112:115], v[136:139], v[24:27]
    s_add_u32 m0, s25, 12288
    s_nop 0
    buffer_load_dwordx4 v3, s[12:15], s49 offen lds
    v_mfma_f32_16x16x32_bf16 v[28:31], v[112:115], v[140:143], v[28:31]
    s_add_u32 m0, s25, 16384
    s_nop 0
    buffer_load_dwordx4 v3, s[12:15], s50 offen lds
    v_mfma_f32_16x16x32_bf16 v[32:35], v[116:119], v[128:131], v[32:35]
    s_add_u32 m0, s25, 20480
    s_nop 0
    buffer_load_dwordx4 v3, s[12:15], s51 offen lds
    v_mfma_f32_16x16x32_bf16 v[36:39], v[116:119], v[132:135], v[36:39]
    s_add_u32 m0, s25, 24576
    s_nop 0
    buffer_load_dwordx4 v3, s[12:15], s52 offen lds
    v_mfma_f32_16x16x32_bf16 v[40:43], v[116:119], v[136:139], v[40:43]
    s_add_u32 m0, s25, 28672
    s_nop 0
    buffer_load_dwordx4 v3, s[12:15], s53 offen lds
    v_mfma_f32_16x16x32_bf16 v[44:47], v[116:119], v[140:143], v[44:47]
    s_add_u32 m0, s25, 32768
    s_nop 0
    buffer_load_dwordx4 v3, s[12:15], s54 offen lds
    v_mfma_f32_16x16x32_bf16 v[48:51], v[120:123], v[128:131], v[48:51]
    s_add_u32 m0, s25, 36864
    s_nop 0
    buffer_load_dwordx4 v3, s[12:15], s55 offen lds
    v_mfma_f32_16x16x32_bf16 v[52:55], v[120:123], v[132:135], v[52:55]
    s_add_u32 s8, s8, 128
    s_addc_u32 s9, s9, 0
    s_add_u32 s12, s12, 128
    s_addc_u32 s13, s13, 0
    v_mfma_f32_16x16x32_bf16 v[56:59], v[120:123], v[136:139], v[56:59]
    v_mfma_f32_16x16x32_bf16 v[60:63], v[120:123], v[140:143], v[60:63]
    v_mfma_f32_16x16x32_bf16 v[64:67], v[124:127], v[128:131], v[64:67]
    v_mfma_f32_16x16x32_bf16 v[68:71], v[124:127], v[132:135], v[68:71]
    v_mfma_f32_16x16x32_bf16 v[72:75], v[124:127], v[136:139], v[72:75]
    v_mfma_f32_16x16x32_bf16 v[76:79], v[124:127], v[140:143], v[76:79]
    ds_read_b128 v[112:115], v7 offset:40960
    ds_read_b128 v[116:119], v7 offset:43008
    ds_read_b128 v[120:123], v7 offset:45056
    ds_read_b128 v[124:127], v7 offset:47104
    ds_read_b128 v[128:131], v11 offset:49152
    ds_read_b128 v[132:135], v11 offset:51200
    ds_read_b128 v[136:139], v11 offset:53248
    ds_read_b128 v[140:143], v11 offset:55296
    s_waitcnt lgkmcnt(8)
    v_mfma_f32_16x16x32_bf16 v[16:19], v[80:83], v[96:99], v[16:19]
    v_mfma_f32_16x16x32_bf16 v[20:23], v[80:83], v[100:103], v[20:23]
    v_mfma_f32_16x16x32_bf16 v[24:27], v[80:83], v[104:107], v[24:27]
    v_mfma_f32_16x16x32_bf16 v[28:31], v[80:83], v[108:111], v[28:31]
    v_mfma_f32_16x16x32_bf16 v[32:35], v[84:87], v[96:99], v[32:35]
    v_mfma_f32_16x16x32_bf16 v[36:39], v[84:87], v[100:103], v[36:39]
    v_mfma_f32_16x16x32_bf16 v[40:43], v[84:87], v[104:107], v[40:43]
    v_mfma_f32_16x16x32_bf16 v[44:47], v[84:87], v[108:111], v[44:47]
    v_mfma_f32_16x16x32_bf16 v[48:51], v[88:91], v[96:99], v[48:51]
    v_mfma_f32_16x16x32_bf16 v[52:55], v[88:91], v[100:103], v[52:55]
    v_mfma_f32_16x16x32_bf16 v[56:59], v[88:91], v[104:107], v[56:59]
    v_mfma_f32_16x16x32_bf16 v[60:63], v[88:91], v[108:111], v[60:63]
    v_mfma_f32_16x16x32_bf16 v[64:67], v[92:95], v[96:99], v[64:67]
    v_mfma_f32_16x16x32_bf16 v[68:71], v[92:95], v[100:103], v[68:71]
    v_mfma_f32_16x16x32_bf16 v[72:75], v[92:95], v[104:107], v[72:75]
    v_mfma_f32_16x16x32_bf16 v[76:79], v[92:95], v[108:111], v[76:79]
    s_waitcnt lgkmcnt(0)
    s_waitcnt vmcnt(10)
    s_barrier
    ds_read_b128 v[80:83], v8 offset:16384
    ds_read_b128 v[84:87], v8 offset:18432
    ds_read_b128 v[88:91], v8 offset:20480
    ds_read_b128 v[92:95], v8 offset:22528
    ds_read_b128 v[96:99], v12 offset:24576
    ds_read_b128 v[100:103], v12 offset:26624
    ds_read_b128 v[104:107], v12 offset:28672
    ds_read_b128 v[108:111], v12 offset:30720
    s_add_u32 m0, s25, 40960
    s_nop 0
    buffer_load_dwordx4 v2, s[8:11], s32 offen lds
    v_mfma_f32_16x16x32_bf16 v[16:19], v[112:115], v[128:131], v[16:19]
    s_add_u32 m0, s25, 45056
    s_nop 0
    buffer_load_dwordx4 v2, s[8:11], s33 offen lds
    v_mfma_f32_16x16x32_bf16 v[20:23], v[112:115], v[132:135], v[20:23]
    s_add_u32 m0, s25, 49152
    s_nop 0
    buffer_load_dwordx4 v3, s[12:15], s48 offen lds
    v_mfma_f32_16x16x32_bf16 v[24:27], v[112:115], v[136:139], v[24:27]
    s_add_u32 m0, s25, 53248
    s_nop 0
    buffer_load_dwordx4 v3, s[12:15], s49 offen lds
    v_mfma_f32_16x16x32_bf16 v[28:31], v[112:115], v[140:143], v[28:31]
    s_add_u32 m0, s25, 57344
    s_nop 0
    buffer_load_dwordx4 v3, s[12:15], s50 offen lds
    v_mfma_f32_16x16x32_bf16 v[32:35], v[116:119], v[128:131], v[32:35]
    s_add_u32 m0, s25, 61440
    s_nop 0
    buffer_load_dwordx4 v3, s[12:15], s51 offen lds
    v_mfma_f32_16x16x32_bf16 v[36:39], v[116:119], v[132:135], v[36:39]
    s_add_u32 m0, s25, 65536
    s_nop 0
    buffer_load_dwordx4 v3, s[12:15], s52 offen lds
    v_mfma_f32_16x16x32_bf16 v[40:43], v[116:119], v[136:139], v[40:43]
    s_add_u32 m0, s25, 69632
    s_nop 0
    buffer_load_dwordx4 v3, s[12:15], s53 offen lds
    v_mfma_f32_16x16x32_bf16 v[44:47], v[116:119], v[140:143], v[44:47]
    s_add_u32 m0, s25, 73728
    s_nop 0
    buffer_load_dwordx4 v3, s[12:15], s54 offen lds
    v_mfma_f32_16x16x32_bf16 v[48:51], v[120:123], v[128:131], v[48:51]
    s_add_u32 m0, s25, 77824
    s_nop 0
    buffer_load_dwordx4 v3, s[12:15], s55 offen lds
    v_mfma_f32_16x16x32_bf16 v[52:55], v[120:123], v[132:135], v[52:55]
    s_add_u32 s8, s8, 128
    s_addc_u32 s9, s9, 0
    s_add_u32 s12, s12, 128
    s_addc_u32 s13, s13, 0
    v_mfma_f32_16x16x32_bf16 v[56:59], v[120:123], v[136:139], v[56:59]
    v_mfma_f32_16x16x32_bf16 v[60:63], v[120:123], v[140:143], v[60:63]
    v_mfma_f32_16x16x32_bf16 v[64:67], v[124:127], v[128:131], v[64:67]
    v_mfma_f32_16x16x32_bf16 v[68:71], v[124:127], v[132:135], v[68:71]
    v_mfma_f32_16x16x32_bf16 v[72:75], v[124:127], v[136:139], v[72:75]
    v_mfma_f32_16x16x32_bf16 v[76:79], v[124:127], v[140:143], v[76:79]
    ds_read_b128 v[112:115], v9 offset:16384
    ds_read_b128 v[116:119], v9 offset:18432
    ds_read_b128 v[120:123], v9 offset:20480
    ds_read_b128 v[124:127], v9 offset:22528
    ds_read_b128 v[128:131], v13 offset:24576
    ds_read_b128 v[132:135], v13 offset:26624
    ds_read_b128 v[136:139], v13 offset:28672
    ds_read_b128 v[140:143], v13 offset:30720
    s_waitcnt lgkmcnt(8)
    v_mfma_f32_16x16x32_bf16 v[16:19], v[80:83], v[96:99], v[16:19]
    v_mfma_f32_16x16x32_bf16 v[20:23], v[80:83], v[100:103], v[20:23]
    v_mfma_f32_16x16x32_bf16 v[24:27], v[80:83], v[104:107], v[24:27]
    v_mfma_f32_16x16x32_bf16 v[28:31], v[80:83], v[108:111], v[28:31]
    v_mfma_f32_16x16x32_bf16 v[32:35], v[84:87], v[96:99], v[32:35]
    v_mfma_f32_16x16x32_bf16 v[36:39], v[84:87], v[100:103], v[36:39]
    v_mfma_f32_16x16x32_bf16 v[40:43], v[84:87], v[104:107], v[40:43]
    v_mfma_f32_16x16x32_bf16 v[44:47], v[84:87], v[108:111], v[44:47]
    v_mfma_f32_16x16x32_bf16 v[48:51], v[88:91], v[96:99], v[48:51]
    v_mfma_f32_16x16x32_bf16 v[52:55], v[88:91], v[100:103], v[52:55]
    v_mfma_f32_16x16x32_bf16 v[56:59], v[88:91], v[104:107], v[56:59]
    v_mfma_f32_16x16x32_bf16 v[60:63], v[88:91], v[108:111], v[60:63]
    v_mfma_f32_16x16x32_bf16 v[64:67], v[92:95], v[96:99], v[64:67]
    v_mfma_f32_16x16x32_bf16 v[68:71], v[92:95], v[100:103], v[68:71]
    v_mfma_f32_16x16x32_bf16 v[72:75], v[92:95], v[104:107], v[72:75]
    v_mfma_f32_16x16x32_bf16 v[76:79], v[92:95], v[108:111], v[76:79]
    s_waitcnt lgkmcnt(0)
    s_waitcnt vmcnt(10)
    s_barrier
    ds_read_b128 v[80:83], v6 offset:0
    ds_read_b128 v[84:87], v6 offset:2048
    ds_read_b128 v[88:91], v6 offset:4096
    ds_read_b128 v[92:95], v6 offset:6144
    ds_read_b128 v[96:99], v10 offset:8192
    ds_read_b128 v[100:103], v10 offset:10240
    ds_read_b128 v[104:107], v10 offset:12288
    ds_read_b128 v[108:111], v10 offset:14336
    s_add_u32 m0, s25, 81920
    s_nop 0
    buffer_load_dwordx4 v2, s[8:11], s32 offen lds
    v_mfma_f32_16x16x32_bf16 v[16:19], v[112:115], v[128:131], v[16:19]
    s_add_u32 m0, s25, 86016
    s_nop 0
    buffer_load_dwordx4 v2, s[8:11], s33 offen lds
    v_mfma_f32_16x16x32_bf16 v[20:23], v[112:115], v[132:135], v[20:23]
    s_add_u32 m0, s25, 90112
    s_nop 0
    buffer_load_dwordx4 v3, s[12:15], s48 offen lds
    v_mfma_f32_16x16x32_bf16 v[24:27], v[112:115], v[136:139], v[24:27]
    s_add_u32 m0, s25, 94208
    s_nop 0
    buffer_load_dwordx4 v3, s[12:15], s49 offen lds
    v_mfma_f32_16x16x32_bf16 v[28:31], v[112:115], v[140:143], v[28:31]
    s_add_u32 m0, s25, 98304
    s_nop 0
    buffer_load_dwordx4 v3, s[12:15], s50 offen lds
    v_mfma_f32_16x16x32_bf16 v[32:35], v[116:119], v[128:131], v[32:35]
    s_add_u32 m0, s25, 102400
    s_nop 0
    buffer_load_dwordx4 v3, s[12:15], s51 offen lds
    v_mfma_f32_16x16x32_bf16 v[36:39], v[116:119], v[132:135], v[36:39]
    s_add_u32 m0, s25, 106496
    s_nop 0
    buffer_load_dwordx4 v3, s[12:15], s52 offen lds
    v_mfma_f32_16x16x32_bf16 v[40:43], v[116:119], v[136:139], v[40:43]
    s_add_u32 m0, s25, 110592
    s_nop 0
    buffer_load_dwordx4 v3, s[12:15], s53 offen lds
    v_mfma_f32_16x16x32_bf16 v[44:47], v[116:119], v[140:143], v[44:47]
    s_add_u32 m0, s25, 114688
    s_nop 0
    buffer_load_dwordx4 v3, s[12:15], s54 offen lds
    v_mfma_f32_16x16x32_bf16 v[48:51], v[120:123], v[128:131], v[48:51]
    s_add_u32 m0, s25, 118784
    s_nop 0
    buffer_load_dwordx4 v3, s[12:15], s55 offen lds
    v_mfma_f32_16x16x32_bf16 v[52:55], v[120:123], v[132:135], v[52:55]
    s_add_u32 s8, s8, 128
    s_addc_u32 s9, s9, 0
    s_add_u32 s12, s12, 128
    s_addc_u32 s13, s13, 0
    v_mfma_f32_16x16x32_bf16 v[56:59], v[120:123], v[136:139], v[56:59]
    v_mfma_f32_16x16x32_bf16 v[60:63], v[120:123], v[140:143], v[60:63]
    v_mfma_f32_16x16x32_bf16 v[64:67], v[124:127], v[128:131], v[64:67]
    v_mfma_f32_16x16x32_bf16 v[68:71], v[124:127], v[132:135], v[68:71]
    v_mfma_f32_16x16x32_bf16 v[72:75], v[124:127], v[136:139], v[72:75]
    v_mfma_f32_16x16x32_bf16 v[76:79], v[124:127], v[140:143], v[76:79]
    ds_read_b128 v[112:115], v7 offset:0
    ds_read_b128 v[116:119], v7 offset:2048
    ds_read_b128 v[120:123], v7 offset:4096
    ds_read_b128 v[124:127], v7 offset:6144
    ds_read_b128 v[128:131], v11 offset:8192
    ds_read_b128 v[132:135], v11 offset:10240
    ds_read_b128 v[136:139], v11 offset:12288
    ds_read_b128 v[140:143], v11 offset:14336
    s_waitcnt lgkmcnt(8)
    v_mfma_f32_16x16x32_bf16 v[16:19], v[80:83], v[96:99], v[16:19]
    v_mfma_f32_16x16x32_bf16 v[20:23], v[80:83], v[100:103], v[20:23]
    v_mfma_f32_16x16x32_bf16 v[24:27], v[80:83], v[104:107], v[24:27]
    v_mfma_f32_16x16x32_bf16 v[28:31], v[80:83], v[108:111], v[28:31]
    v_mfma_f32_16x16x32_bf16 v[32:35], v[84:87], v[96:99], v[32:35]
    v_mfma_f32_16x16x32_bf16 v[36:39], v[84:87], v[100:103], v[36:39]
    v_mfma_f32_16x16x32_bf16 v[40:43], v[84:87], v[104:107], v[40:43]
    v_mfma_f32_16x16x32_bf16 v[44:47], v[84:87], v[108:111], v[44:47]
    v_mfma_f32_16x16x32_bf16 v[48:51], v[88:91], v[96:99], v[48:51]
    v_mfma_f32_16x16x32_bf16 v[52:55], v[88:91], v[100:103], v[52:55]
    v_mfma_f32_16x16x32_bf16 v[56:59], v[88:91], v[104:107], v[56:59]
    v_mfma_f32_16x16x32_bf16 v[60:63], v[88:91], v[108:111], v[60:63]
    v_mfma_f32_16x16x32_bf16 v[64:67], v[92:95], v[96:99], v[64:67]
    v_mfma_f32_16x16x32_bf16 v[68:71], v[92:95], v[100:103], v[68:71]
    v_mfma_f32_16x16x32_bf16 v[72:75], v[92:95], v[104:107], v[72:75]
    v_mfma_f32_16x16x32_bf16 v[76:79], v[92:95], v[108:111], v[76:79]
    s_waitcnt lgkmcnt(0)
    s_waitcnt vmcnt(10)
    s_barrier
    ds_read_b128 v[80:83], v6 offset:40960
    ds_read_b128 v[84:87], v6 offset:43008
    ds_read_b128 v[88:91], v6 offset:45056
    ds_read_b128 v[92:95], v6 offset:47104
    ds_read_b128 v[96:99], v10 offset:49152
    ds_read_b128 v[100:103], v10 offset:51200
    ds_read_b128 v[104:107], v10 offset:53248
    ds_read_b128 v[108:111], v10 offset:55296
    s_add_u32 m0, s25, 0
    s_nop 0
    buffer_load_dwordx4 v2, s[8:11], s32 offen lds
    v_mfma_f32_16x16x32_bf16 v[16:19], v[112:115], v[128:131], v[16:19]
    s_add_u32 m0, s25, 4096
    s_nop 0
    buffer_load_dwordx4 v2, s[8:11], s33 offen lds
    v_mfma_f32_16x16x32_bf16 v[20:23], v[112:115], v[132:135], v[20:23]
    s_add_u32 m0, s25, 8192
    s_nop 0
    buffer_load_dwordx4 v3, s[12:15], s48 offen lds
    v_mfma_f32_16x16x32_bf16 v[24:27], v[112:115], v[136:139], v[24:27]
    s_add_u32 m0, s25, 12288
    s_nop 0
    buffer_load_dwordx4 v3, s[12:15], s49 offen lds
    v_mfma_f32_16x16x32_bf16 v[28:31], v[112:115], v[140:143], v[28:31]
    s_add_u32 m0, s25, 16384
    s_nop 0
    buffer_load_dwordx4 v3, s[12:15], s50 offen lds
    v_mfma_f32_16x16x32_bf16 v[32:35], v[116:119], v[128:131], v[32:35]
    s_add_u32 m0, s25, 20480
    s_nop 0
    buffer_load_dwordx4 v3, s[12:15], s51 offen lds
    v_mfma_f32_16x16x32_bf16 v[36:39], v[116:119], v[132:135], v[36:39]
    s_add_u32 m0, s25, 24576
    s_nop 0
    buffer_load_dwordx4 v3, s[12:15], s52 offen lds
    v_mfma_f32_16x16x32_bf16 v[40:43], v[116:119], v[136:139], v[40:43]
    s_add_u32 m0, s25, 28672
    s_nop 0
    buffer_load_dwordx4 v3, s[12:15], s53 offen lds
    v_mfma_f32_16x16x32_bf16 v[44:47], v[116:119], v[140:143], v[44:47]
    s_add_u32 m0, s25, 32768
    s_nop 0
    buffer_load_dwordx4 v3, s[12:15], s54 offen lds
    v_mfma_f32_16x16x32_bf16 v[48:51], v[120:123], v[128:131], v[48:51]
    s_add_u32 m0, s25, 36864
    s_nop 0
    buffer_load_dwordx4 v3, s[12:15], s55 offen lds
    v_mfma_f32_16x16x32_bf16 v[52:55], v[120:123], v[132:135], v[52:55]
    s_add_u32 s8, s8, 128
    s_addc_u32 s9, s9, 0
    s_add_u32 s12, s12, 128
    s_addc_u32 s13, s13, 0
    v_mfma_f32_16x16x32_bf16 v[56:59], v[120:123], v[136:139], v[56:59]
    v_mfma_f32_16x16x32_bf16 v[60:63], v[120:123], v[140:143], v[60:63]
    v_mfma_f32_16x16x32_bf16 v[64:67], v[124:127], v[128:131], v[64:67]
    v_mfma_f32_16x16x32_bf16 v[68:71], v[124:127], v[132:135], v[68:71]
    v_mfma_f32_16x16x32_bf16 v[72:75], v[124:127], v[136:139], v[72:75]
    v_mfma_f32_16x16x32_bf16 v[76:79], v[124:127], v[140:143], v[76:79]
    ds_read_b128 v[112:115], v7 offset:40960
    ds_read_b128 v[116:119], v7 offset:43008
    ds_read_b128 v[120:123], v7 offset:45056
    ds_read_b128 v[124:127], v7 offset:47104
    ds_read_b128 v[128:131], v11 offset:49152
    ds_read_b128 v[132:135], v11 offset:51200
    ds_read_b128 v[136:139], v11 offset:53248
    ds_read_b128 v[140:143], v11 offset:55296
    s_waitcnt lgkmcnt(8)
    v_mfma_f32_16x16x32_bf16 v[16:19], v[80:83], v[96:99], v[16:19]
    v_mfma_f32_16x16x32_bf16 v[20:23], v[80:83], v[100:103], v[20:23]
    v_mfma_f32_16x16x32_bf16 v[24:27], v[80:83], v[104:107], v[24:27]
    v_mfma_f32_16x16x32_bf16 v[28:31], v[80:83], v[108:111], v[28:31]
    v_mfma_f32_16x16x32_bf16 v[32:35], v[84:87], v[96:99], v[32:35]
    v_mfma_f32_16x16x32_bf16 v[36:39], v[84:87], v[100:103], v[36:39]
    v_mfma_f32_16x16x32_bf16 v[40:43], v[84:87], v[104:107], v[40:43]
    v_mfma_f32_16x16x32_bf16 v[44:47], v[84:87], v[108:111], v[44:47]
    v_mfma_f32_16x16x32_bf16 v[48:51], v[88:91], v[96:99], v[48:51]
    v_mfma_f32_16x16x32_bf16 v[52:55], v[88:91], v[100:103], v[52:55]
    v_mfma_f32_16x16x32_bf16 v[56:59], v[88:91], v[104:107], v[56:59]
    v_mfma_f32_16x16x32_bf16 v[60:63], v[88:91], v[108:111], v[60:63]
    v_mfma_f32_16x16x32_bf16 v[64:67], v[92:95], v[96:99], v[64:67]
    v_mfma_f32_16x16x32_bf16 v[68:71], v[92:95], v[100:103], v[68:71]
    v_mfma_f32_16x16x32_bf16 v[72:75], v[92:95], v[104:107], v[72:75]
    v_mfma_f32_16x16x32_bf16 v[76:79], v[92:95], v[108:111], v[76:79]
    s_waitcnt lgkmcnt(0)
    s_waitcnt vmcnt(10)
    s_barrier
    ds_read_b128 v[80:83], v8 offset:16384
    ds_read_b128 v[84:87], v8 offset:18432
    ds_read_b128 v[88:91], v8 offset:20480
    ds_read_b128 v[92:95], v8 offset:22528
    ds_read_b128 v[96:99], v12 offset:24576
    ds_read_b128 v[100:103], v12 offset:26624
    ds_read_b128 v[104:107], v12 offset:28672
    ds_read_b128 v[108:111], v12 offset:30720
    s_add_u32 m0, s25, 40960
    s_nop 0
    buffer_load_dwordx4 v2, s[8:11], s32 offen lds
    v_mfma_f32_16x16x32_bf16 v[16:19], v[112:115], v[128:131], v[16:19]
    s_add_u32 m0, s25, 45056
    s_nop 0
    buffer_load_dwordx4 v2, s[8:11], s33 offen lds
    v_mfma_f32_16x16x32_bf16 v[20:23], v[112:115], v[132:135], v[20:23]
    s_add_u32 m0, s25, 49152
    s_nop 0
    buffer_load_dwordx4 v3, s[12:15], s48 offen lds
    v_mfma_f32_16x16x32_bf16 v[24:27], v[112:115], v[136:139], v[24:27]
    s_add_u32 m0, s25, 53248
    s_nop 0
    buffer_load_dwordx4 v3, s[12:15], s49 offen lds
    v_mfma_f32_16x16x32_bf16 v[28:31], v[112:115], v[140:143], v[28:31]
    s_add_u32 m0, s25, 57344
    s_nop 0
    buffer_load_dwordx4 v3, s[12:15], s50 offen lds
    v_mfma_f32_16x16x32_bf16 v[32:35], v[116:119], v[128:131], v[32:35]
    s_add_u32 m0, s25, 61440
    s_nop 0
    buffer_load_dwordx4 v3, s[12:15], s51 offen lds
    v_mfma_f32_16x16x32_bf16 v[36:39], v[116:119], v[132:135], v[36:39]
    s_add_u32 m0, s25, 65536
    s_nop 0
    buffer_load_dwordx4 v3, s[12:15], s52 offen lds
    v_mfma_f32_16x16x32_bf16 v[40:43], v[116:119], v[136:139], v[40:43]
    s_add_u32 m0, s25, 69632
    s_nop 0
    buffer_load_dwordx4 v3, s[12:15], s53 offen lds
    v_mfma_f32_16x16x32_bf16 v[44:47], v[116:119], v[140:143], v[44:47]
    s_add_u32 m0, s25, 73728
    s_nop 0
    buffer_load_dwordx4 v3, s[12:15], s54 offen lds
    v_mfma_f32_16x16x32_bf16 v[48:51], v[120:123], v[128:131], v[48:51]
    s_add_u32 m0, s25, 77824
    s_nop 0
    buffer_load_dwordx4 v3, s[12:15], s55 offen lds
    v_mfma_f32_16x16x32_bf16 v[52:55], v[120:123], v[132:135], v[52:55]
    s_add_u32 s8, s8, 128
    s_addc_u32 s9, s9, 0
    s_add_u32 s12, s12, 128
    s_addc_u32 s13, s13, 0
    v_mfma_f32_16x16x32_bf16 v[56:59], v[120:123], v[136:139], v[56:59]
    v_mfma_f32_16x16x32_bf16 v[60:63], v[120:123], v[140:143], v[60:63]
    v_mfma_f32_16x16x32_bf16 v[64:67], v[124:127], v[128:131], v[64:67]
    v_mfma_f32_16x16x32_bf16 v[68:71], v[124:127], v[132:135], v[68:71]
    v_mfma_f32_16x16x32_bf16 v[72:75], v[124:127], v[136:139], v[72:75]
    v_mfma_f32_16x16x32_bf16 v[76:79], v[124:127], v[140:143], v[76:79]
    ds_read_b128 v[112:115], v9 offset:16384
    ds_read_b128 v[116:119], v9 offset:18432
    ds_read_b128 v[120:123], v9 offset:20480
    ds_read_b128 v[124:127], v9 offset:22528
    ds_read_b128 v[128:131], v13 offset:24576
    ds_read_b128 v[132:135], v13 offset:26624
    ds_read_b128 v[136:139], v13 offset:28672
    ds_read_b128 v[140:143], v13 offset:30720
    s_waitcnt lgkmcnt(8)
    v_mfma_f32_16x16x32_bf16 v[16:19], v[80:83], v[96:99], v[16:19]
    v_mfma_f32_16x16x32_bf16 v[20:23], v[80:83], v[100:103], v[20:23]
    v_mfma_f32_16x16x32_bf16 v[24:27], v[80:83], v[104:107], v[24:27]
    v_mfma_f32_16x16x32_bf16 v[28:31], v[80:83], v[108:111], v[28:31]
    v_mfma_f32_16x16x32_bf16 v[32:35], v[84:87], v[96:99], v[32:35]
    v_mfma_f32_16x16x32_bf16 v[36:39], v[84:87], v[100:103], v[36:39]
    v_mfma_f32_16x16x32_bf16 v[40:43], v[84:87], v[104:107], v[40:43]
    v_mfma_f32_16x16x32_bf16 v[44:47], v[84:87], v[108:111], v[44:47]
    v_mfma_f32_16x16x32_bf16 v[48:51], v[88:91], v[96:99], v[48:51]
    v_mfma_f32_16x16x32_bf16 v[52:55], v[88:91], v[100:103], v[52:55]
    v_mfma_f32_16x16x32_bf16 v[56:59], v[88:91], v[104:107], v[56:59]
    v_mfma_f32_16x16x32_bf16 v[60:63], v[88:91], v[108:111], v[60:63]
    v_mfma_f32_16x16x32_bf16 v[64:67], v[92:95], v[96:99], v[64:67]
    v_mfma_f32_16x16x32_bf16 v[68:71], v[92:95], v[100:103], v[68:71]
    v_mfma_f32_16x16x32_bf16 v[72:75], v[92:95], v[104:107], v[72:75]
    v_mfma_f32_16x16x32_bf16 v[76:79], v[92:95], v[108:111], v[76:79]
    s_waitcnt lgkmcnt(0)
    s_waitcnt vmcnt(10)
    s_barrier
    ds_read_b128 v[80:83], v6 offset:0
    ds_read_b128 v[84:87], v6 offset:2048
    ds_read_b128 v[88:91], v6 offset:4096
    ds_read_b128 v[92:95], v6 offset:6144
    ds_read_b128 v[96:99], v10 offset:8192
    ds_read_b128 v[100:103], v10 offset:10240
    ds_read_b128 v[104:107], v10 offset:12288
    ds_read_b128 v[108:111], v10 offset:14336
    s_add_u32 m0, s25, 81920
    s_nop 0
    buffer_load_dwordx4 v2, s[8:11], s32 offen lds
    v_mfma_f32_16x16x32_bf16 v[16:19], v[112:115], v[128:131], v[16:19]
    s_add_u32 m0, s25, 86016
    s_nop 0
    buffer_load_dwordx4 v2, s[8:11], s33 offen lds
    v_mfma_f32_16x16x32_bf16 v[20:23], v[112:115], v[132:135], v[20:23]
    s_add_u32 m0, s25, 90112
    s_nop 0
    buffer_load_dwordx4 v3, s[12:15], s48 offen lds
    v_mfma_f32_16x16x32_bf16 v[24:27], v[112:115], v[136:139], v[24:27]
    s_add_u32 m0, s25, 94208
    s_nop 0
    buffer_load_dwordx4 v3, s[12:15], s49 offen lds
    v_mfma_f32_16x16x32_bf16 v[28:31], v[112:115], v[140:143], v[28:31]
    s_add_u32 m0, s25, 98304
    s_nop 0
    buffer_load_dwordx4 v3, s[12:15], s50 offen lds
    v_mfma_f32_16x16x32_bf16 v[32:35], v[116:119], v[128:131], v[32:35]
    s_add_u32 m0, s25, 102400
    s_nop 0
    buffer_load_dwordx4 v3, s[12:15], s51 offen lds
    v_mfma_f32_16x16x32_bf16 v[36:39], v[116:119], v[132:135], v[36:39]
    s_add_u32 m0, s25, 106496
    s_nop 0
    buffer_load_dwordx4 v3, s[12:15], s52 offen lds
    v_mfma_f32_16x16x32_bf16 v[40:43], v[116:119], v[136:139], v[40:43]
    s_add_u32 m0, s25, 110592
    s_nop 0
    buffer_load_dwordx4 v3, s[12:15], s53 offen lds
    v_mfma_f32_16x16x32_bf16 v[44:47], v[116:119], v[140:143], v[44:47]
    s_add_u32 m0, s25, 114688
    s_nop 0
    buffer_load_dwordx4 v3, s[12:15], s54 offen lds
    v_mfma_f32_16x16x32_bf16 v[48:51], v[120:123], v[128:131], v[48:51]
    s_add_u32 m0, s25, 118784
    s_nop 0
    buffer_load_dwordx4 v3, s[12:15], s55 offen lds
    v_mfma_f32_16x16x32_bf16 v[52:55], v[120:123], v[132:135], v[52:55]
    s_add_u32 s8, s8, 128
    s_addc_u32 s9, s9, 0
    s_add_u32 s12, s12, 128
    s_addc_u32 s13, s13, 0
    v_mfma_f32_16x16x32_bf16 v[56:59], v[120:123], v[136:139], v[56:59]
    v_mfma_f32_16x16x32_bf16 v[60:63], v[120:123], v[140:143], v[60:63]
    v_mfma_f32_16x16x32_bf16 v[64:67], v[124:127], v[128:131], v[64:67]
    v_mfma_f32_16x16x32_bf16 v[68:71], v[124:127], v[132:135], v[68:71]
    v_mfma_f32_16x16x32_bf16 v[72:75], v[124:127], v[136:139], v[72:75]
    v_mfma_f32_16x16x32_bf16 v[76:79], v[124:127], v[140:143], v[76:79]
    ds_read_b128 v[112:115], v7 offset:0
    ds_read_b128 v[116:119], v7 offset:2048
    ds_read_b128 v[120:123], v7 offset:4096
    ds_read_b128 v[124:127], v7 offset:6144
    ds_read_b128 v[128:131], v11 offset:8192
    ds_read_b128 v[132:135], v11 offset:10240
    ds_read_b128 v[136:139], v11 offset:12288
    ds_read_b128 v[140:143], v11 offset:14336
    s_waitcnt lgkmcnt(8)
    v_mfma_f32_16x16x32_bf16 v[16:19], v[80:83], v[96:99], v[16:19]
    v_mfma_f32_16x16x32_bf16 v[20:23], v[80:83], v[100:103], v[20:23]
    v_mfma_f32_16x16x32_bf16 v[24:27], v[80:83], v[104:107], v[24:27]
    v_mfma_f32_16x16x32_bf16 v[28:31], v[80:83], v[108:111], v[28:31]
    v_mfma_f32_16x16x32_bf16 v[32:35], v[84:87], v[96:99], v[32:35]
    v_mfma_f32_16x16x32_bf16 v[36:39], v[84:87], v[100:103], v[36:39]
    v_mfma_f32_16x16x32_bf16 v[40:43], v[84:87], v[104:107], v[40:43]
    v_mfma_f32_16x16x32_bf16 v[44:47], v[84:87], v[108:111], v[44:47]
    v_mfma_f32_16x16x32_bf16 v[48:51], v[88:91], v[96:99], v[48:51]
    v_mfma_f32_16x16x32_bf16 v[52:55], v[88:91], v[100:103], v[52:55]
    v_mfma_f32_16x16x32_bf16 v[56:59], v[88:91], v[104:107], v[56:59]
    v_mfma_f32_16x16x32_bf16 v[60:63], v[88:91], v[108:111], v[60:63]
    v_mfma_f32_16x16x32_bf16 v[64:67], v[92:95], v[96:99], v[64:67]
    v_mfma_f32_16x16x32_bf16 v[68:71], v[92:95], v[100:103], v[68:71]
    v_mfma_f32_16x16x32_bf16 v[72:75], v[92:95], v[104:107], v[72:75]
    v_mfma_f32_16x16x32_bf16 v[76:79], v[92:95], v[108:111], v[76:79]
    s_waitcnt lgkmcnt(0)
    s_waitcnt vmcnt(10)
    s_barrier
    ds_read_b128 v[80:83], v6 offset:40960
    ds_read_b128 v[84:87], v6 offset:43008
    ds_read_b128 v[88:91], v6 offset:45056
    ds_read_b128 v[92:95], v6 offset:47104
    ds_read_b128 v[96:99], v10 offset:49152
    ds_read_b128 v[100:103], v10 offset:51200
    ds_read_b128 v[104:107], v10 offset:53248
    ds_read_b128 v[108:111], v10 offset:55296
    v_mfma_f32_16x16x32_bf16 v[16:19], v[112:115], v[128:131], v[16:19]
    v_mfma_f32_16x16x32_bf16 v[20:23], v[112:115], v[132:135], v[20:23]
    v_mfma_f32_16x16x32_bf16 v[24:27], v[112:115], v[136:139], v[24:27]
    v_mfma_f32_16x16x32_bf16 v[28:31], v[112:115], v[140:143], v[28:31]
    v_mfma_f32_16x16x32_bf16 v[32:35], v[116:119], v[128:131], v[32:35]
    v_mfma_f32_16x16x32_bf16 v[36:39], v[116:119], v[132:135], v[36:39]
    v_mfma_f32_16x16x32_bf16 v[40:43], v[116:119], v[136:139], v[40:43]
    v_mfma_f32_16x16x32_bf16 v[44:47], v[116:119], v[140:143], v[44:47]
    v_mfma_f32_16x16x32_bf16 v[48:51], v[120:123], v[128:131], v[48:51]
    v_mfma_f32_16x16x32_bf16 v[52:55], v[120:123], v[132:135], v[52:55]
    v_mfma_f32_16x16x32_bf16 v[56:59], v[120:123], v[136:139], v[56:59]
    v_mfma_f32_16x16x32_bf16 v[60:63], v[120:123], v[140:143], v[60:63]
    v_mfma_f32_16x16x32_bf16 v[64:67], v[124:127], v[128:131], v[64:67]
    v_mfma_f32_16x16x32_bf16 v[68:71], v[124:127], v[132:135], v[68:71]
    v_mfma_f32_16x16x32_bf16 v[72:75], v[124:127], v[136:139], v[72:75]
    v_mfma_f32_16x16x32_bf16 v[76:79], v[124:127], v[140:143], v[76:79]
    ds_read_b128 v[112:115], v7 offset:40960
    ds_read_b128 v[116:119], v7 offset:43008
    ds_read_b128 v[120:123], v7 offset:45056
    ds_read_b128 v[124:127], v7 offset:47104
    ds_read_b128 v[128:131], v11 offset:49152
    ds_read_b128 v[132:135], v11 offset:51200
    ds_read_b128 v[136:139], v11 offset:53248
    ds_read_b128 v[140:143], v11 offset:55296
    s_waitcnt lgkmcnt(8)
    v_mfma_f32_16x16x32_bf16 v[16:19], v[80:83], v[96:99], v[16:19]
    v_mfma_f32_16x16x32_bf16 v[20:23], v[80:83], v[100:103], v[20:23]
    v_mfma_f32_16x16x32_bf16 v[24:27], v[80:83], v[104:107], v[24:27]
    v_mfma_f32_16x16x32_bf16 v[28:31], v[80:83], v[108:111], v[28:31]
    v_mfma_f32_16x16x32_bf16 v[32:35], v[84:87], v[96:99], v[32:35]
    v_mfma_f32_16x16x32_bf16 v[36:39], v[84:87], v[100:103], v[36:39]
    v_mfma_f32_16x16x32_bf16 v[40:43], v[84:87], v[104:107], v[40:43]
    v_mfma_f32_16x16x32_bf16 v[44:47], v[84:87], v[108:111], v[44:47]
    v_mfma_f32_16x16x32_bf16 v[48:51], v[88:91], v[96:99], v[48:51]
    v_mfma_f32_16x16x32_bf16 v[52:55], v[88:91], v[100:103], v[52:55]
    v_mfma_f32_16x16x32_bf16 v[56:59], v[88:91], v[104:107], v[56:59]
    v_mfma_f32_16x16x32_bf16 v[60:63], v[88:91], v[108:111], v[60:63]
    v_mfma_f32_16x16x32_bf16 v[64:67], v[92:95], v[96:99], v[64:67]
    v_mfma_f32_16x16x32_bf16 v[68:71], v[92:95], v[100:103], v[68:71]
    v_mfma_f32_16x16x32_bf16 v[72:75], v[92:95], v[104:107], v[72:75]
    v_mfma_f32_16x16x32_bf16 v[76:79], v[92:95], v[108:111], v[76:79]
    s_waitcnt lgkmcnt(0)
    s_waitcnt vmcnt(0)
    s_barrier
    ds_read_b128 v[80:83], v8 offset:16384
    ds_read_b128 v[84:87], v8 offset:18432
    ds_read_b128 v[88:91], v8 offset:20480
    ds_read_b128 v[92:95], v8 offset:22528
    ds_read_b128 v[96:99], v12 offset:24576
    ds_read_b128 v[100:103], v12 offset:26624
    ds_read_b128 v[104:107], v12 offset:28672
    ds_read_b128 v[108:111], v12 offset:30720
    v_mfma_f32_16x16x32_bf16 v[16:19], v[112:115], v[128:131], v[16:19]
    v_mfma_f32_16x16x32_bf16 v[20:23], v[112:115], v[132:135], v[20:23]
    v_mfma_f32_16x16x32_bf16 v[24:27], v[112:115], v[136:139], v[24:27]
    v_mfma_f32_16x16x32_bf16 v[28:31], v[112:115], v[140:143], v[28:31]
    v_mfma_f32_16x16x32_bf16 v[32:35], v[116:119], v[128:131], v[32:35]
    v_mfma_f32_16x16x32_bf16 v[36:39], v[116:119], v[132:135], v[36:39]
    v_mfma_f32_16x16x32_bf16 v[40:43], v[116:119], v[136:139], v[40:43]
    v_mfma_f32_16x16x32_bf16 v[44:47], v[116:119], v[140:143], v[44:47]
    v_mfma_f32_16x16x32_bf16 v[48:51], v[120:123], v[128:131], v[48:51]
    v_mfma_f32_16x16x32_bf16 v[52:55], v[120:123], v[132:135], v[52:55]
    v_mfma_f32_16x16x32_bf16 v[56:59], v[120:123], v[136:139], v[56:59]
    v_mfma_f32_16x16x32_bf16 v[60:63], v[120:123], v[140:143], v[60:63]
    v_mfma_f32_16x16x32_bf16 v[64:67], v[124:127], v[128:131], v[64:67]
    v_mfma_f32_16x16x32_bf16 v[68:71], v[124:127], v[132:135], v[68:71]
    v_mfma_f32_16x16x32_bf16 v[72:75], v[124:127], v[136:139], v[72:75]
    v_mfma_f32_16x16x32_bf16 v[76:79], v[124:127], v[140:143], v[76:79]
    ds_read_b128 v[112:115], v9 offset:16384
    ds_read_b128 v[116:119], v9 offset:18432
    ds_read_b128 v[120:123], v9 offset:20480
    ds_read_b128 v[124:127], v9 offset:22528
    ds_read_b128 v[128:131], v13 offset:24576
    ds_read_b128 v[132:135], v13 offset:26624
    ds_read_b128 v[136:139], v13 offset:28672
    ds_read_b128 v[140:143], v13 offset:30720
    s_waitcnt lgkmcnt(8)
    v_mfma_f32_16x16x32_bf16 v[16:19], v[80:83], v[96:99], v[16:19]
    v_mfma_f32_16x16x32_bf16 v[20:23], v[80:83], v[100:103], v[20:23]
    v_mfma_f32_16x16x32_bf16 v[24:27], v[80:83], v[104:107], v[24:27]
    v_mfma_f32_16x16x32_bf16 v[28:31], v[80:83], v[108:111], v[28:31]
    v_mfma_f32_16x16x32_bf16 v[32:35], v[84:87], v[96:99], v[32:35]
    v_mfma_f32_16x16x32_bf16 v[36:39], v[84:87], v[100:103], v[36:39]
    v_mfma_f32_16x16x32_bf16 v[40:43], v[84:87], v[104:107], v[40:43]
    v_mfma_f32_16x16x32_bf16 v[44:47], v[84:87], v[108:111], v[44:47]
    v_mfma_f32_16x16x32_bf16 v[48:51], v[88:91], v[96:99], v[48:51]
    v_mfma_f32_16x16x32_bf16 v[52:55], v[88:91], v[100:103], v[52:55]
    v_mfma_f32_16x16x32_bf16 v[56:59], v[88:91], v[104:107], v[56:59]
    v_mfma_f32_16x16x32_bf16 v[60:63], v[88:91], v[108:111], v[60:63]
    v_mfma_f32_16x16x32_bf16 v[64:67], v[92:95], v[96:99], v[64:67]
    v_mfma_f32_16x16x32_bf16 v[68:71], v[92:95], v[100:103], v[68:71]
    v_mfma_f32_16x16x32_bf16 v[72:75], v[92:95], v[104:107], v[72:75]
    v_mfma_f32_16x16x32_bf16 v[76:79], v[92:95], v[108:111], v[76:79]
    s_waitcnt lgkmcnt(0)
    v_mfma_f32_16x16x32_bf16 v[16:19], v[112:115], v[128:131], v[16:19]
    v_mfma_f32_16x16x32_bf16 v[20:23], v[112:115], v[132:135], v[20:23]
    v_mfma_f32_16x16x32_bf16 v[24:27], v[112:115], v[136:139], v[24:27]
    v_mfma_f32_16x16x32_bf16 v[28:31], v[112:115], v[140:143], v[28:31]
    v_mfma_f32_16x16x32_bf16 v[32:35], v[116:119], v[128:131], v[32:35]
    v_mfma_f32_16x16x32_bf16 v[36:39], v[116:119], v[132:135], v[36:39]
    v_mfma_f32_16x16x32_bf16 v[40:43], v[116:119], v[136:139], v[40:43]
    v_mfma_f32_16x16x32_bf16 v[44:47], v[116:119], v[140:143], v[44:47]
    v_mfma_f32_16x16x32_bf16 v[48:51], v[120:123], v[128:131], v[48:51]
    v_mfma_f32_16x16x32_bf16 v[52:55], v[120:123], v[132:135], v[52:55]
    v_mfma_f32_16x16x32_bf16 v[56:59], v[120:123], v[136:139], v[56:59]
    v_mfma_f32_16x16x32_bf16 v[60:63], v[120:123], v[140:143], v[60:63]
    v_mfma_f32_16x16x32_bf16 v[64:67], v[124:127], v[128:131], v[64:67]
    v_mfma_f32_16x16x32_bf16 v[68:71], v[124:127], v[132:135], v[68:71]
    v_mfma_f32_16x16x32_bf16 v[72:75], v[124:127], v[136:139], v[72:75]
    v_mfma_f32_16x16x32_bf16 v[76:79], v[124:127], v[140:143], v[76:79]
    s_nop 7
    s_nop 7
    s_mul_i32 s28, s27, 256
    s_lshr_b32 s29, s24, 0
    s_mul_i32 s29, s29, 64
    s_add_u32 s28, s28, s29
    s_mul_i32 s29, s26, 64
    s_and_b32 s30, s24, 0
    s_mul_i32 s30, s30, 64
    s_add_u32 s29, s29, s30
    s_lshl_b32 s29, s29, 1
    v_and_b32 v4, 15, v1
    v_add_u32 v4, s28, v4
    s_mov_b32 s30, 3456
    v_mul_lo_u32 v4, v4, s30
    v_lshrrev_b32 v5, 4, v1
    v_lshlrev_b32 v5, 3, v5
    v_add_u32 v4, v4, v5
    v_add_u32 v4, s29, v4
    s_mov_b32 s31, 0
    v_cvt_pk_bf16_f32 v80, v16, v17
    v_cvt_pk_bf16_f32 v81, v18, v19
    buffer_store_dwordx2 v[80:81], v4, s[16:19], s31 offen
    s_mov_b32 s31, 32
    v_cvt_pk_bf16_f32 v80, v32, v33
    v_cvt_pk_bf16_f32 v81, v34, v35
    buffer_store_dwordx2 v[80:81], v4, s[16:19], s31 offen
    s_mov_b32 s31, 64
    v_cvt_pk_bf16_f32 v80, v48, v49
    v_cvt_pk_bf16_f32 v81, v50, v51
    buffer_store_dwordx2 v[80:81], v4, s[16:19], s31 offen
    s_mov_b32 s31, 96
    v_cvt_pk_bf16_f32 v80, v64, v65
    v_cvt_pk_bf16_f32 v81, v66, v67
    buffer_store_dwordx2 v[80:81], v4, s[16:19], s31 offen
    s_mov_b32 s31, 55296
    v_cvt_pk_bf16_f32 v80, v20, v21
    v_cvt_pk_bf16_f32 v81, v22, v23
    buffer_store_dwordx2 v[80:81], v4, s[16:19], s31 offen
    s_mov_b32 s31, 55328
    v_cvt_pk_bf16_f32 v80, v36, v37
    v_cvt_pk_bf16_f32 v81, v38, v39
    buffer_store_dwordx2 v[80:81], v4, s[16:19], s31 offen
    s_mov_b32 s31, 55360
    v_cvt_pk_bf16_f32 v80, v52, v53
    v_cvt_pk_bf16_f32 v81, v54, v55
    buffer_store_dwordx2 v[80:81], v4, s[16:19], s31 offen
    s_mov_b32 s31, 55392
    v_cvt_pk_bf16_f32 v80, v68, v69
    v_cvt_pk_bf16_f32 v81, v70, v71
    buffer_store_dwordx2 v[80:81], v4, s[16:19], s31 offen
    s_mov_b32 s31, 110592
    v_cvt_pk_bf16_f32 v80, v24, v25
    v_cvt_pk_bf16_f32 v81, v26, v27
    buffer_store_dwordx2 v[80:81], v4, s[16:19], s31 offen
    s_mov_b32 s31, 110624
    v_cvt_pk_bf16_f32 v80, v40, v41
    v_cvt_pk_bf16_f32 v81, v42, v43
    buffer_store_dwordx2 v[80:81], v4, s[16:19], s31 offen
    s_mov_b32 s31, 110656
    v_cvt_pk_bf16_f32 v80, v56, v57
    v_cvt_pk_bf16_f32 v81, v58, v59
    buffer_store_dwordx2 v[80:81], v4, s[16:19], s31 offen
    s_mov_b32 s31, 110688
    v_cvt_pk_bf16_f32 v80, v72, v73
    v_cvt_pk_bf16_f32 v81, v74, v75
    buffer_store_dwordx2 v[80:81], v4, s[16:19], s31 offen
    s_mov_b32 s31, 165888
    v_cvt_pk_bf16_f32 v80, v28, v29
    v_cvt_pk_bf16_f32 v81, v30, v31
    buffer_store_dwordx2 v[80:81], v4, s[16:19], s31 offen
    s_mov_b32 s31, 165920
    v_cvt_pk_bf16_f32 v80, v44, v45
    v_cvt_pk_bf16_f32 v81, v46, v47
    buffer_store_dwordx2 v[80:81], v4, s[16:19], s31 offen
    s_mov_b32 s31, 165952
    v_cvt_pk_bf16_f32 v80, v60, v61
    v_cvt_pk_bf16_f32 v81, v62, v63
    buffer_store_dwordx2 v[80:81], v4, s[16:19], s31 offen
    s_mov_b32 s31, 165984
    v_cvt_pk_bf16_f32 v80, v76, v77
    v_cvt_pk_bf16_f32 v81, v78, v79
    buffer_store_dwordx2 v[80:81], v4, s[16:19], s31 offen
g1_kernel_end:
    s_endpgm
.section .rodata,"a"
.p2align 6
.amdhsa_kernel g1_kernel
  .amdhsa_next_free_vgpr 152
  .amdhsa_next_free_sgpr 102
  .amdhsa_accum_offset 152
  .amdhsa_group_segment_fixed_size 0
  .amdhsa_kernarg_size 96
  .amdhsa_user_sgpr_count 2
  .amdhsa_user_sgpr_kernarg_segment_ptr 1
  .amdhsa_system_sgpr_workgroup_id_x 1
.end_amdhsa_kernel
.text
.globl kv_kernel
.p2align 8
.type kv_kernel,@function
kv_kernel:
    s_cmp_ge_u32 s2, 256
    s_cbranch_scc1 kv_kernel_end
    s_load_dwordx2 s[4:5], s[0:1], 88
    s_load_dwordx2 s[6:7], s[0:1], 16
    v_and_b32 v1, 63, v0
    v_lshrrev_b32 v2, 6, v0
    s_nop 0
    v_readfirstlane_b32 s24, v2
    s_and_b32 s26, s2, 31
    s_lshr_b32 s27, s2, 5
    s_waitcnt lgkmcnt(0)
    s_add_u32 s8, s4, 0x240000
    s_addc_u32 s9, s5, 0
    s_mov_b32 s10, 0x6c0000
    s_mov_b32 s11, 0x00020000
    s_add_u32 s12, s4, 0x1db0000
    s_addc_u32 s13, s5, 0
    s_mov_b32 s14, 0xb4000
    s_mov_b32 s15, 0x00020000
    s_mov_b32 s16, s6
    s_mov_b32 s17, s7
    s_mov_b32 s18, 0x5100
    s_mov_b32 s19, 0x00020000
    s_lshl_b32 s28, s27, 8
    s_lshl_b32 s29, s24, 6
    s_add_u32 s28, s28, s29
    v_add_u32 v3, s28, v1
    s_mov_b32 s29, 3456
    v_mul_lo_u32 v3, v3, s29
    s_mul_i32 s30, s26, 36
    s_add_u32 s31, s30, 1152
    s_add_u32 s30, s30, 2304
    buffer_load_dwordx4 v[8:11], v3, s[8:11], s31 offen
    buffer_load_dwordx4 v[12:15], v3, s[8:11], s31 offen offset:16
    buffer_load_dword v16, v3, s[8:11], s31 offen offset:32
    buffer_load_dwordx4 v[20:23], v3, s[8:11], s30 offen
    buffer_load_dwordx4 v[24:27], v3, s[8:11], s30 offen offset:16
    buffer_load_dword v28, v3, s[8:11], s30 offen offset:32
    s_mul_i32 s28, s26, 648
    v_lshlrev_b32 v4, 1, v0
    buffer_load_ushort v5, v4, s[16:19], s28 offen offset:0
    v_cmp_gt_u32 vcc, 68, v0
    s_and_saveexec_b64 s[32:33], vcc
    v_lshlrev_b32 v4, 1, v0
    buffer_load_ushort v6, v4, s[16:19], s28 offen offset:512
    s_mov_b64 exec, s[32:33]
    s_waitcnt vmcnt(0)
    v_lshlrev_b32 v5, 16, v5
    v_lshlrev_b32 v4, 2, v0
    ds_write_b32 v4, v5 offset:46080
    v_cmp_gt_u32 vcc, 68, v0
    s_and_saveexec_b64 s[32:33], vcc
    v_lshlrev_b32 v6, 16, v6
    v_lshlrev_b32 v4, 2, v0
    ds_write_b32 v4, v6 offset:47104
    s_mov_b64 exec, s[32:33]
    v_mov_b32 v7, 0
    s_waitcnt lgkmcnt(0)
    s_barrier
    v_lshlrev_b32 v32, 16, v8
    v_and_b32 v33, 0xffff0000, v8
    v_lshlrev_b32 v34, 16, v9
    v_and_b32 v35, 0xffff0000, v9
    v_lshlrev_b32 v36, 16, v10
    v_and_b32 v37, 0xffff0000, v10
    v_lshlrev_b32 v38, 16, v11
    v_and_b32 v39, 0xffff0000, v11
    v_lshlrev_b32 v40, 16, v12
    v_and_b32 v41, 0xffff0000, v12
    v_lshlrev_b32 v42, 16, v13
    v_and_b32 v43, 0xffff0000, v13
    v_lshlrev_b32 v44, 16, v14
    v_and_b32 v45, 0xffff0000, v14
    v_lshlrev_b32 v46, 16, v15
    v_and_b32 v47, 0xffff0000, v15
    v_lshlrev_b32 v48, 16, v16
    v_and_b32 v49, 0xffff0000, v16
    v_mov_b32 v52, 0
    v_mov_b32 v53, 0
    v_mov_b32 v54, 0
    v_mov_b32 v55, 0
    v_mov_b32 v56, 0
    v_mov_b32 v57, 0
    v_mov_b32 v58, 0
    v_mov_b32 v59, 0
    v_mov_b32 v60, 0
    v_mov_b32 v61, 0
    v_mov_b32 v62, 0
    v_mov_b32 v63, 0
    v_mov_b32 v64, 0
    v_mov_b32 v65, 0
    v_mov_b32 v66, 0
    v_mov_b32 v67, 0
    v_mov_b32 v68, 0
    v_mov_b32 v69, 0
    ds_read_b128 v[124:127], v7 offset:46080
    ds_read_b128 v[128:131], v7 offset:46096
    ds_read_b128 v[132:135], v7 offset:46112
    ds_read_b128 v[136:139], v7 offset:46128
    s_waitcnt lgkmcnt(3)
    v_pk_fma_f32 v[52:53], v[124:125], v[32:33], v[52:53] op_sel:[0,0,0] op_sel_hi:[1,0,1]
    v_pk_fma_f32 v[54:55], v[126:127], v[32:33], v[54:55] op_sel:[0,0,0] op_sel_hi:[1,0,1]
    ds_read_b128 v[124:127], v7 offset:46144
    s_waitcnt lgkmcnt(3)
    v_pk_fma_f32 v[56:57], v[128:129], v[32:33], v[56:57] op_sel:[0,0,0] op_sel_hi:[1,0,1]
    v_pk_fma_f32 v[58:59], v[130:131], v[32:33], v[58:59] op_sel:[0,0,0] op_sel_hi:[1,0,1]
    ds_read_b128 v[128:131], v7 offset:46160
    s_waitcnt lgkmcnt(3)
    v_pk_fma_f32 v[60:61], v[132:133], v[32:33], v[60:61] op_sel:[0,0,0] op_sel_hi:[1,0,1]
    v_pk_fma_f32 v[62:63], v[134:135], v[32:33], v[62:63] op_sel:[0,0,0] op_sel_hi:[1,0,1]
    ds_read_b128 v[132:135], v7 offset:46176
    s_waitcnt lgkmcnt(3)
    v_pk_fma_f32 v[64:65], v[136:137], v[32:33], v[64:65] op_sel:[0,0,0] op_sel_hi:[1,0,1]
    v_pk_fma_f32 v[66:67], v[138:139], v[32:33], v[66:67] op_sel:[0,0,0] op_sel_hi:[1,0,1]
    ds_read_b128 v[136:139], v7 offset:46192
    s_waitcnt lgkmcnt(3)
    v_pk_fma_f32 v[68:69], v[124:125], v[32:33], v[68:69] op_sel:[0,0,0] op_sel_hi:[1,0,1]
    v_pk_fma_f32 v[52:53], v[126:127], v[32:33], v[52:53] op_sel:[0,1,0] op_sel_hi:[1,1,1]
    ds_read_b128 v[124:127], v7 offset:46208
    s_waitcnt lgkmcnt(3)
    v_pk_fma_f32 v[54:55], v[128:129], v[32:33], v[54:55] op_sel:[0,1,0] op_sel_hi:[1,1,1]
    v_pk_fma_f32 v[56:57], v[130:131], v[32:33], v[56:57] op_sel:[0,1,0] op_sel_hi:[1,1,1]
    ds_read_b128 v[128:131], v7 offset:46224
    s_waitcnt lgkmcnt(3)
    v_pk_fma_f32 v[58:59], v[132:133], v[32:33], v[58:59] op_sel:[0,1,0] op_sel_hi:[1,1,1]
    v_pk_fma_f32 v[60:61], v[134:135], v[32:33], v[60:61] op_sel:[0,1,0] op_sel_hi:[1,1,1]
    ds_read_b128 v[132:135], v7 offset:46240
    s_waitcnt lgkmcnt(3)
    v_pk_fma_f32 v[62:63], v[136:137], v[32:33], v[62:63] op_sel:[0,1,0] op_sel_hi:[1,1,1]
    v_pk_fma_f32 v[64:65], v[138:139], v[32:33], v[64:65] op_sel:[0,1,0] op_sel_hi:[1,1,1]
    ds_read_b128 v[136:139], v7 offset:46256
    s_waitcnt lgkmcnt(3)
    v_pk_fma_f32 v[66:67], v[124:125], v[32:33], v[66:67] op_sel:[0,1,0] op_sel_hi:[1,1,1]
    v_pk_fma_f32 v[68:69], v[126:127], v[32:33], v[68:69] op_sel:[0,1,0] op_sel_hi:[1,1,1]
    ds_read_b128 v[124:127], v7 offset:46272
    s_waitcnt lgkmcnt(3)
    v_pk_fma_f32 v[52:53], v[128:129], v[34:35], v[52:53] op_sel:[0,0,0] op_sel_hi:[1,0,1]
    v_pk_fma_f32 v[54:55], v[130:131], v[34:35], v[54:55] op_sel:[0,0,0] op_sel_hi:[1,0,1]
    ds_read_b128 v[128:131], v7 offset:46288
    s_waitcnt lgkmcnt(3)
    v_pk_fma_f32 v[56:57], v[132:133], v[34:35], v[56:57] op_sel:[0,0,0] op_sel_hi:[1,0,1]
    v_pk_fma_f32 v[58:59], v[134:135], v[34:35], v[58:59] op_sel:[0,0,0] op_sel_hi:[1,0,1]
    ds_read_b128 v[132:135], v7 offset:46304
    s_waitcnt lgkmcnt(3)
    v_pk_fma_f32 v[60:61], v[136:137], v[34:35], v[60:61] op_sel:[0,0,0] op_sel_hi:[1,0,1]
    v_pk_fma_f32 v[62:63], v[138:139], v[34:35], v[62:63] op_sel:[0,0,0] op_sel_hi:[1,0,1]
    ds_read_b128 v[136:139], v7 offset:46320
    s_waitcnt lgkmcnt(3)
    v_pk_fma_f32 v[64:65], v[124:125], v[34:35], v[64:65] op_sel:[0,0,0] op_sel_hi:[1,0,1]
    v_pk_fma_f32 v[66:67], v[126:127], v[34:35], v[66:67] op_sel:[0,0,0] op_sel_hi:[1,0,1]
    ds_read_b128 v[124:127], v7 offset:46336
    s_waitcnt lgkmcnt(3)
    v_pk_fma_f32 v[68:69], v[128:129], v[34:35], v[68:69] op_sel:[0,0,0] op_sel_hi:[1,0,1]
    v_pk_fma_f32 v[52:53], v[130:131], v[34:35], v[52:53] op_sel:[0,1,0] op_sel_hi:[1,1,1]
    ds_read_b128 v[128:131], v7 offset:46352
    s_waitcnt lgkmcnt(3)
    v_pk_fma_f32 v[54:55], v[132:133], v[34:35], v[54:55] op_sel:[0,1,0] op_sel_hi:[1,1,1]
    v_pk_fma_f32 v[56:57], v[134:135], v[34:35], v[56:57] op_sel:[0,1,0] op_sel_hi:[1,1,1]
    ds_read_b128 v[132:135], v7 offset:46368
    s_waitcnt lgkmcnt(3)
    v_pk_fma_f32 v[58:59], v[136:137], v[34:35], v[58:59] op_sel:[0,1,0] op_sel_hi:[1,1,1]
    v_pk_fma_f32 v[60:61], v[138:139], v[34:35], v[60:61] op_sel:[0,1,0] op_sel_hi:[1,1,1]
    ds_read_b128 v[136:139], v7 offset:46384
    s_waitcnt lgkmcnt(3)
    v_pk_fma_f32 v[62:63], v[124:125], v[34:35], v[62:63] op_sel:[0,1,0] op_sel_hi:[1,1,1]
    v_pk_fma_f32 v[64:65], v[126:127], v[34:35], v[64:65] op_sel:[0,1,0] op_sel_hi:[1,1,1]
    ds_read_b128 v[124:127], v7 offset:46400
    s_waitcnt lgkmcnt(3)
    v_pk_fma_f32 v[66:67], v[128:129], v[34:35], v[66:67] op_sel:[0,1,0] op_sel_hi:[1,1,1]
    v_pk_fma_f32 v[68:69], v[130:131], v[34:35], v[68:69] op_sel:[0,1,0] op_sel_hi:[1,1,1]
    ds_read_b128 v[128:131], v7 offset:46416
    s_waitcnt lgkmcnt(3)
    v_pk_fma_f32 v[52:53], v[132:133], v[36:37], v[52:53] op_sel:[0,0,0] op_sel_hi:[1,0,1]
    v_pk_fma_f32 v[54:55], v[134:135], v[36:37], v[54:55] op_sel:[0,0,0] op_sel_hi:[1,0,1]
    ds_read_b128 v[132:135], v7 offset:46432
    s_waitcnt lgkmcnt(3)
    v_pk_fma_f32 v[56:57], v[136:137], v[36:37], v[56:57] op_sel:[0,0,0] op_sel_hi:[1,0,1]
    v_pk_fma_f32 v[58:59], v[138:139], v[36:37], v[58:59] op_sel:[0,0,0] op_sel_hi:[1,0,1]
    ds_read_b128 v[136:139], v7 offset:46448
    s_waitcnt lgkmcnt(3)
    v_pk_fma_f32 v[60:61], v[124:125], v[36:37], v[60:61] op_sel:[0,0,0] op_sel_hi:[1,0,1]
    v_pk_fma_f32 v[62:63], v[126:127], v[36:37], v[62:63] op_sel:[0,0,0] op_sel_hi:[1,0,1]
    ds_read_b128 v[124:127], v7 offset:46464
    s_waitcnt lgkmcnt(3)
    v_pk_fma_f32 v[64:65], v[128:129], v[36:37], v[64:65] op_sel:[0,0,0] op_sel_hi:[1,0,1]
    v_pk_fma_f32 v[66:67], v[130:131], v[36:37], v[66:67] op_sel:[0,0,0] op_sel_hi:[1,0,1]
    ds_read_b128 v[128:131], v7 offset:46480
    s_waitcnt lgkmcnt(3)
    v_pk_fma_f32 v[68:69], v[132:133], v[36:37], v[68:69] op_sel:[0,0,0] op_sel_hi:[1,0,1]
    v_pk_fma_f32 v[52:53], v[134:135], v[36:37], v[52:53] op_sel:[0,1,0] op_sel_hi:[1,1,1]
    ds_read_b128 v[132:135], v7 offset:46496
    s_waitcnt lgkmcnt(3)
    v_pk_fma_f32 v[54:55], v[136:137], v[36:37], v[54:55] op_sel:[0,1,0] op_sel_hi:[1,1,1]
    v_pk_fma_f32 v[56:57], v[138:139], v[36:37], v[56:57] op_sel:[0,1,0] op_sel_hi:[1,1,1]
    ds_read_b128 v[136:139], v7 offset:46512
    s_waitcnt lgkmcnt(3)
    v_pk_fma_f32 v[58:59], v[124:125], v[36:37], v[58:59] op_sel:[0,1,0] op_sel_hi:[1,1,1]
    v_pk_fma_f32 v[60:61], v[126:127], v[36:37], v[60:61] op_sel:[0,1,0] op_sel_hi:[1,1,1]
    ds_read_b128 v[124:127], v7 offset:46528
    s_waitcnt lgkmcnt(3)
    v_pk_fma_f32 v[62:63], v[128:129], v[36:37], v[62:63] op_sel:[0,1,0] op_sel_hi:[1,1,1]
    v_pk_fma_f32 v[64:65], v[130:131], v[36:37], v[64:65] op_sel:[0,1,0] op_sel_hi:[1,1,1]
    ds_read_b128 v[128:131], v7 offset:46544
    s_waitcnt lgkmcnt(3)
    v_pk_fma_f32 v[66:67], v[132:133], v[36:37], v[66:67] op_sel:[0,1,0] op_sel_hi:[1,1,1]
    v_pk_fma_f32 v[68:69], v[134:135], v[36:37], v[68:69] op_sel:[0,1,0] op_sel_hi:[1,1,1]
    ds_read_b128 v[132:135], v7 offset:46560
    s_waitcnt lgkmcnt(3)
    v_pk_fma_f32 v[52:53], v[136:137], v[38:39], v[52:53] op_sel:[0,0,0] op_sel_hi:[1,0,1]
    v_pk_fma_f32 v[54:55], v[138:139], v[38:39], v[54:55] op_sel:[0,0,0] op_sel_hi:[1,0,1]
    ds_read_b128 v[136:139], v7 offset:46576
    s_waitcnt lgkmcnt(3)
    v_pk_fma_f32 v[56:57], v[124:125], v[38:39], v[56:57] op_sel:[0,0,0] op_sel_hi:[1,0,1]
    v_pk_fma_f32 v[58:59], v[126:127], v[38:39], v[58:59] op_sel:[0,0,0] op_sel_hi:[1,0,1]
    ds_read_b128 v[124:127], v7 offset:46592
    s_waitcnt lgkmcnt(3)
    v_pk_fma_f32 v[60:61], v[128:129], v[38:39], v[60:61] op_sel:[0,0,0] op_sel_hi:[1,0,1]
    v_pk_fma_f32 v[62:63], v[130:131], v[38:39], v[62:63] op_sel:[0,0,0] op_sel_hi:[1,0,1]
    ds_read_b128 v[128:131], v7 offset:46608
    s_waitcnt lgkmcnt(3)
    v_pk_fma_f32 v[64:65], v[132:133], v[38:39], v[64:65] op_sel:[0,0,0] op_sel_hi:[1,0,1]
    v_pk_fma_f32 v[66:67], v[134:135], v[38:39], v[66:67] op_sel:[0,0,0] op_sel_hi:[1,0,1]
    ds_read_b128 v[132:135], v7 offset:46624
    s_waitcnt lgkmcnt(3)
    v_pk_fma_f32 v[68:69], v[136:137], v[38:39], v[68:69] op_sel:[0,0,0] op_sel_hi:[1,0,1]
    v_pk_fma_f32 v[52:53], v[138:139], v[38:39], v[52:53] op_sel:[0,1,0] op_sel_hi:[1,1,1]
    ds_read_b128 v[136:139], v7 offset:46640
    s_waitcnt lgkmcnt(3)
    v_pk_fma_f32 v[54:55], v[124:125], v[38:39], v[54:55] op_sel:[0,1,0] op_sel_hi:[1,1,1]
    v_pk_fma_f32 v[56:57], v[126:127], v[38:39], v[56:57] op_sel:[0,1,0] op_sel_hi:[1,1,1]
    ds_read_b128 v[124:127], v7 offset:46656
    s_waitcnt lgkmcnt(3)
    v_pk_fma_f32 v[58:59], v[128:129], v[38:39], v[58:59] op_sel:[0,1,0] op_sel_hi:[1,1,1]
    v_pk_fma_f32 v[60:61], v[130:131], v[38:39], v[60:61] op_sel:[0,1,0] op_sel_hi:[1,1,1]
    ds_read_b128 v[128:131], v7 offset:46672
    s_waitcnt lgkmcnt(3)
    v_pk_fma_f32 v[62:63], v[132:133], v[38:39], v[62:63] op_sel:[0,1,0] op_sel_hi:[1,1,1]
    v_pk_fma_f32 v[64:65], v[134:135], v[38:39], v[64:65] op_sel:[0,1,0] op_sel_hi:[1,1,1]
    ds_read_b128 v[132:135], v7 offset:46688
    s_waitcnt lgkmcnt(3)
    v_pk_fma_f32 v[66:67], v[136:137], v[38:39], v[66:67] op_sel:[0,1,0] op_sel_hi:[1,1,1]
    v_pk_fma_f32 v[68:69], v[138:139], v[38:39], v[68:69] op_sel:[0,1,0] op_sel_hi:[1,1,1]
    ds_read_b128 v[136:139], v7 offset:46704
    s_waitcnt lgkmcnt(3)
    v_pk_fma_f32 v[52:53], v[124:125], v[40:41], v[52:53] op_sel:[0,0,0] op_sel_hi:[1,0,1]
    v_pk_fma_f32 v[54:55], v[126:127], v[40:41], v[54:55] op_sel:[0,0,0] op_sel_hi:[1,0,1]
    ds_read_b128 v[124:127], v7 offset:46720
    s_waitcnt lgkmcnt(3)
    v_pk_fma_f32 v[56:57], v[128:129], v[40:41], v[56:57] op_sel:[0,0,0] op_sel_hi:[1,0,1]
    v_pk_fma_f32 v[58:59], v[130:131], v[40:41], v[58:59] op_sel:[0,0,0] op_sel_hi:[1,0,1]
    ds_read_b128 v[128:131], v7 offset:46736
    s_waitcnt lgkmcnt(3)
    v_pk_fma_f32 v[60:61], v[132:133], v[40:41], v[60:61] op_sel:[0,0,0] op_sel_hi:[1,0,1]
    v_pk_fma_f32 v[62:63], v[134:135], v[40:41], v[62:63] op_sel:[0,0,0] op_sel_hi:[1,0,1]
    ds_read_b128 v[132:135], v7 offset:46752
    s_waitcnt lgkmcnt(3)
    v_pk_fma_f32 v[64:65], v[136:137], v[40:41], v[64:65] op_sel:[0,0,0] op_sel_hi:[1,0,1]
    v_pk_fma_f32 v[66:67], v[138:139], v[40:41], v[66:67] op_sel:[0,0,0] op_sel_hi:[1,0,1]
    ds_read_b128 v[136:139], v7 offset:46768
    s_waitcnt lgkmcnt(3)
    v_pk_fma_f32 v[68:69], v[124:125], v[40:41], v[68:69] op_sel:[0,0,0] op_sel_hi:[1,0,1]
    v_pk_fma_f32 v[52:53], v[126:127], v[40:41], v[52:53] op_sel:[0,1,0] op_sel_hi:[1,1,1]
    ds_read_b128 v[124:127], v7 offset:46784
    s_waitcnt lgkmcnt(3)
    v_pk_fma_f32 v[54:55], v[128:129], v[40:41], v[54:55] op_sel:[0,1,0] op_sel_hi:[1,1,1]
    v_pk_fma_f32 v[56:57], v[130:131], v[40:41], v[56:57] op_sel:[0,1,0] op_sel_hi:[1,1,1]
    ds_read_b128 v[128:131], v7 offset:46800
    s_waitcnt lgkmcnt(3)
    v_pk_fma_f32 v[58:59], v[132:133], v[40:41], v[58:59] op_sel:[0,1,0] op_sel_hi:[1,1,1]
    v_pk_fma_f32 v[60:61], v[134:135], v[40:41], v[60:61] op_sel:[0,1,0] op_sel_hi:[1,1,1]
    ds_read_b128 v[132:135], v7 offset:46816
    s_waitcnt lgkmcnt(3)
    v_pk_fma_f32 v[62:63], v[136:137], v[40:41], v[62:63] op_sel:[0,1,0] op_sel_hi:[1,1,1]
    v_pk_fma_f32 v[64:65], v[138:139], v[40:41], v[64:65] op_sel:[0,1,0] op_sel_hi:[1,1,1]
    ds_read_b128 v[136:139], v7 offset:46832
    s_waitcnt lgkmcnt(3)
    v_pk_fma_f32 v[66:67], v[124:125], v[40:41], v[66:67] op_sel:[0,1,0] op_sel_hi:[1,1,1]
    v_pk_fma_f32 v[68:69], v[126:127], v[40:41], v[68:69] op_sel:[0,1,0] op_sel_hi:[1,1,1]
    ds_read_b128 v[124:127], v7 offset:46848
    s_waitcnt lgkmcnt(3)
    v_pk_fma_f32 v[52:53], v[128:129], v[42:43], v[52:53] op_sel:[0,0,0] op_sel_hi:[1,0,1]
    v_pk_fma_f32 v[54:55], v[130:131], v[42:43], v[54:55] op_sel:[0,0,0] op_sel_hi:[1,0,1]
    ds_read_b128 v[128:131], v7 offset:46864
    s_waitcnt lgkmcnt(3)
    v_pk_fma_f32 v[56:57], v[132:133], v[42:43], v[56:57] op_sel:[0,0,0] op_sel_hi:[1,0,1]
    v_pk_fma_f32 v[58:59], v[134:135], v[42:43], v[58:59] op_sel:[0,0,0] op_sel_hi:[1,0,1]
    ds_read_b128 v[132:135], v7 offset:46880
    s_waitcnt lgkmcnt(3)
    v_pk_fma_f32 v[60:61], v[136:137], v[42:43], v[60:61] op_sel:[0,0,0] op_sel_hi:[1,0,1]
    v_pk_fma_f32 v[62:63], v[138:139], v[42:43], v[62:63] op_sel:[0,0,0] op_sel_hi:[1,0,1]
    ds_read_b128 v[136:139], v7 offset:46896
    s_waitcnt lgkmcnt(3)
    v_pk_fma_f32 v[64:65], v[124:125], v[42:43], v[64:65] op_sel:[0,0,0] op_sel_hi:[1,0,1]
    v_pk_fma_f32 v[66:67], v[126:127], v[42:43], v[66:67] op_sel:[0,0,0] op_sel_hi:[1,0,1]
    ds_read_b128 v[124:127], v7 offset:46912
    s_waitcnt lgkmcnt(3)
    v_pk_fma_f32 v[68:69], v[128:129], v[42:43], v[68:69] op_sel:[0,0,0] op_sel_hi:[1,0,1]
    v_pk_fma_f32 v[52:53], v[130:131], v[42:43], v[52:53] op_sel:[0,1,0] op_sel_hi:[1,1,1]
    ds_read_b128 v[128:131], v7 offset:46928
    s_waitcnt lgkmcnt(3)
    v_pk_fma_f32 v[54:55], v[132:133], v[42:43], v[54:55] op_sel:[0,1,0] op_sel_hi:[1,1,1]
    v_pk_fma_f32 v[56:57], v[134:135], v[42:43], v[56:57] op_sel:[0,1,0] op_sel_hi:[1,1,1]
    ds_read_b128 v[132:135], v7 offset:46944
    s_waitcnt lgkmcnt(3)
    v_pk_fma_f32 v[58:59], v[136:137], v[42:43], v[58:59] op_sel:[0,1,0] op_sel_hi:[1,1,1]
    v_pk_fma_f32 v[60:61], v[138:139], v[42:43], v[60:61] op_sel:[0,1,0] op_sel_hi:[1,1,1]
    ds_read_b128 v[136:139], v7 offset:46960
    s_waitcnt lgkmcnt(3)
    v_pk_fma_f32 v[62:63], v[124:125], v[42:43], v[62:63] op_sel:[0,1,0] op_sel_hi:[1,1,1]
    v_pk_fma_f32 v[64:65], v[126:127], v[42:43], v[64:65] op_sel:[0,1,0] op_sel_hi:[1,1,1]
    ds_read_b128 v[124:127], v7 offset:46976
    s_waitcnt lgkmcnt(3)
    v_pk_fma_f32 v[66:67], v[128:129], v[42:43], v[66:67] op_sel:[0,1,0] op_sel_hi:[1,1,1]
    v_pk_fma_f32 v[68:69], v[130:131], v[42:43], v[68:69] op_sel:[0,1,0] op_sel_hi:[1,1,1]
    ds_read_b128 v[128:131], v7 offset:46992
    s_waitcnt lgkmcnt(3)
    v_pk_fma_f32 v[52:53], v[132:133], v[44:45], v[52:53] op_sel:[0,0,0] op_sel_hi:[1,0,1]
    v_pk_fma_f32 v[54:55], v[134:135], v[44:45], v[54:55] op_sel:[0,0,0] op_sel_hi:[1,0,1]
    ds_read_b128 v[132:135], v7 offset:47008
    s_waitcnt lgkmcnt(3)
    v_pk_fma_f32 v[56:57], v[136:137], v[44:45], v[56:57] op_sel:[0,0,0] op_sel_hi:[1,0,1]
    v_pk_fma_f32 v[58:59], v[138:139], v[44:45], v[58:59] op_sel:[0,0,0] op_sel_hi:[1,0,1]
    ds_read_b128 v[136:139], v7 offset:47024
    s_waitcnt lgkmcnt(3)
    v_pk_fma_f32 v[60:61], v[124:125], v[44:45], v[60:61] op_sel:[0,0,0] op_sel_hi:[1,0,1]
    v_pk_fma_f32 v[62:63], v[126:127], v[44:45], v[62:63] op_sel:[0,0,0] op_sel_hi:[1,0,1]
    ds_read_b128 v[124:127], v7 offset:47040
    s_waitcnt lgkmcnt(3)
    v_pk_fma_f32 v[64:65], v[128:129], v[44:45], v[64:65] op_sel:[0,0,0] op_sel_hi:[1,0,1]
    v_pk_fma_f32 v[66:67], v[130:131], v[44:45], v[66:67] op_sel:[0,0,0] op_sel_hi:[1,0,1]
    ds_read_b128 v[128:131], v7 offset:47056
    s_waitcnt lgkmcnt(3)
    v_pk_fma_f32 v[68:69], v[132:133], v[44:45], v[68:69] op_sel:[0,0,0] op_sel_hi:[1,0,1]
    v_pk_fma_f32 v[52:53], v[134:135], v[44:45], v[52:53] op_sel:[0,1,0] op_sel_hi:[1,1,1]
    ds_read_b128 v[132:135], v7 offset:47072
    s_waitcnt lgkmcnt(3)
    v_pk_fma_f32 v[54:55], v[136:137], v[44:45], v[54:55] op_sel:[0,1,0] op_sel_hi:[1,1,1]
    v_pk_fma_f32 v[56:57], v[138:139], v[44:45], v[56:57] op_sel:[0,1,0] op_sel_hi:[1,1,1]
    ds_read_b128 v[136:139], v7 offset:47088
    s_waitcnt lgkmcnt(3)
    v_pk_fma_f32 v[58:59], v[124:125], v[44:45], v[58:59] op_sel:[0,1,0] op_sel_hi:[1,1,1]
    v_pk_fma_f32 v[60:61], v[126:127], v[44:45], v[60:61] op_sel:[0,1,0] op_sel_hi:[1,1,1]
    ds_read_b128 v[124:127], v7 offset:47104
    s_waitcnt lgkmcnt(3)
    v_pk_fma_f32 v[62:63], v[128:129], v[44:45], v[62:63] op_sel:[0,1,0] op_sel_hi:[1,1,1]
    v_pk_fma_f32 v[64:65], v[130:131], v[44:45], v[64:65] op_sel:[0,1,0] op_sel_hi:[1,1,1]
    ds_read_b128 v[128:131], v7 offset:47120
    s_waitcnt lgkmcnt(3)
    v_pk_fma_f32 v[66:67], v[132:133], v[44:45], v[66:67] op_sel:[0,1,0] op_sel_hi:[1,1,1]
    v_pk_fma_f32 v[68:69], v[134:135], v[44:45], v[68:69] op_sel:[0,1,0] op_sel_hi:[1,1,1]
    ds_read_b128 v[132:135], v7 offset:47136
    s_waitcnt lgkmcnt(3)
    v_pk_fma_f32 v[52:53], v[136:137], v[46:47], v[52:53] op_sel:[0,0,0] op_sel_hi:[1,0,1]
    v_pk_fma_f32 v[54:55], v[138:139], v[46:47], v[54:55] op_sel:[0,0,0] op_sel_hi:[1,0,1]
    ds_read_b128 v[136:139], v7 offset:47152
    s_waitcnt lgkmcnt(3)
    v_pk_fma_f32 v[56:57], v[124:125], v[46:47], v[56:57] op_sel:[0,0,0] op_sel_hi:[1,0,1]
    v_pk_fma_f32 v[58:59], v[126:127], v[46:47], v[58:59] op_sel:[0,0,0] op_sel_hi:[1,0,1]
    ds_read_b128 v[124:127], v7 offset:47168
    s_waitcnt lgkmcnt(3)
    v_pk_fma_f32 v[60:61], v[128:129], v[46:47], v[60:61] op_sel:[0,0,0] op_sel_hi:[1,0,1]
    v_pk_fma_f32 v[62:63], v[130:131], v[46:47], v[62:63] op_sel:[0,0,0] op_sel_hi:[1,0,1]
    ds_read_b128 v[128:131], v7 offset:47184
    s_waitcnt lgkmcnt(3)
    v_pk_fma_f32 v[64:65], v[132:133], v[46:47], v[64:65] op_sel:[0,0,0] op_sel_hi:[1,0,1]
    v_pk_fma_f32 v[66:67], v[134:135], v[46:47], v[66:67] op_sel:[0,0,0] op_sel_hi:[1,0,1]
    ds_read_b128 v[132:135], v7 offset:47200
    s_waitcnt lgkmcnt(3)
    v_pk_fma_f32 v[68:69], v[136:137], v[46:47], v[68:69] op_sel:[0,0,0] op_sel_hi:[1,0,1]
    v_pk_fma_f32 v[52:53], v[138:139], v[46:47], v[52:53] op_sel:[0,1,0] op_sel_hi:[1,1,1]
    ds_read_b128 v[136:139], v7 offset:47216
    s_waitcnt lgkmcnt(3)
    v_pk_fma_f32 v[54:55], v[124:125], v[46:47], v[54:55] op_sel:[0,1,0] op_sel_hi:[1,1,1]
    v_pk_fma_f32 v[56:57], v[126:127], v[46:47], v[56:57] op_sel:[0,1,0] op_sel_hi:[1,1,1]
    ds_read_b128 v[124:127], v7 offset:47232
    s_waitcnt lgkmcnt(3)
    v_pk_fma_f32 v[58:59], v[128:129], v[46:47], v[58:59] op_sel:[0,1,0] op_sel_hi:[1,1,1]
    v_pk_fma_f32 v[60:61], v[130:131], v[46:47], v[60:61] op_sel:[0,1,0] op_sel_hi:[1,1,1]
    ds_read_b128 v[128:131], v7 offset:47248
    s_waitcnt lgkmcnt(3)
    v_pk_fma_f32 v[62:63], v[132:133], v[46:47], v[62:63] op_sel:[0,1,0] op_sel_hi:[1,1,1]
    v_pk_fma_f32 v[64:65], v[134:135], v[46:47], v[64:65] op_sel:[0,1,0] op_sel_hi:[1,1,1]
    ds_read_b128 v[132:135], v7 offset:47264
    s_waitcnt lgkmcnt(3)
    v_pk_fma_f32 v[66:67], v[136:137], v[46:47], v[66:67] op_sel:[0,1,0] op_sel_hi:[1,1,1]
    v_pk_fma_f32 v[68:69], v[138:139], v[46:47], v[68:69] op_sel:[0,1,0] op_sel_hi:[1,1,1]
    ds_read_b128 v[136:139], v7 offset:47280
    s_waitcnt lgkmcnt(3)
    v_pk_fma_f32 v[52:53], v[124:125], v[48:49], v[52:53] op_sel:[0,0,0] op_sel_hi:[1,0,1]
    v_pk_fma_f32 v[54:55], v[126:127], v[48:49], v[54:55] op_sel:[0,0,0] op_sel_hi:[1,0,1]
    ds_read_b128 v[124:127], v7 offset:47296
    s_waitcnt lgkmcnt(3)
    v_pk_fma_f32 v[56:57], v[128:129], v[48:49], v[56:57] op_sel:[0,0,0] op_sel_hi:[1,0,1]
    v_pk_fma_f32 v[58:59], v[130:131], v[48:49], v[58:59] op_sel:[0,0,0] op_sel_hi:[1,0,1]
    ds_read_b128 v[128:131], v7 offset:47312
    s_waitcnt lgkmcnt(3)
    v_pk_fma_f32 v[60:61], v[132:133], v[48:49], v[60:61] op_sel:[0,0,0] op_sel_hi:[1,0,1]
    v_pk_fma_f32 v[62:63], v[134:135], v[48:49], v[62:63] op_sel:[0,0,0] op_sel_hi:[1,0,1]
    ds_read_b128 v[132:135], v7 offset:47328
    s_waitcnt lgkmcnt(3)
    v_pk_fma_f32 v[64:65], v[136:137], v[48:49], v[64:65] op_sel:[0,0,0] op_sel_hi:[1,0,1]
    v_pk_fma_f32 v[66:67], v[138:139], v[48:49], v[66:67] op_sel:[0,0,0] op_sel_hi:[1,0,1]
    ds_read_b128 v[136:139], v7 offset:47344
    s_waitcnt lgkmcnt(3)
    v_pk_fma_f32 v[68:69], v[124:125], v[48:49], v[68:69] op_sel:[0,0,0] op_sel_hi:[1,0,1]
    v_pk_fma_f32 v[52:53], v[126:127], v[48:49], v[52:53] op_sel:[0,1,0] op_sel_hi:[1,1,1]
    ds_read_b128 v[124:127], v7 offset:47360
    s_waitcnt lgkmcnt(3)
    v_pk_fma_f32 v[54:55], v[128:129], v[48:49], v[54:55] op_sel:[0,1,0] op_sel_hi:[1,1,1]
    v_pk_fma_f32 v[56:57], v[130:131], v[48:49], v[56:57] op_sel:[0,1,0] op_sel_hi:[1,1,1]
    s_waitcnt lgkmcnt(2)
    v_pk_fma_f32 v[58:59], v[132:133], v[48:49], v[58:59] op_sel:[0,1,0] op_sel_hi:[1,1,1]
    v_pk_fma_f32 v[60:61], v[134:135], v[48:49], v[60:61] op_sel:[0,1,0] op_sel_hi:[1,1,1]
    s_waitcnt lgkmcnt(1)
    v_pk_fma_f32 v[62:63], v[136:137], v[48:49], v[62:63] op_sel:[0,1,0] op_sel_hi:[1,1,1]
    v_pk_fma_f32 v[64:65], v[138:139], v[48:49], v[64:65] op_sel:[0,1,0] op_sel_hi:[1,1,1]
    s_waitcnt lgkmcnt(0)
    v_pk_fma_f32 v[66:67], v[124:125], v[48:49], v[66:67] op_sel:[0,1,0] op_sel_hi:[1,1,1]
    v_pk_fma_f32 v[68:69], v[126:127], v[48:49], v[68:69] op_sel:[0,1,0] op_sel_hi:[1,1,1]
    v_cvt_pk_bf16_f32 v8, v52, v53
    v_cvt_pk_bf16_f32 v9, v54, v55
    v_cvt_pk_bf16_f32 v10, v56, v57
    v_cvt_pk_bf16_f32 v11, v58, v59
    v_cvt_pk_bf16_f32 v12, v60, v61
    v_cvt_pk_bf16_f32 v13, v62, v63
    v_cvt_pk_bf16_f32 v14, v64, v65
    v_cvt_pk_bf16_f32 v15, v66, v67
    v_cvt_pk_bf16_f32 v16, v68, v69
    v_lshlrev_b32 v52, 16, v8
    v_and_b32 v53, 0xffff0000, v8
    v_lshlrev_b32 v54, 16, v9
    v_and_b32 v55, 0xffff0000, v9
    v_lshlrev_b32 v56, 16, v10
    v_and_b32 v57, 0xffff0000, v10
    v_lshlrev_b32 v58, 16, v11
    v_and_b32 v59, 0xffff0000, v11
    v_lshlrev_b32 v60, 16, v12
    v_and_b32 v61, 0xffff0000, v12
    v_lshlrev_b32 v62, 16, v13
    v_and_b32 v63, 0xffff0000, v13
    v_lshlrev_b32 v64, 16, v14
    v_and_b32 v65, 0xffff0000, v14
    v_lshlrev_b32 v66, 16, v15
    v_and_b32 v67, 0xffff0000, v15
    v_lshlrev_b32 v68, 16, v16
    v_and_b32 v69, 0xffff0000, v16
    v_max3_f32 v8, v52, v53, v54
    v_min3_f32 v9, v52, v53, v54
    v_max3_f32 v8, v8, v55, v56
    v_min3_f32 v9, v9, v55, v56
    v_max3_f32 v8, v8, v57, v58
    v_min3_f32 v9, v9, v57, v58
    v_max3_f32 v8, v8, v59, v60
    v_min3_f32 v9, v9, v59, v60
    v_max3_f32 v8, v8, v61, v62
    v_min3_f32 v9, v9, v61, v62
    v_max3_f32 v8, v8, v63, v64
    v_min3_f32 v9, v9, v63, v64
    v_max3_f32 v8, v8, v65, v66
    v_min3_f32 v9, v9, v65, v66
    v_max3_f32 v8, v8, v67, v68
    v_min3_f32 v9, v9, v67, v68
    v_max_f32 v8, v8, v69
    v_min_f32 v9, v9, v69
    s_mov_b32 s34, 0x3fb8aa3b
    v_mul_f32 v8, s34, v8
    v_mul_f32 v9, s34, v9
    v_fma_f32 v72, v52, s34, -v8
    v_fma_f32 v92, -v52, s34, v9
    v_fma_f32 v73, v53, s34, -v8
    v_fma_f32 v93, -v53, s34, v9
    v_fma_f32 v74, v54, s34, -v8
    v_fma_f32 v94, -v54, s34, v9
    v_fma_f32 v75, v55, s34, -v8
    v_fma_f32 v95, -v55, s34, v9
    v_fma_f32 v76, v56, s34, -v8
    v_fma_f32 v96, -v56, s34, v9
    v_fma_f32 v77, v57, s34, -v8
    v_fma_f32 v97, -v57, s34, v9
    v_fma_f32 v78, v58, s34, -v8
    v_fma_f32 v98, -v58, s34, v9
    v_fma_f32 v79, v59, s34, -v8
    v_fma_f32 v99, -v59, s34, v9
    v_fma_f32 v80, v60, s34, -v8
    v_fma_f32 v100, -v60, s34, v9
    v_fma_f32 v81, v61, s34, -v8
    v_fma_f32 v101, -v61, s34, v9
    v_fma_f32 v82, v62, s34, -v8
    v_fma_f32 v102, -v62, s34, v9
    v_fma_f32 v83, v63, s34, -v8
    v_fma_f32 v103, -v63, s34, v9
    v_fma_f32 v84, v64, s34, -v8
    v_fma_f32 v104, -v64, s34, v9
    v_fma_f32 v85, v65, s34, -v8
    v_fma_f32 v105, -v65, s34, v9
    v_fma_f32 v86, v66, s34, -v8
    v_fma_f32 v106, -v66, s34, v9
    v_fma_f32 v87, v67, s34, -v8
    v_fma_f32 v107, -v67, s34, v9
    v_fma_f32 v88, v68, s34, -v8
    v_fma_f32 v108, -v68, s34, v9
    v_fma_f32 v89, v69, s34, -v8
    v_fma_f32 v109, -v69, s34, v9
    v_exp_f32 v72, v72
    v_exp_f32 v92, v92
    v_exp_f32 v73, v73
    v_exp_f32 v93, v93
    v_exp_f32 v74, v74
    v_exp_f32 v94, v94
    v_exp_f32 v75, v75
    v_exp_f32 v95, v95
    v_exp_f32 v76, v76
    v_exp_f32 v96, v96
    v_exp_f32 v77, v77
    v_exp_f32 v97, v97
    v_exp_f32 v78, v78
    v_exp_f32 v98, v98
    v_exp_f32 v79, v79
    v_exp_f32 v99, v99
    v_exp_f32 v80, v80
    v_exp_f32 v100, v100
    v_exp_f32 v81, v81
    v_exp_f32 v101, v101
    v_exp_f32 v82, v82
    v_exp_f32 v102, v102
    v_exp_f32 v83, v83
    v_exp_f32 v103, v103
    v_exp_f32 v84, v84
    v_exp_f32 v104, v104
    v_exp_f32 v85, v85
    v_exp_f32 v105, v105
    v_exp_f32 v86, v86
    v_exp_f32 v106, v106
    v_exp_f32 v87, v87
    v_exp_f32 v107, v107
    v_exp_f32 v88, v88
    v_exp_f32 v108, v108
    v_exp_f32 v89, v89
    v_exp_f32 v109, v109
    s_nop 0
    v_add_f32 v10, v72, v73
    v_add_f32 v11, v92, v93
    v_add_f32 v10, v10, v74
    v_add_f32 v11, v11, v94
    v_add_f32 v10, v10, v75
    v_add_f32 v11, v11, v95
    v_add_f32 v10, v10, v76
    v_add_f32 v11, v11, v96
    v_add_f32 v10, v10, v77
    v_add_f32 v11, v11, v97
    v_add_f32 v10, v10, v78
    v_add_f32 v11, v11, v98
    v_add_f32 v10, v10, v79
    v_add_f32 v11, v11, v99
    v_add_f32 v10, v10, v80
    v_add_f32 v11, v11, v100
    v_add_f32 v10, v10, v81
    v_add_f32 v11, v11, v101
    v_add_f32 v10, v10, v82
    v_add_f32 v11, v11, v102
    v_add_f32 v10, v10, v83
    v_add_f32 v11, v11, v103
    v_add_f32 v10, v10, v84
    v_add_f32 v11, v11, v104
    v_add_f32 v10, v10, v85
    v_add_f32 v11, v11, v105
    v_add_f32 v10, v10, v86
    v_add_f32 v11, v11, v106
    v_add_f32 v10, v10, v87
    v_add_f32 v11, v11, v107
    v_add_f32 v10, v10, v88
    v_add_f32 v11, v11, v108
    v_add_f32 v10, v10, v89
    v_add_f32 v11, v11, v109
    v_rcp_f32 v10, v10
    v_rcp_f32 v11, v11
    s_nop 0
    v_pk_mul_f32 v[72:73], v[72:73], v[10:11] op_sel:[0,0] op_sel_hi:[1,0]
    v_pk_mul_f32 v[92:93], v[92:93], v[10:11] op_sel:[0,1] op_sel_hi:[1,1]
    v_pk_mul_f32 v[74:75], v[74:75], v[10:11] op_sel:[0,0] op_sel_hi:[1,0]
    v_pk_mul_f32 v[94:95], v[94:95], v[10:11] op_sel:[0,1] op_sel_hi:[1,1]
    v_pk_mul_f32 v[76:77], v[76:77], v[10:11] op_sel:[0,0] op_sel_hi:[1,0]
    v_pk_mul_f32 v[96:97], v[96:97], v[10:11] op_sel:[0,1] op_sel_hi:[1,1]
    v_pk_mul_f32 v[78:79], v[78:79], v[10:11] op_sel:[0,0] op_sel_hi:[1,0]
    v_pk_mul_f32 v[98:99], v[98:99], v[10:11] op_sel:[0,1] op_sel_hi:[1,1]
    v_pk_mul_f32 v[80:81], v[80:81], v[10:11] op_sel:[0,0] op_sel_hi:[1,0]
    v_pk_mul_f32 v[100:101], v[100:101], v[10:11] op_sel:[0,1] op_sel_hi:[1,1]
    v_pk_mul_f32 v[82:83], v[82:83], v[10:11] op_sel:[0,0] op_sel_hi:[1,0]
    v_pk_mul_f32 v[102:103], v[102:103], v[10:11] op_sel:[0,1] op_sel_hi:[1,1]
    v_pk_mul_f32 v[84:85], v[84:85], v[10:11] op_sel:[0,0] op_sel_hi:[1,0]
    v_pk_mul_f32 v[104:105], v[104:105], v[10:11] op_sel:[0,1] op_sel_hi:[1,1]
    v_pk_mul_f32 v[86:87], v[86:87], v[10:11] op_sel:[0,0] op_sel_hi:[1,0]
    v_pk_mul_f32 v[106:107], v[106:107], v[10:11] op_sel:[0,1] op_sel_hi:[1,1]
    v_pk_mul_f32 v[88:89], v[88:89], v[10:11] op_sel:[0,0] op_sel_hi:[1,0]
    v_pk_mul_f32 v[108:109], v[108:109], v[10:11] op_sel:[0,1] op_sel_hi:[1,1]
    v_cvt_pk_bf16_f32 v32, v72, v73
    v_cvt_pk_bf16_f32 v41, v92, v93
    v_cvt_pk_bf16_f32 v33, v74, v75
    v_cvt_pk_bf16_f32 v42, v94, v95
    v_cvt_pk_bf16_f32 v34, v76, v77
    v_cvt_pk_bf16_f32 v43, v96, v97
    v_cvt_pk_bf16_f32 v35, v78, v79
    v_cvt_pk_bf16_f32 v44, v98, v99
    v_cvt_pk_bf16_f32 v36, v80, v81
    v_cvt_pk_bf16_f32 v45, v100, v101
    v_cvt_pk_bf16_f32 v37, v82, v83
    v_cvt_pk_bf16_f32 v46, v102, v103
    v_cvt_pk_bf16_f32 v38, v84, v85
    v_cvt_pk_bf16_f32 v47, v104, v105
    v_cvt_pk_bf16_f32 v39, v86, v87
    v_cvt_pk_bf16_f32 v48, v106, v107
    v_cvt_pk_bf16_f32 v40, v88, v89
    v_cvt_pk_bf16_f32 v49, v108, v109
    s_mul_i32 s28, s24, 11520
    v_lshlrev_b32 v4, 1, v1
    v_add_u32 v4, s28, v4
    ds_write_b16 v4, v32 offset:0
    ds_write_b16_d16_hi v4, v32 offset:144
    ds_write_b16 v4, v33 offset:288
    ds_write_b16_d16_hi v4, v33 offset:432
    ds_write_b16 v4, v34 offset:576
    ds_write_b16_d16_hi v4, v34 offset:720
    ds_write_b16 v4, v35 offset:864
    ds_write_b16_d16_hi v4, v35 offset:1008
    ds_write_b16 v4, v36 offset:1152
    ds_write_b16_d16_hi v4, v36 offset:1296
    ds_write_b16 v4, v37 offset:1440
    ds_write_b16_d16_hi v4, v37 offset:1584
    ds_write_b16 v4, v38 offset:1728
    ds_write_b16_d16_hi v4, v38 offset:1872
    ds_write_b16 v4, v39 offset:2016
    ds_write_b16_d16_hi v4, v39 offset:2160
    ds_write_b16 v4, v40 offset:2304
    ds_write_b16_d16_hi v4, v40 offset:2448
    ds_write_b16 v4, v41 offset:2592
    ds_write_b16_d16_hi v4, v41 offset:2736
    ds_write_b16 v4, v42 offset:2880
    ds_write_b16_d16_hi v4, v42 offset:3024
    ds_write_b16 v4, v43 offset:3168
    ds_write_b16_d16_hi v4, v43 offset:3312
    ds_write_b16 v4, v44 offset:3456
    ds_write_b16_d16_hi v4, v44 offset:3600
    ds_write_b16 v4, v45 offset:3744
    ds_write_b16_d16_hi v4, v45 offset:3888
    ds_write_b16 v4, v46 offset:4032
    ds_write_b16_d16_hi v4, v46 offset:4176
    ds_write_b16 v4, v47 offset:4320
    ds_write_b16_d16_hi v4, v47 offset:4464
    ds_write_b16 v4, v48 offset:4608
    ds_write_b16_d16_hi v4, v48 offset:4752
    ds_write_b16 v4, v49 offset:4896
    ds_write_b16_d16_hi v4, v49 offset:5040
    ds_write_b16 v4, v20 offset:6912
    ds_write_b16_d16_hi v4, v20 offset:7056
    ds_write_b16 v4, v21 offset:7200
    ds_write_b16_d16_hi v4, v21 offset:7344
    ds_write_b16 v4, v22 offset:7488
    ds_write_b16_d16_hi v4, v22 offset:7632
    ds_write_b16 v4, v23 offset:7776
    ds_write_b16_d16_hi v4, v23 offset:7920
    ds_write_b16 v4, v24 offset:8064
    ds_write_b16_d16_hi v4, v24 offset:8208
    ds_write_b16 v4, v25 offset:8352
    ds_write_b16_d16_hi v4, v25 offset:8496
    ds_write_b16 v4, v26 offset:8640
    ds_write_b16_d16_hi v4, v26 offset:8784
    ds_write_b16 v4, v27 offset:8928
    ds_write_b16_d16_hi v4, v27 offset:9072
    ds_write_b16 v4, v28 offset:9216
    ds_write_b16_d16_hi v4, v28 offset:9360
    v_mov_b32 v5, 0x3f80
    ds_write_b16 v4, v5 offset:9504
    v_and_b32 v5, 15, v1
    s_mov_b32 s29, 144
    v_mul_lo_u32 v5, v5, s29
    v_lshrrev_b32 v6, 4, v1
    v_lshl_add_u32 v5, v6, 4, v5
    v_add_u32 v5, s28, v5
    v_mov_b32 v100, 0
    v_mov_b32 v101, 0
    v_mov_b32 v102, 0
    v_mov_b32 v103, 0
    v_mov_b32 v104, 0
    v_mov_b32 v105, 0
    v_mov_b32 v106, 0
    v_mov_b32 v107, 0
    v_mov_b32 v108, 0
    v_mov_b32 v109, 0
    v_mov_b32 v110, 0
    v_mov_b32 v111, 0
    v_mov_b32 v112, 0
    v_mov_b32 v113, 0
    v_mov_b32 v114, 0
    v_mov_b32 v115, 0
    v_mov_b32 v116, 0
    v_mov_b32 v117, 0
    v_mov_b32 v118, 0
    v_mov_b32 v119, 0
    v_mov_b32 v120, 0
    v_mov_b32 v121, 0
    v_mov_b32 v122, 0
    v_mov_b32 v123, 0
    s_waitcnt lgkmcnt(0)
    ds_read_b128 v[52:55], v5 offset:0
    ds_read_b128 v[56:59], v5 offset:2304
    ds_read_b128 v[60:63], v5 offset:4608
    ds_read_b128 v[64:67], v5 offset:6912
    ds_read_b128 v[68:71], v5 offset:9216
    s_waitcnt lgkmcnt(0)
    v_mfma_f32_16x16x32_bf16 v[100:103], v[52:55], v[64:67], v[100:103]
    v_mfma_f32_16x16x32_bf16 v[104:107], v[52:55], v[68:71], v[104:107]
    v_mfma_f32_16x16x32_bf16 v[108:111], v[56:59], v[64:67], v[108:111]
    v_mfma_f32_16x16x32_bf16 v[112:115], v[56:59], v[68:71], v[112:115]
    v_mfma_f32_16x16x32_bf16 v[116:119], v[60:63], v[64:67], v[116:119]
    v_mfma_f32_16x16x32_bf16 v[120:123], v[60:63], v[68:71], v[120:123]
    ds_read_b128 v[52:55], v5 offset:64
    ds_read_b128 v[56:59], v5 offset:2368
    ds_read_b128 v[60:63], v5 offset:4672
    ds_read_b128 v[64:67], v5 offset:6976
    ds_read_b128 v[68:71], v5 offset:9280
    s_waitcnt lgkmcnt(0)
    v_mfma_f32_16x16x32_bf16 v[100:103], v[52:55], v[64:67], v[100:103]
    v_mfma_f32_16x16x32_bf16 v[104:107], v[52:55], v[68:71], v[104:107]
    v_mfma_f32_16x16x32_bf16 v[108:111], v[56:59], v[64:67], v[108:111]
    v_mfma_f32_16x16x32_bf16 v[112:115], v[56:59], v[68:71], v[112:115]
    v_mfma_f32_16x16x32_bf16 v[116:119], v[60:63], v[64:67], v[116:119]
    v_mfma_f32_16x16x32_bf16 v[120:123], v[60:63], v[68:71], v[120:123]
    s_nop 7
    s_nop 7
    v_lshlrev_b32 v6, 2, v1
    v_add_u32 v6, s28, v6
    ds_write_b32 v6, v100 offset:0
    ds_write_b32 v6, v101 offset:256
    ds_write_b32 v6, v102 offset:512
    ds_write_b32 v6, v103 offset:768
    ds_write_b32 v6, v104 offset:1024
    ds_write_b32 v6, v105 offset:1280
    ds_write_b32 v6, v106 offset:1536
    ds_write_b32 v6, v107 offset:1792
    ds_write_b32 v6, v108 offset:2048
    ds_write_b32 v6, v109 offset:2304
    ds_write_b32 v6, v110 offset:2560
    ds_write_b32 v6, v111 offset:2816
    ds_write_b32 v6, v112 offset:3072
    ds_write_b32 v6, v113 offset:3328
    ds_write_b32 v6, v114 offset:3584
    ds_write_b32 v6, v115 offset:3840
    ds_write_b32 v6, v116 offset:4096
    ds_write_b32 v6, v117 offset:4352
    ds_write_b32 v6, v118 offset:4608
    ds_write_b32 v6, v119 offset:4864
    ds_write_b32 v6, v120 offset:5120
    ds_write_b32 v6, v121 offset:5376
    ds_write_b32 v6, v122 offset:5632
    ds_write_b32 v6, v123 offset:5888
    s_waitcnt lgkmcnt(0)
    s_barrier
    v_lshlrev_b32 v6, 2, v1
    s_lshl_b32 s29, s24, 8
    v_add_u32 v6, s29, v6
    ds_read_b32 v52, v6 offset:0
    ds_read_b32 v53, v6 offset:11520
    ds_read_b32 v54, v6 offset:23040
    ds_read_b32 v55, v6 offset:34560
    ds_read_b32 v56, v6 offset:1024
    ds_read_b32 v57, v6 offset:12544
    ds_read_b32 v58, v6 offset:24064
    ds_read_b32 v59, v6 offset:35584
    ds_read_b32 v60, v6 offset:2048
    ds_read_b32 v61, v6 offset:13568
    ds_read_b32 v62, v6 offset:25088
    ds_read_b32 v63, v6 offset:36608
    ds_read_b32 v64, v6 offset:3072
    ds_read_b32 v65, v6 offset:14592
    ds_read_b32 v66, v6 offset:26112
    ds_read_b32 v67, v6 offset:37632
    ds_read_b32 v68, v6 offset:4096
    ds_read_b32 v69, v6 offset:15616
    ds_read_b32 v70, v6 offset:27136
    ds_read_b32 v71, v6 offset:38656
    ds_read_b32 v72, v6 offset:5120
    ds_read_b32 v73, v6 offset:16640
    ds_read_b32 v74, v6 offset:28160
    ds_read_b32 v75, v6 offset:39680
    s_waitcnt lgkmcnt(0)
    v_lshrrev_b32 v7, 4, v1
    v_lshlrev_b32 v7, 2, v7
    v_add_u32 v7, s24, v7
    v_and_b32 v8, 15, v1
    s_mul_i32 s28, s2, 2880
    v_add_f32 v52, v52, v53
    v_add_f32 v54, v54, v55
    v_add_f32 v52, v52, v54
    v_add_u32 v9, 0, v7
    v_add_u32 v10, 0, v8
    v_cmp_gt_u32 vcc, 36, v9
    v_cmp_gt_u32 s[30:31], 19, v10
    s_and_b64 vcc, vcc, s[30:31]
    s_mov_b32 s29, 80
    v_mul_lo_u32 v9, v9, s29
    v_lshl_add_u32 v9, v10, 2, v9
    s_and_saveexec_b64 s[30:31], vcc
    buffer_store_dword v52, v9, s[12:15], s28 offen
    s_mov_b64 exec, s[30:31]
    v_add_f32 v56, v56, v57
    v_add_f32 v58, v58, v59
    v_add_f32 v56, v56, v58
    v_add_u32 v9, 0, v7
    v_add_u32 v10, 16, v8
    v_cmp_gt_u32 vcc, 36, v9
    v_cmp_gt_u32 s[30:31], 19, v10
    s_and_b64 vcc, vcc, s[30:31]
    s_mov_b32 s29, 80
    v_mul_lo_u32 v9, v9, s29
    v_lshl_add_u32 v9, v10, 2, v9
    s_and_saveexec_b64 s[30:31], vcc
    buffer_store_dword v56, v9, s[12:15], s28 offen
    s_mov_b64 exec, s[30:31]
    v_add_f32 v60, v60, v61
    v_add_f32 v62, v62, v63
    v_add_f32 v60, v60, v62
    v_add_u32 v9, 16, v7
    v_add_u32 v10, 0, v8
    v_cmp_gt_u32 vcc, 36, v9
    v_cmp_gt_u32 s[30:31], 19, v10
    s_and_b64 vcc, vcc, s[30:31]
    s_mov_b32 s29, 80
    v_mul_lo_u32 v9, v9, s29
    v_lshl_add_u32 v9, v10, 2, v9
    s_and_saveexec_b64 s[30:31], vcc
    buffer_store_dword v60, v9, s[12:15], s28 offen
    s_mov_b64 exec, s[30:31]
    v_add_f32 v64, v64, v65
    v_add_f32 v66, v66, v67
    v_add_f32 v64, v64, v66
    v_add_u32 v9, 16, v7
    v_add_u32 v10, 16, v8
    v_cmp_gt_u32 vcc, 36, v9
    v_cmp_gt_u32 s[30:31], 19, v10
    s_and_b64 vcc, vcc, s[30:31]
    s_mov_b32 s29, 80
    v_mul_lo_u32 v9, v9, s29
    v_lshl_add_u32 v9, v10, 2, v9
    s_and_saveexec_b64 s[30:31], vcc
    buffer_store_dword v64, v9, s[12:15], s28 offen
    s_mov_b64 exec, s[30:31]
    v_add_f32 v68, v68, v69
    v_add_f32 v70, v70, v71
    v_add_f32 v68, v68, v70
    v_add_u32 v9, 32, v7
    v_add_u32 v10, 0, v8
    v_cmp_gt_u32 vcc, 36, v9
    v_cmp_gt_u32 s[30:31], 19, v10
    s_and_b64 vcc, vcc, s[30:31]
    s_mov_b32 s29, 80
    v_mul_lo_u32 v9, v9, s29
    v_lshl_add_u32 v9, v10, 2, v9
    s_and_saveexec_b64 s[30:31], vcc
    buffer_store_dword v68, v9, s[12:15], s28 offen
    s_mov_b64 exec, s[30:31]
    v_add_f32 v72, v72, v73
    v_add_f32 v74, v74, v75
    v_add_f32 v72, v72, v74
    v_add_u32 v9, 32, v7
    v_add_u32 v10, 16, v8
    v_cmp_gt_u32 vcc, 36, v9
    v_cmp_gt_u32 s[30:31], 19, v10
    s_and_b64 vcc, vcc, s[30:31]
    s_mov_b32 s29, 80
    v_mul_lo_u32 v9, v9, s29
    v_lshl_add_u32 v9, v10, 2, v9
    s_and_saveexec_b64 s[30:31], vcc
    buffer_store_dword v72, v9, s[12:15], s28 offen
    s_mov_b64 exec, s[30:31]
kv_kernel_end:
    s_endpgm
.section .rodata,"a"
.p2align 6
.amdhsa_kernel kv_kernel
  .amdhsa_next_free_vgpr 144
  .amdhsa_next_free_sgpr 102
  .amdhsa_accum_offset 144
  .amdhsa_group_segment_fixed_size 0
  .amdhsa_kernarg_size 96
  .amdhsa_user_sgpr_count 2
  .amdhsa_user_sgpr_kernarg_segment_ptr 1
  .amdhsa_system_sgpr_workgroup_id_x 1
.end_amdhsa_kernel
.text
.globl o_kernel
.p2align 8
.type o_kernel,@function
o_kernel:
    s_cmp_ge_u32 s2, 256
    s_cbranch_scc1 o_kernel_end
    s_load_dwordx2 s[4:5], s[0:1], 88
    s_load_dwordx2 s[6:7], s[0:1], 16
    v_and_b32 v1, 63, v0
    v_lshrrev_b32 v2, 6, v0
    s_nop 0
    v_readfirstlane_b32 s24, v2
    s_and_b32 s26, s2, 31
    s_lshr_b32 s27, s2, 5
    s_waitcnt lgkmcnt(0)
    s_add_u32 s8, s4, 0x240000
    s_addc_u32 s9, s5, 0
    s_mov_b32 s10, 0x6c0000
    s_mov_b32 s11, 0x00020000
    s_add_u32 s12, s4, 0x1db0000
    s_addc_u32 s13, s5, 0
    s_mov_b32 s14, 0xb4000
    s_mov_b32 s15, 0x00020000
    s_mov_b32 s16, s6
    s_mov_b32 s17, s7
    s_mov_b32 s18, 0x5100
    s_mov_b32 s19, 0x00020000
    s_add_u32 s20, s4, 0x900000
    s_addc_u32 s21, s5, 0
    s_mov_b32 s22, 0x240000
    s_mov_b32 s23, 0x00020000
    s_lshl_b32 s28, s27, 8
    s_lshl_b32 s29, s24, 6
    s_add_u32 s28, s28, s29
    v_add_u32 v3, s28, v1
    s_mov_b32 s29, 3456
    v_mul_lo_u32 v4, v3, s29
    s_mul_i32 s30, s26, 36
    buffer_load_dwordx4 v[8:11], v4, s[8:11], s30 offen
    buffer_load_dwordx4 v[12:15], v4, s[8:11], s30 offen offset:16
    buffer_load_dword v16, v4, s[8:11], s30 offen offset:32
    v_lshlrev_b32 v5, 2, v0
    s_add_u32 s28, s26, 0
    s_mul_i32 s28, s28, 2880
    buffer_load_dword v20, v5, s[12:15], s28 offen offset:0
    s_add_u32 s28, s26, 32
    s_mul_i32 s28, s28, 2880
    buffer_load_dword v21, v5, s[12:15], s28 offen offset:0
    s_add_u32 s28, s26, 64
    s_mul_i32 s28, s28, 2880
    buffer_load_dword v22, v5, s[12:15], s28 offen offset:0
    s_add_u32 s28, s26, 96
    s_mul_i32 s28, s28, 2880
    buffer_load_dword v23, v5, s[12:15], s28 offen offset:0
    s_add_u32 s28, s26, 128
    s_mul_i32 s28, s28, 2880
    buffer_load_dword v24, v5, s[12:15], s28 offen offset:0
    s_add_u32 s28, s26, 160
    s_mul_i32 s28, s28, 2880
    buffer_load_dword v25, v5, s[12:15], s28 offen offset:0
    s_add_u32 s28, s26, 192
    s_mul_i32 s28, s28, 2880
    buffer_load_dword v26, v5, s[12:15], s28 offen offset:0
    s_add_u32 s28, s26, 224
    s_mul_i32 s28, s28, 2880
    buffer_load_dword v27, v5, s[12:15], s28 offen offset:0
    s_add_u32 s28, s26, 0
    s_mul_i32 s28, s28, 2880
    buffer_load_dword v28, v5, s[12:15], s28 offen offset:1024
    s_add_u32 s28, s26, 32
    s_mul_i32 s28, s28, 2880
    buffer_load_dword v29, v5, s[12:15], s28 offen offset:1024
    s_add_u32 s28, s26, 64
    s_mul_i32 s28, s28, 2880
    buffer_load_dword v30, v5, s[12:15], s28 offen offset:1024
    s_add_u32 s28, s26, 96
    s_mul_i32 s28, s28, 2880
    buffer_load_dword v31, v5, s[12:15], s28 offen offset:1024
    s_add_u32 s28, s26, 128
    s_mul_i32 s28, s28, 2880
    buffer_load_dword v32, v5, s[12:15], s28 offen offset:1024
    s_add_u32 s28, s26, 160
    s_mul_i32 s28, s28, 2880
    buffer_load_dword v33, v5, s[12:15], s28 offen offset:1024
    s_add_u32 s28, s26, 192
    s_mul_i32 s28, s28, 2880
    buffer_load_dword v34, v5, s[12:15], s28 offen offset:1024
    s_add_u32 s28, s26, 224
    s_mul_i32 s28, s28, 2880
    buffer_load_dword v35, v5, s[12:15], s28 offen offset:1024
    v_cmp_gt_u32 vcc, 208, v0
    s_and_saveexec_b64 s[32:33], vcc
    s_add_u32 s28, s26, 0
    s_mul_i32 s28, s28, 2880
    buffer_load_dword v36, v5, s[12:15], s28 offen offset:2048
    s_add_u32 s28, s26, 32
    s_mul_i32 s28, s28, 2880
    buffer_load_dword v37, v5, s[12:15], s28 offen offset:2048
    s_add_u32 s28, s26, 64
    s_mul_i32 s28, s28, 2880
    buffer_load_dword v38, v5, s[12:15], s28 offen offset:2048
    s_add_u32 s28, s26, 96
    s_mul_i32 s28, s28, 2880
    buffer_load_dword v39, v5, s[12:15], s28 offen offset:2048
    s_add_u32 s28, s26, 128
    s_mul_i32 s28, s28, 2880
    buffer_load_dword v40, v5, s[12:15], s28 offen offset:2048
    s_add_u32 s28, s26, 160
    s_mul_i32 s28, s28, 2880
    buffer_load_dword v41, v5, s[12:15], s28 offen offset:2048
    s_add_u32 s28, s26, 192
    s_mul_i32 s28, s28, 2880
    buffer_load_dword v42, v5, s[12:15], s28 offen offset:2048
    s_add_u32 s28, s26, 224
    s_mul_i32 s28, s28, 2880
    buffer_load_dword v43, v5, s[12:15], s28 offen offset:2048
    s_mov_b64 exec, s[32:33]
    s_mul_i32 s28, s26, 648
    v_lshlrev_b32 v44, 1, v0
    buffer_load_ushort v45, v44, s[16:19], s28 offen offset:0
    v_cmp_gt_u32 vcc, 68, v0
    s_and_saveexec_b64 s[32:33], vcc
    v_lshlrev_b32 v44, 1, v0
    buffer_load_ushort v46, v44, s[16:19], s28 offen offset:512
    s_mov_b64 exec, s[32:33]
    s_waitcnt vmcnt(0)
    v_lshlrev_b32 v45, 16, v45
    v_lshlrev_b32 v44, 2, v0
    ds_write_b32 v44, v45 offset:2880
    v_cmp_gt_u32 vcc, 68, v0
    s_and_saveexec_b64 s[32:33], vcc
    v_lshlrev_b32 v46, 16, v46
    v_lshlrev_b32 v44, 2, v0
    ds_write_b32 v44, v46 offset:3904
    s_mov_b64 exec, s[32:33]
    v_add_f32 v20, v20, v21
    v_add_f32 v20, v20, v22
    v_add_f32 v20, v20, v23
    v_add_f32 v20, v20, v24
    v_add_f32 v20, v20, v25
    v_add_f32 v20, v20, v26
    v_add_f32 v20, v20, v27
    v_cvt_pk_bf16_f32 v20, v20, v20
    v_lshlrev_b32 v20, 16, v20
    ds_write_b32 v5, v20 offset:0
    v_add_f32 v28, v28, v29
    v_add_f32 v28, v28, v30
    v_add_f32 v28, v28, v31
    v_add_f32 v28, v28, v32
    v_add_f32 v28, v28, v33
    v_add_f32 v28, v28, v34
    v_add_f32 v28, v28, v35
    v_cvt_pk_bf16_f32 v28, v28, v28
    v_lshlrev_b32 v28, 16, v28
    ds_write_b32 v5, v28 offset:1024
    v_add_f32 v36, v36, v37
    v_add_f32 v36, v36, v38
    v_add_f32 v36, v36, v39
    v_add_f32 v36, v36, v40
    v_add_f32 v36, v36, v41
    v_add_f32 v36, v36, v42
    v_add_f32 v36, v36, v43
    v_cvt_pk_bf16_f32 v36, v36, v36
    v_lshlrev_b32 v36, 16, v36
    v_cmp_gt_u32 vcc, 208, v0
    s_and_saveexec_b64 s[32:33], vcc
    ds_write_b32 v5, v36 offset:2048
    s_mov_b64 exec, s[32:33]
    v_mov_b32 v6, 0
    s_waitcnt lgkmcnt(0)
    s_barrier
    v_lshlrev_b32 v32, 16, v8
    v_and_b32 v33, 0xffff0000, v8
    v_lshlrev_b32 v34, 16, v9
    v_and_b32 v35, 0xffff0000, v9
    v_lshlrev_b32 v36, 16, v10
    v_and_b32 v37, 0xffff0000, v10
    v_lshlrev_b32 v38, 16, v11
    v_and_b32 v39, 0xffff0000, v11
    v_lshlrev_b32 v40, 16, v12
    v_and_b32 v41, 0xffff0000, v12
    v_lshlrev_b32 v42, 16, v13
    v_and_b32 v43, 0xffff0000, v13
    v_lshlrev_b32 v44, 16, v14
    v_and_b32 v45, 0xffff0000, v14
    v_lshlrev_b32 v46, 16, v15
    v_and_b32 v47, 0xffff0000, v15
    v_lshlrev_b32 v48, 16, v16
    v_and_b32 v49, 0xffff0000, v16
    v_mov_b32 v52, 0
    v_mov_b32 v53, 0
    v_mov_b32 v54, 0
    v_mov_b32 v55, 0
    v_mov_b32 v56, 0
    v_mov_b32 v57, 0
    v_mov_b32 v58, 0
    v_mov_b32 v59, 0
    v_mov_b32 v60, 0
    v_mov_b32 v61, 0
    v_mov_b32 v62, 0
    v_mov_b32 v63, 0
    v_mov_b32 v64, 0
    v_mov_b32 v65, 0
    v_mov_b32 v66, 0
    v_mov_b32 v67, 0
    v_mov_b32 v68, 0
    v_mov_b32 v69, 0
    ds_read_b128 v[112:115], v6 offset:2880
    ds_read_b128 v[116:119], v6 offset:2896
    ds_read_b128 v[120:123], v6 offset:2912
    ds_read_b128 v[124:127], v6 offset:2928
    s_waitcnt lgkmcnt(3)
    v_pk_fma_f32 v[52:53], v[112:113], v[32:33], v[52:53] op_sel:[0,0,0] op_sel_hi:[1,0,1]
    v_pk_fma_f32 v[54:55], v[114:115], v[32:33], v[54:55] op_sel:[0,0,0] op_sel_hi:[1,0,1]
    ds_read_b128 v[112:115], v6 offset:2944
    s_waitcnt lgkmcnt(3)
    v_pk_fma_f32 v[56:57], v[116:117], v[32:33], v[56:57] op_sel:[0,0,0] op_sel_hi:[1,0,1]
    v_pk_fma_f32 v[58:59], v[118:119], v[32:33], v[58:59] op_sel:[0,0,0] op_sel_hi:[1,0,1]
    ds_read_b128 v[116:119], v6 offset:2960
    s_waitcnt lgkmcnt(3)
    v_pk_fma_f32 v[60:61], v[120:121], v[32:33], v[60:61] op_sel:[0,0,0] op_sel_hi:[1,0,1]
    v_pk_fma_f32 v[62:63], v[122:123], v[32:33], v[62:63] op_sel:[0,0,0] op_sel_hi:[1,0,1]
    ds_read_b128 v[120:123], v6 offset:2976
    s_waitcnt lgkmcnt(3)
    v_pk_fma_f32 v[64:65], v[124:125], v[32:33], v[64:65] op_sel:[0,0,0] op_sel_hi:[1,0,1]
    v_pk_fma_f32 v[66:67], v[126:127], v[32:33], v[66:67] op_sel:[0,0,0] op_sel_hi:[1,0,1]
    ds_read_b128 v[124:127], v6 offset:2992
    s_waitcnt lgkmcnt(3)
    v_pk_fma_f32 v[68:69], v[112:113], v[32:33], v[68:69] op_sel:[0,0,0] op_sel_hi:[1,0,1]
    v_pk_fma_f32 v[52:53], v[114:115], v[32:33], v[52:53] op_sel:[0,1,0] op_sel_hi:[1,1,1]
    ds_read_b128 v[112:115], v6 offset:3008
    s_waitcnt lgkmcnt(3)
    v_pk_fma_f32 v[54:55], v[116:117], v[32:33], v[54:55] op_sel:[0,1,0] op_sel_hi:[1,1,1]
    v_pk_fma_f32 v[56:57], v[118:119], v[32:33], v[56:57] op_sel:[0,1,0] op_sel_hi:[1,1,1]
    ds_read_b128 v[116:119], v6 offset:3024
    s_waitcnt lgkmcnt(3)
    v_pk_fma_f32 v[58:59], v[120:121], v[32:33], v[58:59] op_sel:[0,1,0] op_sel_hi:[1,1,1]
    v_pk_fma_f32 v[60:61], v[122:123], v[32:33], v[60:61] op_sel:[0,1,0] op_sel_hi:[1,1,1]
    ds_read_b128 v[120:123], v6 offset:3040
    s_waitcnt lgkmcnt(3)
    v_pk_fma_f32 v[62:63], v[124:125], v[32:33], v[62:63] op_sel:[0,1,0] op_sel_hi:[1,1,1]
    v_pk_fma_f32 v[64:65], v[126:127], v[32:33], v[64:65] op_sel:[0,1,0] op_sel_hi:[1,1,1]
    ds_read_b128 v[124:127], v6 offset:3056
    s_waitcnt lgkmcnt(3)
    v_pk_fma_f32 v[66:67], v[112:113], v[32:33], v[66:67] op_sel:[0,1,0] op_sel_hi:[1,1,1]
    v_pk_fma_f32 v[68:69], v[114:115], v[32:33], v[68:69] op_sel:[0,1,0] op_sel_hi:[1,1,1]
    ds_read_b128 v[112:115], v6 offset:3072
    s_waitcnt lgkmcnt(3)
    v_pk_fma_f32 v[52:53], v[116:117], v[34:35], v[52:53] op_sel:[0,0,0] op_sel_hi:[1,0,1]
    v_pk_fma_f32 v[54:55], v[118:119], v[34:35], v[54:55] op_sel:[0,0,0] op_sel_hi:[1,0,1]
    ds_read_b128 v[116:119], v6 offset:3088
    s_waitcnt lgkmcnt(3)
    v_pk_fma_f32 v[56:57], v[120:121], v[34:35], v[56:57] op_sel:[0,0,0] op_sel_hi:[1,0,1]
    v_pk_fma_f32 v[58:59], v[122:123], v[34:35], v[58:59] op_sel:[0,0,0] op_sel_hi:[1,0,1]
    ds_read_b128 v[120:123], v6 offset:3104
    s_waitcnt lgkmcnt(3)
    v_pk_fma_f32 v[60:61], v[124:125], v[34:35], v[60:61] op_sel:[0,0,0] op_sel_hi:[1,0,1]
    v_pk_fma_f32 v[62:63], v[126:127], v[34:35], v[62:63] op_sel:[0,0,0] op_sel_hi:[1,0,1]
    ds_read_b128 v[124:127], v6 offset:3120
    s_waitcnt lgkmcnt(3)
    v_pk_fma_f32 v[64:65], v[112:113], v[34:35], v[64:65] op_sel:[0,0,0] op_sel_hi:[1,0,1]
    v_pk_fma_f32 v[66:67], v[114:115], v[34:35], v[66:67] op_sel:[0,0,0] op_sel_hi:[1,0,1]
    ds_read_b128 v[112:115], v6 offset:3136
    s_waitcnt lgkmcnt(3)
    v_pk_fma_f32 v[68:69], v[116:117], v[34:35], v[68:69] op_sel:[0,0,0] op_sel_hi:[1,0,1]
    v_pk_fma_f32 v[52:53], v[118:119], v[34:35], v[52:53] op_sel:[0,1,0] op_sel_hi:[1,1,1]
    ds_read_b128 v[116:119], v6 offset:3152
    s_waitcnt lgkmcnt(3)
    v_pk_fma_f32 v[54:55], v[120:121], v[34:35], v[54:55] op_sel:[0,1,0] op_sel_hi:[1,1,1]
    v_pk_fma_f32 v[56:57], v[122:123], v[34:35], v[56:57] op_sel:[0,1,0] op_sel_hi:[1,1,1]
    ds_read_b128 v[120:123], v6 offset:3168
    s_waitcnt lgkmcnt(3)
    v_pk_fma_f32 v[58:59], v[124:125], v[34:35], v[58:59] op_sel:[0,1,0] op_sel_hi:[1,1,1]
    v_pk_fma_f32 v[60:61], v[126:127], v[34:35], v[60:61] op_sel:[0,1,0] op_sel_hi:[1,1,1]
    ds_read_b128 v[124:127], v6 offset:3184
    s_waitcnt lgkmcnt(3)
    v_pk_fma_f32 v[62:63], v[112:113], v[34:35], v[62:63] op_sel:[0,1,0] op_sel_hi:[1,1,1]
    v_pk_fma_f32 v[64:65], v[114:115], v[34:35], v[64:65] op_sel:[0,1,0] op_sel_hi:[1,1,1]
    ds_read_b128 v[112:115], v6 offset:3200
    s_waitcnt lgkmcnt(3)
    v_pk_fma_f32 v[66:67], v[116:117], v[34:35], v[66:67] op_sel:[0,1,0] op_sel_hi:[1,1,1]
    v_pk_fma_f32 v[68:69], v[118:119], v[34:35], v[68:69] op_sel:[0,1,0] op_sel_hi:[1,1,1]
    ds_read_b128 v[116:119], v6 offset:3216
    s_waitcnt lgkmcnt(3)
    v_pk_fma_f32 v[52:53], v[120:121], v[36:37], v[52:53] op_sel:[0,0,0] op_sel_hi:[1,0,1]
    v_pk_fma_f32 v[54:55], v[122:123], v[36:37], v[54:55] op_sel:[0,0,0] op_sel_hi:[1,0,1]
    ds_read_b128 v[120:123], v6 offset:3232
    s_waitcnt lgkmcnt(3)
    v_pk_fma_f32 v[56:57], v[124:125], v[36:37], v[56:57] op_sel:[0,0,0] op_sel_hi:[1,0,1]
    v_pk_fma_f32 v[58:59], v[126:127], v[36:37], v[58:59] op_sel:[0,0,0] op_sel_hi:[1,0,1]
    ds_read_b128 v[124:127], v6 offset:3248
    s_waitcnt lgkmcnt(3)
    v_pk_fma_f32 v[60:61], v[112:113], v[36:37], v[60:61] op_sel:[0,0,0] op_sel_hi:[1,0,1]
    v_pk_fma_f32 v[62:63], v[114:115], v[36:37], v[62:63] op_sel:[0,0,0] op_sel_hi:[1,0,1]
    ds_read_b128 v[112:115], v6 offset:3264
    s_waitcnt lgkmcnt(3)
    v_pk_fma_f32 v[64:65], v[116:117], v[36:37], v[64:65] op_sel:[0,0,0] op_sel_hi:[1,0,1]
    v_pk_fma_f32 v[66:67], v[118:119], v[36:37], v[66:67] op_sel:[0,0,0] op_sel_hi:[1,0,1]
    ds_read_b128 v[116:119], v6 offset:3280
    s_waitcnt lgkmcnt(3)
    v_pk_fma_f32 v[68:69], v[120:121], v[36:37], v[68:69] op_sel:[0,0,0] op_sel_hi:[1,0,1]
    v_pk_fma_f32 v[52:53], v[122:123], v[36:37], v[52:53] op_sel:[0,1,0] op_sel_hi:[1,1,1]
    ds_read_b128 v[120:123], v6 offset:3296
    s_waitcnt lgkmcnt(3)
    v_pk_fma_f32 v[54:55], v[124:125], v[36:37], v[54:55] op_sel:[0,1,0] op_sel_hi:[1,1,1]
    v_pk_fma_f32 v[56:57], v[126:127], v[36:37], v[56:57] op_sel:[0,1,0] op_sel_hi:[1,1,1]
    ds_read_b128 v[124:127], v6 offset:3312
    s_waitcnt lgkmcnt(3)
    v_pk_fma_f32 v[58:59], v[112:113], v[36:37], v[58:59] op_sel:[0,1,0] op_sel_hi:[1,1,1]
    v_pk_fma_f32 v[60:61], v[114:115], v[36:37], v[60:61] op_sel:[0,1,0] op_sel_hi:[1,1,1]
    ds_read_b128 v[112:115], v6 offset:3328
    s_waitcnt lgkmcnt(3)
    v_pk_fma_f32 v[62:63], v[116:117], v[36:37], v[62:63] op_sel:[0,1,0] op_sel_hi:[1,1,1]
    v_pk_fma_f32 v[64:65], v[118:119], v[36:37], v[64:65] op_sel:[0,1,0] op_sel_hi:[1,1,1]
    ds_read_b128 v[116:119], v6 offset:3344
    s_waitcnt lgkmcnt(3)
    v_pk_fma_f32 v[66:67], v[120:121], v[36:37], v[66:67] op_sel:[0,1,0] op_sel_hi:[1,1,1]
    v_pk_fma_f32 v[68:69], v[122:123], v[36:37], v[68:69] op_sel:[0,1,0] op_sel_hi:[1,1,1]
    ds_read_b128 v[120:123], v6 offset:3360
    s_waitcnt lgkmcnt(3)
    v_pk_fma_f32 v[52:53], v[124:125], v[38:39], v[52:53] op_sel:[0,0,0] op_sel_hi:[1,0,1]
    v_pk_fma_f32 v[54:55], v[126:127], v[38:39], v[54:55] op_sel:[0,0,0] op_sel_hi:[1,0,1]
    ds_read_b128 v[124:127], v6 offset:3376
    s_waitcnt lgkmcnt(3)
    v_pk_fma_f32 v[56:57], v[112:113], v[38:39], v[56:57] op_sel:[0,0,0] op_sel_hi:[1,0,1]
    v_pk_fma_f32 v[58:59], v[114:115], v[38:39], v[58:59] op_sel:[0,0,0] op_sel_hi:[1,0,1]
    ds_read_b128 v[112:115], v6 offset:3392
    s_waitcnt lgkmcnt(3)
    v_pk_fma_f32 v[60:61], v[116:117], v[38:39], v[60:61] op_sel:[0,0,0] op_sel_hi:[1,0,1]
    v_pk_fma_f32 v[62:63], v[118:119], v[38:39], v[62:63] op_sel:[0,0,0] op_sel_hi:[1,0,1]
    ds_read_b128 v[116:119], v6 offset:3408
    s_waitcnt lgkmcnt(3)
    v_pk_fma_f32 v[64:65], v[120:121], v[38:39], v[64:65] op_sel:[0,0,0] op_sel_hi:[1,0,1]
    v_pk_fma_f32 v[66:67], v[122:123], v[38:39], v[66:67] op_sel:[0,0,0] op_sel_hi:[1,0,1]
    ds_read_b128 v[120:123], v6 offset:3424
    s_waitcnt lgkmcnt(3)
    v_pk_fma_f32 v[68:69], v[124:125], v[38:39], v[68:69] op_sel:[0,0,0] op_sel_hi:[1,0,1]
    v_pk_fma_f32 v[52:53], v[126:127], v[38:39], v[52:53] op_sel:[0,1,0] op_sel_hi:[1,1,1]
    ds_read_b128 v[124:127], v6 offset:3440
    s_waitcnt lgkmcnt(3)
    v_pk_fma_f32 v[54:55], v[112:113], v[38:39], v[54:55] op_sel:[0,1,0] op_sel_hi:[1,1,1]
    v_pk_fma_f32 v[56:57], v[114:115], v[38:39], v[56:57] op_sel:[0,1,0] op_sel_hi:[1,1,1]
    ds_read_b128 v[112:115], v6 offset:3456
    s_waitcnt lgkmcnt(3)
    v_pk_fma_f32 v[58:59], v[116:117], v[38:39], v[58:59] op_sel:[0,1,0] op_sel_hi:[1,1,1]
    v_pk_fma_f32 v[60:61], v[118:119], v[38:39], v[60:61] op_sel:[0,1,0] op_sel_hi:[1,1,1]
    ds_read_b128 v[116:119], v6 offset:3472
    s_waitcnt lgkmcnt(3)
    v_pk_fma_f32 v[62:63], v[120:121], v[38:39], v[62:63] op_sel:[0,1,0] op_sel_hi:[1,1,1]
    v_pk_fma_f32 v[64:65], v[122:123], v[38:39], v[64:65] op_sel:[0,1,0] op_sel_hi:[1,1,1]
    ds_read_b128 v[120:123], v6 offset:3488
    s_waitcnt lgkmcnt(3)
    v_pk_fma_f32 v[66:67], v[124:125], v[38:39], v[66:67] op_sel:[0,1,0] op_sel_hi:[1,1,1]
    v_pk_fma_f32 v[68:69], v[126:127], v[38:39], v[68:69] op_sel:[0,1,0] op_sel_hi:[1,1,1]
    ds_read_b128 v[124:127], v6 offset:3504
    s_waitcnt lgkmcnt(3)
    v_pk_fma_f32 v[52:53], v[112:113], v[40:41], v[52:53] op_sel:[0,0,0] op_sel_hi:[1,0,1]
    v_pk_fma_f32 v[54:55], v[114:115], v[40:41], v[54:55] op_sel:[0,0,0] op_sel_hi:[1,0,1]
    ds_read_b128 v[112:115], v6 offset:3520
    s_waitcnt lgkmcnt(3)
    v_pk_fma_f32 v[56:57], v[116:117], v[40:41], v[56:57] op_sel:[0,0,0] op_sel_hi:[1,0,1]
    v_pk_fma_f32 v[58:59], v[118:119], v[40:41], v[58:59] op_sel:[0,0,0] op_sel_hi:[1,0,1]
    ds_read_b128 v[116:119], v6 offset:3536
    s_waitcnt lgkmcnt(3)
    v_pk_fma_f32 v[60:61], v[120:121], v[40:41], v[60:61] op_sel:[0,0,0] op_sel_hi:[1,0,1]
    v_pk_fma_f32 v[62:63], v[122:123], v[40:41], v[62:63] op_sel:[0,0,0] op_sel_hi:[1,0,1]
    ds_read_b128 v[120:123], v6 offset:3552
    s_waitcnt lgkmcnt(3)
    v_pk_fma_f32 v[64:65], v[124:125], v[40:41], v[64:65] op_sel:[0,0,0] op_sel_hi:[1,0,1]
    v_pk_fma_f32 v[66:67], v[126:127], v[40:41], v[66:67] op_sel:[0,0,0] op_sel_hi:[1,0,1]
    ds_read_b128 v[124:127], v6 offset:3568
    s_waitcnt lgkmcnt(3)
    v_pk_fma_f32 v[68:69], v[112:113], v[40:41], v[68:69] op_sel:[0,0,0] op_sel_hi:[1,0,1]
    v_pk_fma_f32 v[52:53], v[114:115], v[40:41], v[52:53] op_sel:[0,1,0] op_sel_hi:[1,1,1]
    ds_read_b128 v[112:115], v6 offset:3584
    s_waitcnt lgkmcnt(3)
    v_pk_fma_f32 v[54:55], v[116:117], v[40:41], v[54:55] op_sel:[0,1,0] op_sel_hi:[1,1,1]
    v_pk_fma_f32 v[56:57], v[118:119], v[40:41], v[56:57] op_sel:[0,1,0] op_sel_hi:[1,1,1]
    ds_read_b128 v[116:119], v6 offset:3600
    s_waitcnt lgkmcnt(3)
    v_pk_fma_f32 v[58:59], v[120:121], v[40:41], v[58:59] op_sel:[0,1,0] op_sel_hi:[1,1,1]
    v_pk_fma_f32 v[60:61], v[122:123], v[40:41], v[60:61] op_sel:[0,1,0] op_sel_hi:[1,1,1]
    ds_read_b128 v[120:123], v6 offset:3616
    s_waitcnt lgkmcnt(3)
    v_pk_fma_f32 v[62:63], v[124:125], v[40:41], v[62:63] op_sel:[0,1,0] op_sel_hi:[1,1,1]
    v_pk_fma_f32 v[64:65], v[126:127], v[40:41], v[64:65] op_sel:[0,1,0] op_sel_hi:[1,1,1]
    ds_read_b128 v[124:127], v6 offset:3632
    s_waitcnt lgkmcnt(3)
    v_pk_fma_f32 v[66:67], v[112:113], v[40:41], v[66:67] op_sel:[0,1,0] op_sel_hi:[1,1,1]
    v_pk_fma_f32 v[68:69], v[114:115], v[40:41], v[68:69] op_sel:[0,1,0] op_sel_hi:[1,1,1]
    ds_read_b128 v[112:115], v6 offset:3648
    s_waitcnt lgkmcnt(3)
    v_pk_fma_f32 v[52:53], v[116:117], v[42:43], v[52:53] op_sel:[0,0,0] op_sel_hi:[1,0,1]
    v_pk_fma_f32 v[54:55], v[118:119], v[42:43], v[54:55] op_sel:[0,0,0] op_sel_hi:[1,0,1]
    ds_read_b128 v[116:119], v6 offset:3664
    s_waitcnt lgkmcnt(3)
    v_pk_fma_f32 v[56:57], v[120:121], v[42:43], v[56:57] op_sel:[0,0,0] op_sel_hi:[1,0,1]
    v_pk_fma_f32 v[58:59], v[122:123], v[42:43], v[58:59] op_sel:[0,0,0] op_sel_hi:[1,0,1]
    ds_read_b128 v[120:123], v6 offset:3680
    s_waitcnt lgkmcnt(3)
    v_pk_fma_f32 v[60:61], v[124:125], v[42:43], v[60:61] op_sel:[0,0,0] op_sel_hi:[1,0,1]
    v_pk_fma_f32 v[62:63], v[126:127], v[42:43], v[62:63] op_sel:[0,0,0] op_sel_hi:[1,0,1]
    ds_read_b128 v[124:127], v6 offset:3696
    s_waitcnt lgkmcnt(3)
    v_pk_fma_f32 v[64:65], v[112:113], v[42:43], v[64:65] op_sel:[0,0,0] op_sel_hi:[1,0,1]
    v_pk_fma_f32 v[66:67], v[114:115], v[42:43], v[66:67] op_sel:[0,0,0] op_sel_hi:[1,0,1]
    ds_read_b128 v[112:115], v6 offset:3712
    s_waitcnt lgkmcnt(3)
    v_pk_fma_f32 v[68:69], v[116:117], v[42:43], v[68:69] op_sel:[0,0,0] op_sel_hi:[1,0,1]
    v_pk_fma_f32 v[52:53], v[118:119], v[42:43], v[52:53] op_sel:[0,1,0] op_sel_hi:[1,1,1]
    ds_read_b128 v[116:119], v6 offset:3728
    s_waitcnt lgkmcnt(3)
    v_pk_fma_f32 v[54:55], v[120:121], v[42:43], v[54:55] op_sel:[0,1,0] op_sel_hi:[1,1,1]
    v_pk_fma_f32 v[56:57], v[122:123], v[42:43], v[56:57] op_sel:[0,1,0] op_sel_hi:[1,1,1]
    ds_read_b128 v[120:123], v6 offset:3744
    s_waitcnt lgkmcnt(3)
    v_pk_fma_f32 v[58:59], v[124:125], v[42:43], v[58:59] op_sel:[0,1,0] op_sel_hi:[1,1,1]
    v_pk_fma_f32 v[60:61], v[126:127], v[42:43], v[60:61] op_sel:[0,1,0] op_sel_hi:[1,1,1]
    ds_read_b128 v[124:127], v6 offset:3760
    s_waitcnt lgkmcnt(3)
    v_pk_fma_f32 v[62:63], v[112:113], v[42:43], v[62:63] op_sel:[0,1,0] op_sel_hi:[1,1,1]
    v_pk_fma_f32 v[64:65], v[114:115], v[42:43], v[64:65] op_sel:[0,1,0] op_sel_hi:[1,1,1]
    ds_read_b128 v[112:115], v6 offset:3776
    s_waitcnt lgkmcnt(3)
    v_pk_fma_f32 v[66:67], v[116:117], v[42:43], v[66:67] op_sel:[0,1,0] op_sel_hi:[1,1,1]
    v_pk_fma_f32 v[68:69], v[118:119], v[42:43], v[68:69] op_sel:[0,1,0] op_sel_hi:[1,1,1]
    ds_read_b128 v[116:119], v6 offset:3792
    s_waitcnt lgkmcnt(3)
    v_pk_fma_f32 v[52:53], v[120:121], v[44:45], v[52:53] op_sel:[0,0,0] op_sel_hi:[1,0,1]
    v_pk_fma_f32 v[54:55], v[122:123], v[44:45], v[54:55] op_sel:[0,0,0] op_sel_hi:[1,0,1]
    ds_read_b128 v[120:123], v6 offset:3808
    s_waitcnt lgkmcnt(3)
    v_pk_fma_f32 v[56:57], v[124:125], v[44:45], v[56:57] op_sel:[0,0,0] op_sel_hi:[1,0,1]
    v_pk_fma_f32 v[58:59], v[126:127], v[44:45], v[58:59] op_sel:[0,0,0] op_sel_hi:[1,0,1]
    ds_read_b128 v[124:127], v6 offset:3824
    s_waitcnt lgkmcnt(3)
    v_pk_fma_f32 v[60:61], v[112:113], v[44:45], v[60:61] op_sel:[0,0,0] op_sel_hi:[1,0,1]
    v_pk_fma_f32 v[62:63], v[114:115], v[44:45], v[62:63] op_sel:[0,0,0] op_sel_hi:[1,0,1]
    ds_read_b128 v[112:115], v6 offset:3840
    s_waitcnt lgkmcnt(3)
    v_pk_fma_f32 v[64:65], v[116:117], v[44:45], v[64:65] op_sel:[0,0,0] op_sel_hi:[1,0,1]
    v_pk_fma_f32 v[66:67], v[118:119], v[44:45], v[66:67] op_sel:[0,0,0] op_sel_hi:[1,0,1]
    ds_read_b128 v[116:119], v6 offset:3856
    s_waitcnt lgkmcnt(3)
    v_pk_fma_f32 v[68:69], v[120:121], v[44:45], v[68:69] op_sel:[0,0,0] op_sel_hi:[1,0,1]
    v_pk_fma_f32 v[52:53], v[122:123], v[44:45], v[52:53] op_sel:[0,1,0] op_sel_hi:[1,1,1]
    ds_read_b128 v[120:123], v6 offset:3872
    s_waitcnt lgkmcnt(3)
    v_pk_fma_f32 v[54:55], v[124:125], v[44:45], v[54:55] op_sel:[0,1,0] op_sel_hi:[1,1,1]
    v_pk_fma_f32 v[56:57], v[126:127], v[44:45], v[56:57] op_sel:[0,1,0] op_sel_hi:[1,1,1]
    ds_read_b128 v[124:127], v6 offset:3888
    s_waitcnt lgkmcnt(3)
    v_pk_fma_f32 v[58:59], v[112:113], v[44:45], v[58:59] op_sel:[0,1,0] op_sel_hi:[1,1,1]
    v_pk_fma_f32 v[60:61], v[114:115], v[44:45], v[60:61] op_sel:[0,1,0] op_sel_hi:[1,1,1]
    ds_read_b128 v[112:115], v6 offset:3904
    s_waitcnt lgkmcnt(3)
    v_pk_fma_f32 v[62:63], v[116:117], v[44:45], v[62:63] op_sel:[0,1,0] op_sel_hi:[1,1,1]
    v_pk_fma_f32 v[64:65], v[118:119], v[44:45], v[64:65] op_sel:[0,1,0] op_sel_hi:[1,1,1]
    ds_read_b128 v[116:119], v6 offset:3920
    s_waitcnt lgkmcnt(3)
    v_pk_fma_f32 v[66:67], v[120:121], v[44:45], v[66:67] op_sel:[0,1,0] op_sel_hi:[1,1,1]
    v_pk_fma_f32 v[68:69], v[122:123], v[44:45], v[68:69] op_sel:[0,1,0] op_sel_hi:[1,1,1]
    ds_read_b128 v[120:123], v6 offset:3936
    s_waitcnt lgkmcnt(3)
    v_pk_fma_f32 v[52:53], v[124:125], v[46:47], v[52:53] op_sel:[0,0,0] op_sel_hi:[1,0,1]
    v_pk_fma_f32 v[54:55], v[126:127], v[46:47], v[54:55] op_sel:[0,0,0] op_sel_hi:[1,0,1]
    ds_read_b128 v[124:127], v6 offset:3952
    s_waitcnt lgkmcnt(3)
    v_pk_fma_f32 v[56:57], v[112:113], v[46:47], v[56:57] op_sel:[0,0,0] op_sel_hi:[1,0,1]
    v_pk_fma_f32 v[58:59], v[114:115], v[46:47], v[58:59] op_sel:[0,0,0] op_sel_hi:[1,0,1]
    ds_read_b128 v[112:115], v6 offset:3968
    s_waitcnt lgkmcnt(3)
    v_pk_fma_f32 v[60:61], v[116:117], v[46:47], v[60:61] op_sel:[0,0,0] op_sel_hi:[1,0,1]
    v_pk_fma_f32 v[62:63], v[118:119], v[46:47], v[62:63] op_sel:[0,0,0] op_sel_hi:[1,0,1]
    ds_read_b128 v[116:119], v6 offset:3984
    s_waitcnt lgkmcnt(3)
    v_pk_fma_f32 v[64:65], v[120:121], v[46:47], v[64:65] op_sel:[0,0,0] op_sel_hi:[1,0,1]
    v_pk_fma_f32 v[66:67], v[122:123], v[46:47], v[66:67] op_sel:[0,0,0] op_sel_hi:[1,0,1]
    ds_read_b128 v[120:123], v6 offset:4000
    s_waitcnt lgkmcnt(3)
    v_pk_fma_f32 v[68:69], v[124:125], v[46:47], v[68:69] op_sel:[0,0,0] op_sel_hi:[1,0,1]
    v_pk_fma_f32 v[52:53], v[126:127], v[46:47], v[52:53] op_sel:[0,1,0] op_sel_hi:[1,1,1]
    ds_read_b128 v[124:127], v6 offset:4016
    s_waitcnt lgkmcnt(3)
    v_pk_fma_f32 v[54:55], v[112:113], v[46:47], v[54:55] op_sel:[0,1,0] op_sel_hi:[1,1,1]
    v_pk_fma_f32 v[56:57], v[114:115], v[46:47], v[56:57] op_sel:[0,1,0] op_sel_hi:[1,1,1]
    ds_read_b128 v[112:115], v6 offset:4032
    s_waitcnt lgkmcnt(3)
    v_pk_fma_f32 v[58:59], v[116:117], v[46:47], v[58:59] op_sel:[0,1,0] op_sel_hi:[1,1,1]
    v_pk_fma_f32 v[60:61], v[118:119], v[46:47], v[60:61] op_sel:[0,1,0] op_sel_hi:[1,1,1]
    ds_read_b128 v[116:119], v6 offset:4048
    s_waitcnt lgkmcnt(3)
    v_pk_fma_f32 v[62:63], v[120:121], v[46:47], v[62:63] op_sel:[0,1,0] op_sel_hi:[1,1,1]
    v_pk_fma_f32 v[64:65], v[122:123], v[46:47], v[64:65] op_sel:[0,1,0] op_sel_hi:[1,1,1]
    ds_read_b128 v[120:123], v6 offset:4064
    s_waitcnt lgkmcnt(3)
    v_pk_fma_f32 v[66:67], v[124:125], v[46:47], v[66:67] op_sel:[0,1,0] op_sel_hi:[1,1,1]
    v_pk_fma_f32 v[68:69], v[126:127], v[46:47], v[68:69] op_sel:[0,1,0] op_sel_hi:[1,1,1]
    ds_read_b128 v[124:127], v6 offset:4080
    s_waitcnt lgkmcnt(3)
    v_pk_fma_f32 v[52:53], v[112:113], v[48:49], v[52:53] op_sel:[0,0,0] op_sel_hi:[1,0,1]
    v_pk_fma_f32 v[54:55], v[114:115], v[48:49], v[54:55] op_sel:[0,0,0] op_sel_hi:[1,0,1]
    ds_read_b128 v[112:115], v6 offset:4096
    s_waitcnt lgkmcnt(3)
    v_pk_fma_f32 v[56:57], v[116:117], v[48:49], v[56:57] op_sel:[0,0,0] op_sel_hi:[1,0,1]
    v_pk_fma_f32 v[58:59], v[118:119], v[48:49], v[58:59] op_sel:[0,0,0] op_sel_hi:[1,0,1]
    ds_read_b128 v[116:119], v6 offset:4112
    s_waitcnt lgkmcnt(3)
    v_pk_fma_f32 v[60:61], v[120:121], v[48:49], v[60:61] op_sel:[0,0,0] op_sel_hi:[1,0,1]
    v_pk_fma_f32 v[62:63], v[122:123], v[48:49], v[62:63] op_sel:[0,0,0] op_sel_hi:[1,0,1]
    ds_read_b128 v[120:123], v6 offset:4128
    s_waitcnt lgkmcnt(3)
    v_pk_fma_f32 v[64:65], v[124:125], v[48:49], v[64:65] op_sel:[0,0,0] op_sel_hi:[1,0,1]
    v_pk_fma_f32 v[66:67], v[126:127], v[48:49], v[66:67] op_sel:[0,0,0] op_sel_hi:[1,0,1]
    ds_read_b128 v[124:127], v6 offset:4144
    s_waitcnt lgkmcnt(3)
    v_pk_fma_f32 v[68:69], v[112:113], v[48:49], v[68:69] op_sel:[0,0,0] op_sel_hi:[1,0,1]
    v_pk_fma_f32 v[52:53], v[114:115], v[48:49], v[52:53] op_sel:[0,1,0] op_sel_hi:[1,1,1]
    ds_read_b128 v[112:115], v6 offset:4160
    s_waitcnt lgkmcnt(3)
    v_pk_fma_f32 v[54:55], v[116:117], v[48:49], v[54:55] op_sel:[0,1,0] op_sel_hi:[1,1,1]
    v_pk_fma_f32 v[56:57], v[118:119], v[48:49], v[56:57] op_sel:[0,1,0] op_sel_hi:[1,1,1]
    s_waitcnt lgkmcnt(2)
    v_pk_fma_f32 v[58:59], v[120:121], v[48:49], v[58:59] op_sel:[0,1,0] op_sel_hi:[1,1,1]
    v_pk_fma_f32 v[60:61], v[122:123], v[48:49], v[60:61] op_sel:[0,1,0] op_sel_hi:[1,1,1]
    s_waitcnt lgkmcnt(1)
    v_pk_fma_f32 v[62:63], v[124:125], v[48:49], v[62:63] op_sel:[0,1,0] op_sel_hi:[1,1,1]
    v_pk_fma_f32 v[64:65], v[126:127], v[48:49], v[64:65] op_sel:[0,1,0] op_sel_hi:[1,1,1]
    s_waitcnt lgkmcnt(0)
    v_pk_fma_f32 v[66:67], v[112:113], v[48:49], v[66:67] op_sel:[0,1,0] op_sel_hi:[1,1,1]
    v_pk_fma_f32 v[68:69], v[114:115], v[48:49], v[68:69] op_sel:[0,1,0] op_sel_hi:[1,1,1]
    v_cvt_pk_bf16_f32 v8, v52, v53
    v_cvt_pk_bf16_f32 v9, v54, v55
    v_cvt_pk_bf16_f32 v10, v56, v57
    v_cvt_pk_bf16_f32 v11, v58, v59
    v_cvt_pk_bf16_f32 v12, v60, v61
    v_cvt_pk_bf16_f32 v13, v62, v63
    v_cvt_pk_bf16_f32 v14, v64, v65
    v_cvt_pk_bf16_f32 v15, v66, v67
    v_cvt_pk_bf16_f32 v16, v68, v69
    v_lshlrev_b32 v52, 16, v8
    v_and_b32 v53, 0xffff0000, v8
    v_lshlrev_b32 v54, 16, v9
    v_and_b32 v55, 0xffff0000, v9
    v_lshlrev_b32 v56, 16, v10
    v_and_b32 v57, 0xffff0000, v10
    v_lshlrev_b32 v58, 16, v11
    v_and_b32 v59, 0xffff0000, v11
    v_lshlrev_b32 v60, 16, v12
    v_and_b32 v61, 0xffff0000, v12
    v_lshlrev_b32 v62, 16, v13
    v_and_b32 v63, 0xffff0000, v13
    v_lshlrev_b32 v64, 16, v14
    v_and_b32 v65, 0xffff0000, v14
    v_lshlrev_b32 v66, 16, v15
    v_and_b32 v67, 0xffff0000, v15
    v_lshlrev_b32 v68, 16, v16
    v_and_b32 v69, 0xffff0000, v16
    v_max3_f32 v8, v52, v53, v54
    v_min3_f32 v9, v52, v53, v54
    v_max3_f32 v8, v8, v55, v56
    v_min3_f32 v9, v9, v55, v56
    v_max3_f32 v8, v8, v57, v58
    v_min3_f32 v9, v9, v57, v58
    v_max3_f32 v8, v8, v59, v60
    v_min3_f32 v9, v9, v59, v60
    v_max3_f32 v8, v8, v61, v62
    v_min3_f32 v9, v9, v61, v62
    v_max3_f32 v8, v8, v63, v64
    v_min3_f32 v9, v9, v63, v64
    v_max3_f32 v8, v8, v65, v66
    v_min3_f32 v9, v9, v65, v66
    v_max3_f32 v8, v8, v67, v68
    v_min3_f32 v9, v9, v67, v68
    v_max_f32 v8, v8, v69
    v_min_f32 v9, v9, v69
    s_mov_b32 s34, 0x3fb8aa3b
    v_mul_f32 v8, s34, v8
    v_mul_f32 v9, s34, v9
    v_fma_f32 v72, v52, s34, -v8
    v_fma_f32 v92, -v52, s34, v9
    v_fma_f32 v73, v53, s34, -v8
    v_fma_f32 v93, -v53, s34, v9
    v_fma_f32 v74, v54, s34, -v8
    v_fma_f32 v94, -v54, s34, v9
    v_fma_f32 v75, v55, s34, -v8
    v_fma_f32 v95, -v55, s34, v9
    v_fma_f32 v76, v56, s34, -v8
    v_fma_f32 v96, -v56, s34, v9
    v_fma_f32 v77, v57, s34, -v8
    v_fma_f32 v97, -v57, s34, v9
    v_fma_f32 v78, v58, s34, -v8
    v_fma_f32 v98, -v58, s34, v9
    v_fma_f32 v79, v59, s34, -v8
    v_fma_f32 v99, -v59, s34, v9
    v_fma_f32 v80, v60, s34, -v8
    v_fma_f32 v100, -v60, s34, v9
    v_fma_f32 v81, v61, s34, -v8
    v_fma_f32 v101, -v61, s34, v9
    v_fma_f32 v82, v62, s34, -v8
    v_fma_f32 v102, -v62, s34, v9
    v_fma_f32 v83, v63, s34, -v8
    v_fma_f32 v103, -v63, s34, v9
    v_fma_f32 v84, v64, s34, -v8
    v_fma_f32 v104, -v64, s34, v9
    v_fma_f32 v85, v65, s34, -v8
    v_fma_f32 v105, -v65, s34, v9
    v_fma_f32 v86, v66, s34, -v8
    v_fma_f32 v106, -v66, s34, v9
    v_fma_f32 v87, v67, s34, -v8
    v_fma_f32 v107, -v67, s34, v9
    v_fma_f32 v88, v68, s34, -v8
    v_fma_f32 v108, -v68, s34, v9
    v_fma_f32 v89, v69, s34, -v8
    v_fma_f32 v109, -v69, s34, v9
    v_exp_f32 v72, v72
    v_exp_f32 v92, v92
    v_exp_f32 v73, v73
    v_exp_f32 v93, v93
    v_exp_f32 v74, v74
    v_exp_f32 v94, v94
    v_exp_f32 v75, v75
    v_exp_f32 v95, v95
    v_exp_f32 v76, v76
    v_exp_f32 v96, v96
    v_exp_f32 v77, v77
    v_exp_f32 v97, v97
    v_exp_f32 v78, v78
    v_exp_f32 v98, v98
    v_exp_f32 v79, v79
    v_exp_f32 v99, v99
    v_exp_f32 v80, v80
    v_exp_f32 v100, v100
    v_exp_f32 v81, v81
    v_exp_f32 v101, v101
    v_exp_f32 v82, v82
    v_exp_f32 v102, v102
    v_exp_f32 v83, v83
    v_exp_f32 v103, v103
    v_exp_f32 v84, v84
    v_exp_f32 v104, v104
    v_exp_f32 v85, v85
    v_exp_f32 v105, v105
    v_exp_f32 v86, v86
    v_exp_f32 v106, v106
    v_exp_f32 v87, v87
    v_exp_f32 v107, v107
    v_exp_f32 v88, v88
    v_exp_f32 v108, v108
    v_exp_f32 v89, v89
    v_exp_f32 v109, v109
    s_nop 0
    v_add_f32 v10, v72, v73
    v_add_f32 v11, v92, v93
    v_add_f32 v10, v10, v74
    v_add_f32 v11, v11, v94
    v_add_f32 v10, v10, v75
    v_add_f32 v11, v11, v95
    v_add_f32 v10, v10, v76
    v_add_f32 v11, v11, v96
    v_add_f32 v10, v10, v77
    v_add_f32 v11, v11, v97
    v_add_f32 v10, v10, v78
    v_add_f32 v11, v11, v98
    v_add_f32 v10, v10, v79
    v_add_f32 v11, v11, v99
    v_add_f32 v10, v10, v80
    v_add_f32 v11, v11, v100
    v_add_f32 v10, v10, v81
    v_add_f32 v11, v11, v101
    v_add_f32 v10, v10, v82
    v_add_f32 v11, v11, v102
    v_add_f32 v10, v10, v83
    v_add_f32 v11, v11, v103
    v_add_f32 v10, v10, v84
    v_add_f32 v11, v11, v104
    v_add_f32 v10, v10, v85
    v_add_f32 v11, v11, v105
    v_add_f32 v10, v10, v86
    v_add_f32 v11, v11, v106
    v_add_f32 v10, v10, v87
    v_add_f32 v11, v11, v107
    v_add_f32 v10, v10, v88
    v_add_f32 v11, v11, v108
    v_add_f32 v10, v10, v89
    v_add_f32 v11, v11, v109
    v_rcp_f32 v10, v10
    v_rcp_f32 v11, v11
    s_nop 0
    v_pk_mul_f32 v[72:73], v[72:73], v[10:11] op_sel:[0,0] op_sel_hi:[1,0]
    v_pk_mul_f32 v[92:93], v[92:93], v[10:11] op_sel:[0,1] op_sel_hi:[1,1]
    v_pk_mul_f32 v[74:75], v[74:75], v[10:11] op_sel:[0,0] op_sel_hi:[1,0]
    v_pk_mul_f32 v[94:95], v[94:95], v[10:11] op_sel:[0,1] op_sel_hi:[1,1]
    v_pk_mul_f32 v[76:77], v[76:77], v[10:11] op_sel:[0,0] op_sel_hi:[1,0]
    v_pk_mul_f32 v[96:97], v[96:97], v[10:11] op_sel:[0,1] op_sel_hi:[1,1]
    v_pk_mul_f32 v[78:79], v[78:79], v[10:11] op_sel:[0,0] op_sel_hi:[1,0]
    v_pk_mul_f32 v[98:99], v[98:99], v[10:11] op_sel:[0,1] op_sel_hi:[1,1]
    v_pk_mul_f32 v[80:81], v[80:81], v[10:11] op_sel:[0,0] op_sel_hi:[1,0]
    v_pk_mul_f32 v[100:101], v[100:101], v[10:11] op_sel:[0,1] op_sel_hi:[1,1]
    v_pk_mul_f32 v[82:83], v[82:83], v[10:11] op_sel:[0,0] op_sel_hi:[1,0]
    v_pk_mul_f32 v[102:103], v[102:103], v[10:11] op_sel:[0,1] op_sel_hi:[1,1]
    v_pk_mul_f32 v[84:85], v[84:85], v[10:11] op_sel:[0,0] op_sel_hi:[1,0]
    v_pk_mul_f32 v[104:105], v[104:105], v[10:11] op_sel:[0,1] op_sel_hi:[1,1]
    v_pk_mul_f32 v[86:87], v[86:87], v[10:11] op_sel:[0,0] op_sel_hi:[1,0]
    v_pk_mul_f32 v[106:107], v[106:107], v[10:11] op_sel:[0,1] op_sel_hi:[1,1]
    v_pk_mul_f32 v[88:89], v[88:89], v[10:11] op_sel:[0,0] op_sel_hi:[1,0]
    v_pk_mul_f32 v[108:109], v[108:109], v[10:11] op_sel:[0,1] op_sel_hi:[1,1]
    v_cvt_pk_bf16_f32 v8, v72, v73
    v_lshlrev_b32 v72, 16, v8
    v_and_b32 v73, 0xffff0000, v8
    v_cvt_pk_bf16_f32 v8, v74, v75
    v_lshlrev_b32 v74, 16, v8
    v_and_b32 v75, 0xffff0000, v8
    v_cvt_pk_bf16_f32 v8, v76, v77
    v_lshlrev_b32 v76, 16, v8
    v_and_b32 v77, 0xffff0000, v8
    v_cvt_pk_bf16_f32 v8, v78, v79
    v_lshlrev_b32 v78, 16, v8
    v_and_b32 v79, 0xffff0000, v8
    v_cvt_pk_bf16_f32 v8, v80, v81
    v_lshlrev_b32 v80, 16, v8
    v_and_b32 v81, 0xffff0000, v8
    v_cvt_pk_bf16_f32 v8, v82, v83
    v_lshlrev_b32 v82, 16, v8
    v_and_b32 v83, 0xffff0000, v8
    v_cvt_pk_bf16_f32 v8, v84, v85
    v_lshlrev_b32 v84, 16, v8
    v_and_b32 v85, 0xffff0000, v8
    v_cvt_pk_bf16_f32 v8, v86, v87
    v_lshlrev_b32 v86, 16, v8
    v_and_b32 v87, 0xffff0000, v8
    v_cvt_pk_bf16_f32 v8, v88, v89
    v_lshlrev_b32 v88, 16, v8
    v_and_b32 v89, 0xffff0000, v8
    v_cvt_pk_bf16_f32 v8, v92, v93
    v_lshlrev_b32 v92, 16, v8
    v_and_b32 v93, 0xffff0000, v8
    v_cvt_pk_bf16_f32 v8, v94, v95
    v_lshlrev_b32 v94, 16, v8
    v_and_b32 v95, 0xffff0000, v8
    v_cvt_pk_bf16_f32 v8, v96, v97
    v_lshlrev_b32 v96, 16, v8
    v_and_b32 v97, 0xffff0000, v8
    v_cvt_pk_bf16_f32 v8, v98, v99
    v_lshlrev_b32 v98, 16, v8
    v_and_b32 v99, 0xffff0000, v8
    v_cvt_pk_bf16_f32 v8, v100, v101
    v_lshlrev_b32 v100, 16, v8
    v_and_b32 v101, 0xffff0000, v8
    v_cvt_pk_bf16_f32 v8, v102, v103
    v_lshlrev_b32 v102, 16, v8
    v_and_b32 v103, 0xffff0000, v8
    v_cvt_pk_bf16_f32 v8, v104, v105
    v_lshlrev_b32 v104, 16, v8
    v_and_b32 v105, 0xffff0000, v8
    v_cvt_pk_bf16_f32 v8, v106, v107
    v_lshlrev_b32 v106, 16, v8
    v_and_b32 v107, 0xffff0000, v8
    v_cvt_pk_bf16_f32 v8, v108, v109
    v_lshlrev_b32 v108, 16, v8
    v_and_b32 v109, 0xffff0000, v8
    v_mov_b32 v32, 0
    v_mov_b32 v33, 0
    v_mov_b32 v34, 0
    v_mov_b32 v35, 0
    v_mov_b32 v36, 0
    v_mov_b32 v37, 0
    v_mov_b32 v38, 0
    v_mov_b32 v39, 0
    v_mov_b32 v40, 0
    v_mov_b32 v41, 0
    v_mov_b32 v42, 0
    v_mov_b32 v43, 0
    v_mov_b32 v44, 0
    v_mov_b32 v45, 0
    v_mov_b32 v46, 0
    v_mov_b32 v47, 0
    v_mov_b32 v48, 0
    v_mov_b32 v49, 0
    v_mov_b32 v50, 0
    v_mov_b32 v51, 0
    ds_read_b128 v[112:115], v6 offset:0
    ds_read_b128 v[116:119], v6 offset:16
    ds_read_b128 v[120:123], v6 offset:32
    ds_read_b128 v[124:127], v6 offset:48
    ds_read_b128 v[128:131], v6 offset:64
    ds_read_b128 v[132:135], v6 offset:80
    ds_read_b128 v[136:139], v6 offset:96
    ds_read_b128 v[140:143], v6 offset:112
    ds_read_b128 v[144:147], v6 offset:128
    ds_read_b128 v[148:151], v6 offset:144
    ds_read_b128 v[152:155], v6 offset:160
    ds_read_b128 v[156:159], v6 offset:176
    ds_read_b128 v[160:163], v6 offset:192
    ds_read_b128 v[164:167], v6 offset:208
    ds_read_b128 v[168:171], v6 offset:224
    s_waitcnt lgkmcnt(10)
    v_pk_fma_f32 v[32:33], v[112:113], v[72:73], v[32:33] op_sel:[0,0,0] op_sel_hi:[1,0,1]
    v_pk_fma_f32 v[34:35], v[114:115], v[72:73], v[34:35] op_sel:[0,0,0] op_sel_hi:[1,0,1]
    v_pk_fma_f32 v[36:37], v[116:117], v[72:73], v[36:37] op_sel:[0,0,0] op_sel_hi:[1,0,1]
    v_pk_fma_f32 v[38:39], v[118:119], v[72:73], v[38:39] op_sel:[0,0,0] op_sel_hi:[1,0,1]
    v_pk_fma_f32 v[40:41], v[120:121], v[72:73], v[40:41] op_sel:[0,0,0] op_sel_hi:[1,0,1]
    v_pk_fma_f32 v[42:43], v[122:123], v[72:73], v[42:43] op_sel:[0,0,0] op_sel_hi:[1,0,1]
    v_pk_fma_f32 v[44:45], v[124:125], v[72:73], v[44:45] op_sel:[0,0,0] op_sel_hi:[1,0,1]
    v_pk_fma_f32 v[46:47], v[126:127], v[72:73], v[46:47] op_sel:[0,0,0] op_sel_hi:[1,0,1]
    v_pk_fma_f32 v[48:49], v[128:129], v[72:73], v[48:49] op_sel:[0,0,0] op_sel_hi:[1,0,1]
    v_pk_fma_f32 v[50:51], v[130:131], v[72:73], v[50:51] op_sel:[0,0,0] op_sel_hi:[1,0,1]
    ds_read_b128 v[112:115], v6 offset:240
    ds_read_b128 v[116:119], v6 offset:256
    ds_read_b128 v[120:123], v6 offset:272
    ds_read_b128 v[124:127], v6 offset:288
    ds_read_b128 v[128:131], v6 offset:304
    s_waitcnt lgkmcnt(10)
    v_pk_fma_f32 v[32:33], v[132:133], v[72:73], v[32:33] op_sel:[0,1,0] op_sel_hi:[1,1,1]
    v_pk_fma_f32 v[34:35], v[134:135], v[72:73], v[34:35] op_sel:[0,1,0] op_sel_hi:[1,1,1]
    v_pk_fma_f32 v[36:37], v[136:137], v[72:73], v[36:37] op_sel:[0,1,0] op_sel_hi:[1,1,1]
    v_pk_fma_f32 v[38:39], v[138:139], v[72:73], v[38:39] op_sel:[0,1,0] op_sel_hi:[1,1,1]
    v_pk_fma_f32 v[40:41], v[140:141], v[72:73], v[40:41] op_sel:[0,1,0] op_sel_hi:[1,1,1]
    v_pk_fma_f32 v[42:43], v[142:143], v[72:73], v[42:43] op_sel:[0,1,0] op_sel_hi:[1,1,1]
    v_pk_fma_f32 v[44:45], v[144:145], v[72:73], v[44:45] op_sel:[0,1,0] op_sel_hi:[1,1,1]
    v_pk_fma_f32 v[46:47], v[146:147], v[72:73], v[46:47] op_sel:[0,1,0] op_sel_hi:[1,1,1]
    v_pk_fma_f32 v[48:49], v[148:149], v[72:73], v[48:49] op_sel:[0,1,0] op_sel_hi:[1,1,1]
    v_pk_fma_f32 v[50:51], v[150:151], v[72:73], v[50:51] op_sel:[0,1,0] op_sel_hi:[1,1,1]
    ds_read_b128 v[132:135], v6 offset:320
    ds_read_b128 v[136:139], v6 offset:336
    ds_read_b128 v[140:143], v6 offset:352
    ds_read_b128 v[144:147], v6 offset:368
    ds_read_b128 v[148:151], v6 offset:384
    s_waitcnt lgkmcnt(10)
    v_pk_fma_f32 v[32:33], v[152:153], v[74:75], v[32:33] op_sel:[0,0,0] op_sel_hi:[1,0,1]
    v_pk_fma_f32 v[34:35], v[154:155], v[74:75], v[34:35] op_sel:[0,0,0] op_sel_hi:[1,0,1]
    v_pk_fma_f32 v[36:37], v[156:157], v[74:75], v[36:37] op_sel:[0,0,0] op_sel_hi:[1,0,1]
    v_pk_fma_f32 v[38:39], v[158:159], v[74:75], v[38:39] op_sel:[0,0,0] op_sel_hi:[1,0,1]
    v_pk_fma_f32 v[40:41], v[160:161], v[74:75], v[40:41] op_sel:[0,0,0] op_sel_hi:[1,0,1]
    v_pk_fma_f32 v[42:43], v[162:163], v[74:75], v[42:43] op_sel:[0,0,0] op_sel_hi:[1,0,1]
    v_pk_fma_f32 v[44:45], v[164:165], v[74:75], v[44:45] op_sel:[0,0,0] op_sel_hi:[1,0,1]
    v_pk_fma_f32 v[46:47], v[166:167], v[74:75], v[46:47] op_sel:[0,0,0] op_sel_hi:[1,0,1]
    v_pk_fma_f32 v[48:49], v[168:169], v[74:75], v[48:49] op_sel:[0,0,0] op_sel_hi:[1,0,1]
    v_pk_fma_f32 v[50:51], v[170:171], v[74:75], v[50:51] op_sel:[0,0,0] op_sel_hi:[1,0,1]
    ds_read_b128 v[152:155], v6 offset:400
    ds_read_b128 v[156:159], v6 offset:416
    ds_read_b128 v[160:163], v6 offset:432
    ds_read_b128 v[164:167], v6 offset:448
    ds_read_b128 v[168:171], v6 offset:464
    s_waitcnt lgkmcnt(10)
    v_pk_fma_f32 v[32:33], v[112:113], v[74:75], v[32:33] op_sel:[0,1,0] op_sel_hi:[1,1,1]
    v_pk_fma_f32 v[34:35], v[114:115], v[74:75], v[34:35] op_sel:[0,1,0] op_sel_hi:[1,1,1]
    v_pk_fma_f32 v[36:37], v[116:117], v[74:75], v[36:37] op_sel:[0,1,0] op_sel_hi:[1,1,1]
    v_pk_fma_f32 v[38:39], v[118:119], v[74:75], v[38:39] op_sel:[0,1,0] op_sel_hi:[1,1,1]
    v_pk_fma_f32 v[40:41], v[120:121], v[74:75], v[40:41] op_sel:[0,1,0] op_sel_hi:[1,1,1]
    v_pk_fma_f32 v[42:43], v[122:123], v[74:75], v[42:43] op_sel:[0,1,0] op_sel_hi:[1,1,1]
    v_pk_fma_f32 v[44:45], v[124:125], v[74:75], v[44:45] op_sel:[0,1,0] op_sel_hi:[1,1,1]
    v_pk_fma_f32 v[46:47], v[126:127], v[74:75], v[46:47] op_sel:[0,1,0] op_sel_hi:[1,1,1]
    v_pk_fma_f32 v[48:49], v[128:129], v[74:75], v[48:49] op_sel:[0,1,0] op_sel_hi:[1,1,1]
    v_pk_fma_f32 v[50:51], v[130:131], v[74:75], v[50:51] op_sel:[0,1,0] op_sel_hi:[1,1,1]
    ds_read_b128 v[112:115], v6 offset:480
    ds_read_b128 v[116:119], v6 offset:496
    ds_read_b128 v[120:123], v6 offset:512
    ds_read_b128 v[124:127], v6 offset:528
    ds_read_b128 v[128:131], v6 offset:544
    s_waitcnt lgkmcnt(10)
    v_pk_fma_f32 v[32:33], v[132:133], v[76:77], v[32:33] op_sel:[0,0,0] op_sel_hi:[1,0,1]
    v_pk_fma_f32 v[34:35], v[134:135], v[76:77], v[34:35] op_sel:[0,0,0] op_sel_hi:[1,0,1]
    v_pk_fma_f32 v[36:37], v[136:137], v[76:77], v[36:37] op_sel:[0,0,0] op_sel_hi:[1,0,1]
    v_pk_fma_f32 v[38:39], v[138:139], v[76:77], v[38:39] op_sel:[0,0,0] op_sel_hi:[1,0,1]
    v_pk_fma_f32 v[40:41], v[140:141], v[76:77], v[40:41] op_sel:[0,0,0] op_sel_hi:[1,0,1]
    v_pk_fma_f32 v[42:43], v[142:143], v[76:77], v[42:43] op_sel:[0,0,0] op_sel_hi:[1,0,1]
    v_pk_fma_f32 v[44:45], v[144:145], v[76:77], v[44:45] op_sel:[0,0,0] op_sel_hi:[1,0,1]
    v_pk_fma_f32 v[46:47], v[146:147], v[76:77], v[46:47] op_sel:[0,0,0] op_sel_hi:[1,0,1]
    v_pk_fma_f32 v[48:49], v[148:149], v[76:77], v[48:49] op_sel:[0,0,0] op_sel_hi:[1,0,1]
    v_pk_fma_f32 v[50:51], v[150:151], v[76:77], v[50:51] op_sel:[0,0,0] op_sel_hi:[1,0,1]
    ds_read_b128 v[132:135], v6 offset:560
    ds_read_b128 v[136:139], v6 offset:576
    ds_read_b128 v[140:143], v6 offset:592
    ds_read_b128 v[144:147], v6 offset:608
    ds_read_b128 v[148:151], v6 offset:624
    s_waitcnt lgkmcnt(10)
    v_pk_fma_f32 v[32:33], v[152:153], v[76:77], v[32:33] op_sel:[0,1,0] op_sel_hi:[1,1,1]
    v_pk_fma_f32 v[34:35], v[154:155], v[76:77], v[34:35] op_sel:[0,1,0] op_sel_hi:[1,1,1]
    v_pk_fma_f32 v[36:37], v[156:157], v[76:77], v[36:37] op_sel:[0,1,0] op_sel_hi:[1,1,1]
    v_pk_fma_f32 v[38:39], v[158:159], v[76:77], v[38:39] op_sel:[0,1,0] op_sel_hi:[1,1,1]
    v_pk_fma_f32 v[40:41], v[160:161], v[76:77], v[40:41] op_sel:[0,1,0] op_sel_hi:[1,1,1]
    v_pk_fma_f32 v[42:43], v[162:163], v[76:77], v[42:43] op_sel:[0,1,0] op_sel_hi:[1,1,1]
    v_pk_fma_f32 v[44:45], v[164:165], v[76:77], v[44:45] op_sel:[0,1,0] op_sel_hi:[1,1,1]
    v_pk_fma_f32 v[46:47], v[166:167], v[76:77], v[46:47] op_sel:[0,1,0] op_sel_hi:[1,1,1]
    v_pk_fma_f32 v[48:49], v[168:169], v[76:77], v[48:49] op_sel:[0,1,0] op_sel_hi:[1,1,1]
    v_pk_fma_f32 v[50:51], v[170:171], v[76:77], v[50:51] op_sel:[0,1,0] op_sel_hi:[1,1,1]
    ds_read_b128 v[152:155], v6 offset:640
    ds_read_b128 v[156:159], v6 offset:656
    ds_read_b128 v[160:163], v6 offset:672
    ds_read_b128 v[164:167], v6 offset:688
    ds_read_b128 v[168:171], v6 offset:704
    s_waitcnt lgkmcnt(10)
    v_pk_fma_f32 v[32:33], v[112:113], v[78:79], v[32:33] op_sel:[0,0,0] op_sel_hi:[1,0,1]
    v_pk_fma_f32 v[34:35], v[114:115], v[78:79], v[34:35] op_sel:[0,0,0] op_sel_hi:[1,0,1]
    v_pk_fma_f32 v[36:37], v[116:117], v[78:79], v[36:37] op_sel:[0,0,0] op_sel_hi:[1,0,1]
    v_pk_fma_f32 v[38:39], v[118:119], v[78:79], v[38:39] op_sel:[0,0,0] op_sel_hi:[1,0,1]
    v_pk_fma_f32 v[40:41], v[120:121], v[78:79], v[40:41] op_sel:[0,0,0] op_sel_hi:[1,0,1]
    v_pk_fma_f32 v[42:43], v[122:123], v[78:79], v[42:43] op_sel:[0,0,0] op_sel_hi:[1,0,1]
    v_pk_fma_f32 v[44:45], v[124:125], v[78:79], v[44:45] op_sel:[0,0,0] op_sel_hi:[1,0,1]
    v_pk_fma_f32 v[46:47], v[126:127], v[78:79], v[46:47] op_sel:[0,0,0] op_sel_hi:[1,0,1]
    v_pk_fma_f32 v[48:49], v[128:129], v[78:79], v[48:49] op_sel:[0,0,0] op_sel_hi:[1,0,1]
    v_pk_fma_f32 v[50:51], v[130:131], v[78:79], v[50:51] op_sel:[0,0,0] op_sel_hi:[1,0,1]
    ds_read_b128 v[112:115], v6 offset:720
    ds_read_b128 v[116:119], v6 offset:736
    ds_read_b128 v[120:123], v6 offset:752
    ds_read_b128 v[124:127], v6 offset:768
    ds_read_b128 v[128:131], v6 offset:784
    s_waitcnt lgkmcnt(10)
    v_pk_fma_f32 v[32:33], v[132:133], v[78:79], v[32:33] op_sel:[0,1,0] op_sel_hi:[1,1,1]
    v_pk_fma_f32 v[34:35], v[134:135], v[78:79], v[34:35] op_sel:[0,1,0] op_sel_hi:[1,1,1]
    v_pk_fma_f32 v[36:37], v[136:137], v[78:79], v[36:37] op_sel:[0,1,0] op_sel_hi:[1,1,1]
    v_pk_fma_f32 v[38:39], v[138:139], v[78:79], v[38:39] op_sel:[0,1,0] op_sel_hi:[1,1,1]
    v_pk_fma_f32 v[40:41], v[140:141], v[78:79], v[40:41] op_sel:[0,1,0] op_sel_hi:[1,1,1]
    v_pk_fma_f32 v[42:43], v[142:143], v[78:79], v[42:43] op_sel:[0,1,0] op_sel_hi:[1,1,1]
    v_pk_fma_f32 v[44:45], v[144:145], v[78:79], v[44:45] op_sel:[0,1,0] op_sel_hi:[1,1,1]
    v_pk_fma_f32 v[46:47], v[146:147], v[78:79], v[46:47] op_sel:[0,1,0] op_sel_hi:[1,1,1]
    v_pk_fma_f32 v[48:49], v[148:149], v[78:79], v[48:49] op_sel:[0,1,0] op_sel_hi:[1,1,1]
    v_pk_fma_f32 v[50:51], v[150:151], v[78:79], v[50:51] op_sel:[0,1,0] op_sel_hi:[1,1,1]
    ds_read_b128 v[132:135], v6 offset:800
    ds_read_b128 v[136:139], v6 offset:816
    ds_read_b128 v[140:143], v6 offset:832
    ds_read_b128 v[144:147], v6 offset:848
    ds_read_b128 v[148:151], v6 offset:864
    s_waitcnt lgkmcnt(10)
    v_pk_fma_f32 v[32:33], v[152:153], v[80:81], v[32:33] op_sel:[0,0,0] op_sel_hi:[1,0,1]
    v_pk_fma_f32 v[34:35], v[154:155], v[80:81], v[34:35] op_sel:[0,0,0] op_sel_hi:[1,0,1]
    v_pk_fma_f32 v[36:37], v[156:157], v[80:81], v[36:37] op_sel:[0,0,0] op_sel_hi:[1,0,1]
    v_pk_fma_f32 v[38:39], v[158:159], v[80:81], v[38:39] op_sel:[0,0,0] op_sel_hi:[1,0,1]
    v_pk_fma_f32 v[40:41], v[160:161], v[80:81], v[40:41] op_sel:[0,0,0] op_sel_hi:[1,0,1]
    v_pk_fma_f32 v[42:43], v[162:163], v[80:81], v[42:43] op_sel:[0,0,0] op_sel_hi:[1,0,1]
    v_pk_fma_f32 v[44:45], v[164:165], v[80:81], v[44:45] op_sel:[0,0,0] op_sel_hi:[1,0,1]
    v_pk_fma_f32 v[46:47], v[166:167], v[80:81], v[46:47] op_sel:[0,0,0] op_sel_hi:[1,0,1]
    v_pk_fma_f32 v[48:49], v[168:169], v[80:81], v[48:49] op_sel:[0,0,0] op_sel_hi:[1,0,1]
    v_pk_fma_f32 v[50:51], v[170:171], v[80:81], v[50:51] op_sel:[0,0,0] op_sel_hi:[1,0,1]
    ds_read_b128 v[152:155], v6 offset:880
    ds_read_b128 v[156:159], v6 offset:896
    ds_read_b128 v[160:163], v6 offset:912
    ds_read_b128 v[164:167], v6 offset:928
    ds_read_b128 v[168:171], v6 offset:944
    s_waitcnt lgkmcnt(10)
    v_pk_fma_f32 v[32:33], v[112:113], v[80:81], v[32:33] op_sel:[0,1,0] op_sel_hi:[1,1,1]
    v_pk_fma_f32 v[34:35], v[114:115], v[80:81], v[34:35] op_sel:[0,1,0] op_sel_hi:[1,1,1]
    v_pk_fma_f32 v[36:37], v[116:117], v[80:81], v[36:37] op_sel:[0,1,0] op_sel_hi:[1,1,1]
    v_pk_fma_f32 v[38:39], v[118:119], v[80:81], v[38:39] op_sel:[0,1,0] op_sel_hi:[1,1,1]
    v_pk_fma_f32 v[40:41], v[120:121], v[80:81], v[40:41] op_sel:[0,1,0] op_sel_hi:[1,1,1]
    v_pk_fma_f32 v[42:43], v[122:123], v[80:81], v[42:43] op_sel:[0,1,0] op_sel_hi:[1,1,1]
    v_pk_fma_f32 v[44:45], v[124:125], v[80:81], v[44:45] op_sel:[0,1,0] op_sel_hi:[1,1,1]
    v_pk_fma_f32 v[46:47], v[126:127], v[80:81], v[46:47] op_sel:[0,1,0] op_sel_hi:[1,1,1]
    v_pk_fma_f32 v[48:49], v[128:129], v[80:81], v[48:49] op_sel:[0,1,0] op_sel_hi:[1,1,1]
    v_pk_fma_f32 v[50:51], v[130:131], v[80:81], v[50:51] op_sel:[0,1,0] op_sel_hi:[1,1,1]
    ds_read_b128 v[112:115], v6 offset:960
    ds_read_b128 v[116:119], v6 offset:976
    ds_read_b128 v[120:123], v6 offset:992
    ds_read_b128 v[124:127], v6 offset:1008
    ds_read_b128 v[128:131], v6 offset:1024
    s_waitcnt lgkmcnt(10)
    v_pk_fma_f32 v[32:33], v[132:133], v[82:83], v[32:33] op_sel:[0,0,0] op_sel_hi:[1,0,1]
    v_pk_fma_f32 v[34:35], v[134:135], v[82:83], v[34:35] op_sel:[0,0,0] op_sel_hi:[1,0,1]
    v_pk_fma_f32 v[36:37], v[136:137], v[82:83], v[36:37] op_sel:[0,0,0] op_sel_hi:[1,0,1]
    v_pk_fma_f32 v[38:39], v[138:139], v[82:83], v[38:39] op_sel:[0,0,0] op_sel_hi:[1,0,1]
    v_pk_fma_f32 v[40:41], v[140:141], v[82:83], v[40:41] op_sel:[0,0,0] op_sel_hi:[1,0,1]
    v_pk_fma_f32 v[42:43], v[142:143], v[82:83], v[42:43] op_sel:[0,0,0] op_sel_hi:[1,0,1]
    v_pk_fma_f32 v[44:45], v[144:145], v[82:83], v[44:45] op_sel:[0,0,0] op_sel_hi:[1,0,1]
    v_pk_fma_f32 v[46:47], v[146:147], v[82:83], v[46:47] op_sel:[0,0,0] op_sel_hi:[1,0,1]
    v_pk_fma_f32 v[48:49], v[148:149], v[82:83], v[48:49] op_sel:[0,0,0] op_sel_hi:[1,0,1]
    v_pk_fma_f32 v[50:51], v[150:151], v[82:83], v[50:51] op_sel:[0,0,0] op_sel_hi:[1,0,1]
    ds_read_b128 v[132:135], v6 offset:1040
    ds_read_b128 v[136:139], v6 offset:1056
    ds_read_b128 v[140:143], v6 offset:1072
    ds_read_b128 v[144:147], v6 offset:1088
    ds_read_b128 v[148:151], v6 offset:1104
    s_waitcnt lgkmcnt(10)
    v_pk_fma_f32 v[32:33], v[152:153], v[82:83], v[32:33] op_sel:[0,1,0] op_sel_hi:[1,1,1]
    v_pk_fma_f32 v[34:35], v[154:155], v[82:83], v[34:35] op_sel:[0,1,0] op_sel_hi:[1,1,1]
    v_pk_fma_f32 v[36:37], v[156:157], v[82:83], v[36:37] op_sel:[0,1,0] op_sel_hi:[1,1,1]
    v_pk_fma_f32 v[38:39], v[158:159], v[82:83], v[38:39] op_sel:[0,1,0] op_sel_hi:[1,1,1]
    v_pk_fma_f32 v[40:41], v[160:161], v[82:83], v[40:41] op_sel:[0,1,0] op_sel_hi:[1,1,1]
    v_pk_fma_f32 v[42:43], v[162:163], v[82:83], v[42:43] op_sel:[0,1,0] op_sel_hi:[1,1,1]
    v_pk_fma_f32 v[44:45], v[164:165], v[82:83], v[44:45] op_sel:[0,1,0] op_sel_hi:[1,1,1]
    v_pk_fma_f32 v[46:47], v[166:167], v[82:83], v[46:47] op_sel:[0,1,0] op_sel_hi:[1,1,1]
    v_pk_fma_f32 v[48:49], v[168:169], v[82:83], v[48:49] op_sel:[0,1,0] op_sel_hi:[1,1,1]
    v_pk_fma_f32 v[50:51], v[170:171], v[82:83], v[50:51] op_sel:[0,1,0] op_sel_hi:[1,1,1]
    ds_read_b128 v[152:155], v6 offset:1120
    ds_read_b128 v[156:159], v6 offset:1136
    ds_read_b128 v[160:163], v6 offset:1152
    ds_read_b128 v[164:167], v6 offset:1168
    ds_read_b128 v[168:171], v6 offset:1184
    s_waitcnt lgkmcnt(10)
    v_pk_fma_f32 v[32:33], v[112:113], v[84:85], v[32:33] op_sel:[0,0,0] op_sel_hi:[1,0,1]
    v_pk_fma_f32 v[34:35], v[114:115], v[84:85], v[34:35] op_sel:[0,0,0] op_sel_hi:[1,0,1]
    v_pk_fma_f32 v[36:37], v[116:117], v[84:85], v[36:37] op_sel:[0,0,0] op_sel_hi:[1,0,1]
    v_pk_fma_f32 v[38:39], v[118:119], v[84:85], v[38:39] op_sel:[0,0,0] op_sel_hi:[1,0,1]
    v_pk_fma_f32 v[40:41], v[120:121], v[84:85], v[40:41] op_sel:[0,0,0] op_sel_hi:[1,0,1]
    v_pk_fma_f32 v[42:43], v[122:123], v[84:85], v[42:43] op_sel:[0,0,0] op_sel_hi:[1,0,1]
    v_pk_fma_f32 v[44:45], v[124:125], v[84:85], v[44:45] op_sel:[0,0,0] op_sel_hi:[1,0,1]
    v_pk_fma_f32 v[46:47], v[126:127], v[84:85], v[46:47] op_sel:[0,0,0] op_sel_hi:[1,0,1]
    v_pk_fma_f32 v[48:49], v[128:129], v[84:85], v[48:49] op_sel:[0,0,0] op_sel_hi:[1,0,1]
    v_pk_fma_f32 v[50:51], v[130:131], v[84:85], v[50:51] op_sel:[0,0,0] op_sel_hi:[1,0,1]
    ds_read_b128 v[112:115], v6 offset:1200
    ds_read_b128 v[116:119], v6 offset:1216
    ds_read_b128 v[120:123], v6 offset:1232
    ds_read_b128 v[124:127], v6 offset:1248
    ds_read_b128 v[128:131], v6 offset:1264
    s_waitcnt lgkmcnt(10)
    v_pk_fma_f32 v[32:33], v[132:133], v[84:85], v[32:33] op_sel:[0,1,0] op_sel_hi:[1,1,1]
    v_pk_fma_f32 v[34:35], v[134:135], v[84:85], v[34:35] op_sel:[0,1,0] op_sel_hi:[1,1,1]
    v_pk_fma_f32 v[36:37], v[136:137], v[84:85], v[36:37] op_sel:[0,1,0] op_sel_hi:[1,1,1]
    v_pk_fma_f32 v[38:39], v[138:139], v[84:85], v[38:39] op_sel:[0,1,0] op_sel_hi:[1,1,1]
    v_pk_fma_f32 v[40:41], v[140:141], v[84:85], v[40:41] op_sel:[0,1,0] op_sel_hi:[1,1,1]
    v_pk_fma_f32 v[42:43], v[142:143], v[84:85], v[42:43] op_sel:[0,1,0] op_sel_hi:[1,1,1]
    v_pk_fma_f32 v[44:45], v[144:145], v[84:85], v[44:45] op_sel:[0,1,0] op_sel_hi:[1,1,1]
    v_pk_fma_f32 v[46:47], v[146:147], v[84:85], v[46:47] op_sel:[0,1,0] op_sel_hi:[1,1,1]
    v_pk_fma_f32 v[48:49], v[148:149], v[84:85], v[48:49] op_sel:[0,1,0] op_sel_hi:[1,1,1]
    v_pk_fma_f32 v[50:51], v[150:151], v[84:85], v[50:51] op_sel:[0,1,0] op_sel_hi:[1,1,1]
    ds_read_b128 v[132:135], v6 offset:1280
    ds_read_b128 v[136:139], v6 offset:1296
    ds_read_b128 v[140:143], v6 offset:1312
    ds_read_b128 v[144:147], v6 offset:1328
    ds_read_b128 v[148:151], v6 offset:1344
    s_waitcnt lgkmcnt(10)
    v_pk_fma_f32 v[32:33], v[152:153], v[86:87], v[32:33] op_sel:[0,0,0] op_sel_hi:[1,0,1]
    v_pk_fma_f32 v[34:35], v[154:155], v[86:87], v[34:35] op_sel:[0,0,0] op_sel_hi:[1,0,1]
    v_pk_fma_f32 v[36:37], v[156:157], v[86:87], v[36:37] op_sel:[0,0,0] op_sel_hi:[1,0,1]
    v_pk_fma_f32 v[38:39], v[158:159], v[86:87], v[38:39] op_sel:[0,0,0] op_sel_hi:[1,0,1]
    v_pk_fma_f32 v[40:41], v[160:161], v[86:87], v[40:41] op_sel:[0,0,0] op_sel_hi:[1,0,1]
    v_pk_fma_f32 v[42:43], v[162:163], v[86:87], v[42:43] op_sel:[0,0,0] op_sel_hi:[1,0,1]
    v_pk_fma_f32 v[44:45], v[164:165], v[86:87], v[44:45] op_sel:[0,0,0] op_sel_hi:[1,0,1]
    v_pk_fma_f32 v[46:47], v[166:167], v[86:87], v[46:47] op_sel:[0,0,0] op_sel_hi:[1,0,1]
    v_pk_fma_f32 v[48:49], v[168:169], v[86:87], v[48:49] op_sel:[0,0,0] op_sel_hi:[1,0,1]
    v_pk_fma_f32 v[50:51], v[170:171], v[86:87], v[50:51] op_sel:[0,0,0] op_sel_hi:[1,0,1]
    ds_read_b128 v[152:155], v6 offset:1360
    ds_read_b128 v[156:159], v6 offset:1376
    ds_read_b128 v[160:163], v6 offset:1392
    ds_read_b128 v[164:167], v6 offset:1408
    ds_read_b128 v[168:171], v6 offset:1424
    s_waitcnt lgkmcnt(10)
    v_pk_fma_f32 v[32:33], v[112:113], v[86:87], v[32:33] op_sel:[0,1,0] op_sel_hi:[1,1,1]
    v_pk_fma_f32 v[34:35], v[114:115], v[86:87], v[34:35] op_sel:[0,1,0] op_sel_hi:[1,1,1]
    v_pk_fma_f32 v[36:37], v[116:117], v[86:87], v[36:37] op_sel:[0,1,0] op_sel_hi:[1,1,1]
    v_pk_fma_f32 v[38:39], v[118:119], v[86:87], v[38:39] op_sel:[0,1,0] op_sel_hi:[1,1,1]
    v_pk_fma_f32 v[40:41], v[120:121], v[86:87], v[40:41] op_sel:[0,1,0] op_sel_hi:[1,1,1]
    v_pk_fma_f32 v[42:43], v[122:123], v[86:87], v[42:43] op_sel:[0,1,0] op_sel_hi:[1,1,1]
    v_pk_fma_f32 v[44:45], v[124:125], v[86:87], v[44:45] op_sel:[0,1,0] op_sel_hi:[1,1,1]
    v_pk_fma_f32 v[46:47], v[126:127], v[86:87], v[46:47] op_sel:[0,1,0] op_sel_hi:[1,1,1]
    v_pk_fma_f32 v[48:49], v[128:129], v[86:87], v[48:49] op_sel:[0,1,0] op_sel_hi:[1,1,1]
    v_pk_fma_f32 v[50:51], v[130:131], v[86:87], v[50:51] op_sel:[0,1,0] op_sel_hi:[1,1,1]
    ds_read_b128 v[112:115], v6 offset:1440
    ds_read_b128 v[116:119], v6 offset:1456
    ds_read_b128 v[120:123], v6 offset:1472
    ds_read_b128 v[124:127], v6 offset:1488
    ds_read_b128 v[128:131], v6 offset:1504
    s_waitcnt lgkmcnt(10)
    v_pk_fma_f32 v[32:33], v[132:133], v[88:89], v[32:33] op_sel:[0,0,0] op_sel_hi:[1,0,1]
    v_pk_fma_f32 v[34:35], v[134:135], v[88:89], v[34:35] op_sel:[0,0,0] op_sel_hi:[1,0,1]
    v_pk_fma_f32 v[36:37], v[136:137], v[88:89], v[36:37] op_sel:[0,0,0] op_sel_hi:[1,0,1]
    v_pk_fma_f32 v[38:39], v[138:139], v[88:89], v[38:39] op_sel:[0,0,0] op_sel_hi:[1,0,1]
    v_pk_fma_f32 v[40:41], v[140:141], v[88:89], v[40:41] op_sel:[0,0,0] op_sel_hi:[1,0,1]
    v_pk_fma_f32 v[42:43], v[142:143], v[88:89], v[42:43] op_sel:[0,0,0] op_sel_hi:[1,0,1]
    v_pk_fma_f32 v[44:45], v[144:145], v[88:89], v[44:45] op_sel:[0,0,0] op_sel_hi:[1,0,1]
    v_pk_fma_f32 v[46:47], v[146:147], v[88:89], v[46:47] op_sel:[0,0,0] op_sel_hi:[1,0,1]
    v_pk_fma_f32 v[48:49], v[148:149], v[88:89], v[48:49] op_sel:[0,0,0] op_sel_hi:[1,0,1]
    v_pk_fma_f32 v[50:51], v[150:151], v[88:89], v[50:51] op_sel:[0,0,0] op_sel_hi:[1,0,1]
    ds_read_b128 v[132:135], v6 offset:1520
    ds_read_b128 v[136:139], v6 offset:1536
    ds_read_b128 v[140:143], v6 offset:1552
    ds_read_b128 v[144:147], v6 offset:1568
    ds_read_b128 v[148:151], v6 offset:1584
    s_waitcnt lgkmcnt(10)
    v_pk_fma_f32 v[32:33], v[152:153], v[88:89], v[32:33] op_sel:[0,1,0] op_sel_hi:[1,1,1]
    v_pk_fma_f32 v[34:35], v[154:155], v[88:89], v[34:35] op_sel:[0,1,0] op_sel_hi:[1,1,1]
    v_pk_fma_f32 v[36:37], v[156:157], v[88:89], v[36:37] op_sel:[0,1,0] op_sel_hi:[1,1,1]
    v_pk_fma_f32 v[38:39], v[158:159], v[88:89], v[38:39] op_sel:[0,1,0] op_sel_hi:[1,1,1]
    v_pk_fma_f32 v[40:41], v[160:161], v[88:89], v[40:41] op_sel:[0,1,0] op_sel_hi:[1,1,1]
    v_pk_fma_f32 v[42:43], v[162:163], v[88:89], v[42:43] op_sel:[0,1,0] op_sel_hi:[1,1,1]
    v_pk_fma_f32 v[44:45], v[164:165], v[88:89], v[44:45] op_sel:[0,1,0] op_sel_hi:[1,1,1]
    v_pk_fma_f32 v[46:47], v[166:167], v[88:89], v[46:47] op_sel:[0,1,0] op_sel_hi:[1,1,1]
    v_pk_fma_f32 v[48:49], v[168:169], v[88:89], v[48:49] op_sel:[0,1,0] op_sel_hi:[1,1,1]
    v_pk_fma_f32 v[50:51], v[170:171], v[88:89], v[50:51] op_sel:[0,1,0] op_sel_hi:[1,1,1]
    ds_read_b128 v[152:155], v6 offset:1600
    ds_read_b128 v[156:159], v6 offset:1616
    ds_read_b128 v[160:163], v6 offset:1632
    ds_read_b128 v[164:167], v6 offset:1648
    ds_read_b128 v[168:171], v6 offset:1664
    s_waitcnt lgkmcnt(10)
    v_pk_fma_f32 v[32:33], v[112:113], v[92:93], v[32:33] op_sel:[0,0,0] op_sel_hi:[1,0,1]
    v_pk_fma_f32 v[34:35], v[114:115], v[92:93], v[34:35] op_sel:[0,0,0] op_sel_hi:[1,0,1]
    v_pk_fma_f32 v[36:37], v[116:117], v[92:93], v[36:37] op_sel:[0,0,0] op_sel_hi:[1,0,1]
    v_pk_fma_f32 v[38:39], v[118:119], v[92:93], v[38:39] op_sel:[0,0,0] op_sel_hi:[1,0,1]
    v_pk_fma_f32 v[40:41], v[120:121], v[92:93], v[40:41] op_sel:[0,0,0] op_sel_hi:[1,0,1]
    v_pk_fma_f32 v[42:43], v[122:123], v[92:93], v[42:43] op_sel:[0,0,0] op_sel_hi:[1,0,1]
    v_pk_fma_f32 v[44:45], v[124:125], v[92:93], v[44:45] op_sel:[0,0,0] op_sel_hi:[1,0,1]
    v_pk_fma_f32 v[46:47], v[126:127], v[92:93], v[46:47] op_sel:[0,0,0] op_sel_hi:[1,0,1]
    v_pk_fma_f32 v[48:49], v[128:129], v[92:93], v[48:49] op_sel:[0,0,0] op_sel_hi:[1,0,1]
    v_pk_fma_f32 v[50:51], v[130:131], v[92:93], v[50:51] op_sel:[0,0,0] op_sel_hi:[1,0,1]
    ds_read_b128 v[112:115], v6 offset:1680
    ds_read_b128 v[116:119], v6 offset:1696
    ds_read_b128 v[120:123], v6 offset:1712
    ds_read_b128 v[124:127], v6 offset:1728
    ds_read_b128 v[128:131], v6 offset:1744
    s_waitcnt lgkmcnt(10)
    v_pk_fma_f32 v[32:33], v[132:133], v[92:93], v[32:33] op_sel:[0,1,0] op_sel_hi:[1,1,1]
    v_pk_fma_f32 v[34:35], v[134:135], v[92:93], v[34:35] op_sel:[0,1,0] op_sel_hi:[1,1,1]
    v_pk_fma_f32 v[36:37], v[136:137], v[92:93], v[36:37] op_sel:[0,1,0] op_sel_hi:[1,1,1]
    v_pk_fma_f32 v[38:39], v[138:139], v[92:93], v[38:39] op_sel:[0,1,0] op_sel_hi:[1,1,1]
    v_pk_fma_f32 v[40:41], v[140:141], v[92:93], v[40:41] op_sel:[0,1,0] op_sel_hi:[1,1,1]
    v_pk_fma_f32 v[42:43], v[142:143], v[92:93], v[42:43] op_sel:[0,1,0] op_sel_hi:[1,1,1]
    v_pk_fma_f32 v[44:45], v[144:145], v[92:93], v[44:45] op_sel:[0,1,0] op_sel_hi:[1,1,1]
    v_pk_fma_f32 v[46:47], v[146:147], v[92:93], v[46:47] op_sel:[0,1,0] op_sel_hi:[1,1,1]
    v_pk_fma_f32 v[48:49], v[148:149], v[92:93], v[48:49] op_sel:[0,1,0] op_sel_hi:[1,1,1]
    v_pk_fma_f32 v[50:51], v[150:151], v[92:93], v[50:51] op_sel:[0,1,0] op_sel_hi:[1,1,1]
    ds_read_b128 v[132:135], v6 offset:1760
    ds_read_b128 v[136:139], v6 offset:1776
    ds_read_b128 v[140:143], v6 offset:1792
    ds_read_b128 v[144:147], v6 offset:1808
    ds_read_b128 v[148:151], v6 offset:1824
    s_waitcnt lgkmcnt(10)
    v_pk_fma_f32 v[32:33], v[152:153], v[94:95], v[32:33] op_sel:[0,0,0] op_sel_hi:[1,0,1]
    v_pk_fma_f32 v[34:35], v[154:155], v[94:95], v[34:35] op_sel:[0,0,0] op_sel_hi:[1,0,1]
    v_pk_fma_f32 v[36:37], v[156:157], v[94:95], v[36:37] op_sel:[0,0,0] op_sel_hi:[1,0,1]
    v_pk_fma_f32 v[38:39], v[158:159], v[94:95], v[38:39] op_sel:[0,0,0] op_sel_hi:[1,0,1]
    v_pk_fma_f32 v[40:41], v[160:161], v[94:95], v[40:41] op_sel:[0,0,0] op_sel_hi:[1,0,1]
    v_pk_fma_f32 v[42:43], v[162:163], v[94:95], v[42:43] op_sel:[0,0,0] op_sel_hi:[1,0,1]
    v_pk_fma_f32 v[44:45], v[164:165], v[94:95], v[44:45] op_sel:[0,0,0] op_sel_hi:[1,0,1]
    v_pk_fma_f32 v[46:47], v[166:167], v[94:95], v[46:47] op_sel:[0,0,0] op_sel_hi:[1,0,1]
    v_pk_fma_f32 v[48:49], v[168:169], v[94:95], v[48:49] op_sel:[0,0,0] op_sel_hi:[1,0,1]
    v_pk_fma_f32 v[50:51], v[170:171], v[94:95], v[50:51] op_sel:[0,0,0] op_sel_hi:[1,0,1]
    ds_read_b128 v[152:155], v6 offset:1840
    ds_read_b128 v[156:159], v6 offset:1856
    ds_read_b128 v[160:163], v6 offset:1872
    ds_read_b128 v[164:167], v6 offset:1888
    ds_read_b128 v[168:171], v6 offset:1904
    s_waitcnt lgkmcnt(10)
    v_pk_fma_f32 v[32:33], v[112:113], v[94:95], v[32:33] op_sel:[0,1,0] op_sel_hi:[1,1,1]
    v_pk_fma_f32 v[34:35], v[114:115], v[94:95], v[34:35] op_sel:[0,1,0] op_sel_hi:[1,1,1]
    v_pk_fma_f32 v[36:37], v[116:117], v[94:95], v[36:37] op_sel:[0,1,0] op_sel_hi:[1,1,1]
    v_pk_fma_f32 v[38:39], v[118:119], v[94:95], v[38:39] op_sel:[0,1,0] op_sel_hi:[1,1,1]
    v_pk_fma_f32 v[40:41], v[120:121], v[94:95], v[40:41] op_sel:[0,1,0] op_sel_hi:[1,1,1]
    v_pk_fma_f32 v[42:43], v[122:123], v[94:95], v[42:43] op_sel:[0,1,0] op_sel_hi:[1,1,1]
    v_pk_fma_f32 v[44:45], v[124:125], v[94:95], v[44:45] op_sel:[0,1,0] op_sel_hi:[1,1,1]
    v_pk_fma_f32 v[46:47], v[126:127], v[94:95], v[46:47] op_sel:[0,1,0] op_sel_hi:[1,1,1]
    v_pk_fma_f32 v[48:49], v[128:129], v[94:95], v[48:49] op_sel:[0,1,0] op_sel_hi:[1,1,1]
    v_pk_fma_f32 v[50:51], v[130:131], v[94:95], v[50:51] op_sel:[0,1,0] op_sel_hi:[1,1,1]
    ds_read_b128 v[112:115], v6 offset:1920
    ds_read_b128 v[116:119], v6 offset:1936
    ds_read_b128 v[120:123], v6 offset:1952
    ds_read_b128 v[124:127], v6 offset:1968
    ds_read_b128 v[128:131], v6 offset:1984
    s_waitcnt lgkmcnt(10)
    v_pk_fma_f32 v[32:33], v[132:133], v[96:97], v[32:33] op_sel:[0,0,0] op_sel_hi:[1,0,1]
    v_pk_fma_f32 v[34:35], v[134:135], v[96:97], v[34:35] op_sel:[0,0,0] op_sel_hi:[1,0,1]
    v_pk_fma_f32 v[36:37], v[136:137], v[96:97], v[36:37] op_sel:[0,0,0] op_sel_hi:[1,0,1]
    v_pk_fma_f32 v[38:39], v[138:139], v[96:97], v[38:39] op_sel:[0,0,0] op_sel_hi:[1,0,1]
    v_pk_fma_f32 v[40:41], v[140:141], v[96:97], v[40:41] op_sel:[0,0,0] op_sel_hi:[1,0,1]
    v_pk_fma_f32 v[42:43], v[142:143], v[96:97], v[42:43] op_sel:[0,0,0] op_sel_hi:[1,0,1]
    v_pk_fma_f32 v[44:45], v[144:145], v[96:97], v[44:45] op_sel:[0,0,0] op_sel_hi:[1,0,1]
    v_pk_fma_f32 v[46:47], v[146:147], v[96:97], v[46:47] op_sel:[0,0,0] op_sel_hi:[1,0,1]
    v_pk_fma_f32 v[48:49], v[148:149], v[96:97], v[48:49] op_sel:[0,0,0] op_sel_hi:[1,0,1]
    v_pk_fma_f32 v[50:51], v[150:151], v[96:97], v[50:51] op_sel:[0,0,0] op_sel_hi:[1,0,1]
    ds_read_b128 v[132:135], v6 offset:2000
    ds_read_b128 v[136:139], v6 offset:2016
    ds_read_b128 v[140:143], v6 offset:2032
    ds_read_b128 v[144:147], v6 offset:2048
    ds_read_b128 v[148:151], v6 offset:2064
    s_waitcnt lgkmcnt(10)
    v_pk_fma_f32 v[32:33], v[152:153], v[96:97], v[32:33] op_sel:[0,1,0] op_sel_hi:[1,1,1]
    v_pk_fma_f32 v[34:35], v[154:155], v[96:97], v[34:35] op_sel:[0,1,0] op_sel_hi:[1,1,1]
    v_pk_fma_f32 v[36:37], v[156:157], v[96:97], v[36:37] op_sel:[0,1,0] op_sel_hi:[1,1,1]
    v_pk_fma_f32 v[38:39], v[158:159], v[96:97], v[38:39] op_sel:[0,1,0] op_sel_hi:[1,1,1]
    v_pk_fma_f32 v[40:41], v[160:161], v[96:97], v[40:41] op_sel:[0,1,0] op_sel_hi:[1,1,1]
    v_pk_fma_f32 v[42:43], v[162:163], v[96:97], v[42:43] op_sel:[0,1,0] op_sel_hi:[1,1,1]
    v_pk_fma_f32 v[44:45], v[164:165], v[96:97], v[44:45] op_sel:[0,1,0] op_sel_hi:[1,1,1]
    v_pk_fma_f32 v[46:47], v[166:167], v[96:97], v[46:47] op_sel:[0,1,0] op_sel_hi:[1,1,1]
    v_pk_fma_f32 v[48:49], v[168:169], v[96:97], v[48:49] op_sel:[0,1,0] op_sel_hi:[1,1,1]
    v_pk_fma_f32 v[50:51], v[170:171], v[96:97], v[50:51] op_sel:[0,1,0] op_sel_hi:[1,1,1]
    ds_read_b128 v[152:155], v6 offset:2080
    ds_read_b128 v[156:159], v6 offset:2096
    ds_read_b128 v[160:163], v6 offset:2112
    ds_read_b128 v[164:167], v6 offset:2128
    ds_read_b128 v[168:171], v6 offset:2144
    s_waitcnt lgkmcnt(10)
    v_pk_fma_f32 v[32:33], v[112:113], v[98:99], v[32:33] op_sel:[0,0,0] op_sel_hi:[1,0,1]
    v_pk_fma_f32 v[34:35], v[114:115], v[98:99], v[34:35] op_sel:[0,0,0] op_sel_hi:[1,0,1]
    v_pk_fma_f32 v[36:37], v[116:117], v[98:99], v[36:37] op_sel:[0,0,0] op_sel_hi:[1,0,1]
    v_pk_fma_f32 v[38:39], v[118:119], v[98:99], v[38:39] op_sel:[0,0,0] op_sel_hi:[1,0,1]
    v_pk_fma_f32 v[40:41], v[120:121], v[98:99], v[40:41] op_sel:[0,0,0] op_sel_hi:[1,0,1]
    v_pk_fma_f32 v[42:43], v[122:123], v[98:99], v[42:43] op_sel:[0,0,0] op_sel_hi:[1,0,1]
    v_pk_fma_f32 v[44:45], v[124:125], v[98:99], v[44:45] op_sel:[0,0,0] op_sel_hi:[1,0,1]
    v_pk_fma_f32 v[46:47], v[126:127], v[98:99], v[46:47] op_sel:[0,0,0] op_sel_hi:[1,0,1]
    v_pk_fma_f32 v[48:49], v[128:129], v[98:99], v[48:49] op_sel:[0,0,0] op_sel_hi:[1,0,1]
    v_pk_fma_f32 v[50:51], v[130:131], v[98:99], v[50:51] op_sel:[0,0,0] op_sel_hi:[1,0,1]
    ds_read_b128 v[112:115], v6 offset:2160
    ds_read_b128 v[116:119], v6 offset:2176
    ds_read_b128 v[120:123], v6 offset:2192
    ds_read_b128 v[124:127], v6 offset:2208
    ds_read_b128 v[128:131], v6 offset:2224
    s_waitcnt lgkmcnt(10)
    v_pk_fma_f32 v[32:33], v[132:133], v[98:99], v[32:33] op_sel:[0,1,0] op_sel_hi:[1,1,1]
    v_pk_fma_f32 v[34:35], v[134:135], v[98:99], v[34:35] op_sel:[0,1,0] op_sel_hi:[1,1,1]
    v_pk_fma_f32 v[36:37], v[136:137], v[98:99], v[36:37] op_sel:[0,1,0] op_sel_hi:[1,1,1]
    v_pk_fma_f32 v[38:39], v[138:139], v[98:99], v[38:39] op_sel:[0,1,0] op_sel_hi:[1,1,1]
    v_pk_fma_f32 v[40:41], v[140:141], v[98:99], v[40:41] op_sel:[0,1,0] op_sel_hi:[1,1,1]
    v_pk_fma_f32 v[42:43], v[142:143], v[98:99], v[42:43] op_sel:[0,1,0] op_sel_hi:[1,1,1]
    v_pk_fma_f32 v[44:45], v[144:145], v[98:99], v[44:45] op_sel:[0,1,0] op_sel_hi:[1,1,1]
    v_pk_fma_f32 v[46:47], v[146:147], v[98:99], v[46:47] op_sel:[0,1,0] op_sel_hi:[1,1,1]
    v_pk_fma_f32 v[48:49], v[148:149], v[98:99], v[48:49] op_sel:[0,1,0] op_sel_hi:[1,1,1]
    v_pk_fma_f32 v[50:51], v[150:151], v[98:99], v[50:51] op_sel:[0,1,0] op_sel_hi:[1,1,1]
    ds_read_b128 v[132:135], v6 offset:2240
    ds_read_b128 v[136:139], v6 offset:2256
    ds_read_b128 v[140:143], v6 offset:2272
    ds_read_b128 v[144:147], v6 offset:2288
    ds_read_b128 v[148:151], v6 offset:2304
    s_waitcnt lgkmcnt(10)
    v_pk_fma_f32 v[32:33], v[152:153], v[100:101], v[32:33] op_sel:[0,0,0] op_sel_hi:[1,0,1]
    v_pk_fma_f32 v[34:35], v[154:155], v[100:101], v[34:35] op_sel:[0,0,0] op_sel_hi:[1,0,1]
    v_pk_fma_f32 v[36:37], v[156:157], v[100:101], v[36:37] op_sel:[0,0,0] op_sel_hi:[1,0,1]
    v_pk_fma_f32 v[38:39], v[158:159], v[100:101], v[38:39] op_sel:[0,0,0] op_sel_hi:[1,0,1]
    v_pk_fma_f32 v[40:41], v[160:161], v[100:101], v[40:41] op_sel:[0,0,0] op_sel_hi:[1,0,1]
    v_pk_fma_f32 v[42:43], v[162:163], v[100:101], v[42:43] op_sel:[0,0,0] op_sel_hi:[1,0,1]
    v_pk_fma_f32 v[44:45], v[164:165], v[100:101], v[44:45] op_sel:[0,0,0] op_sel_hi:[1,0,1]
    v_pk_fma_f32 v[46:47], v[166:167], v[100:101], v[46:47] op_sel:[0,0,0] op_sel_hi:[1,0,1]
    v_pk_fma_f32 v[48:49], v[168:169], v[100:101], v[48:49] op_sel:[0,0,0] op_sel_hi:[1,0,1]
    v_pk_fma_f32 v[50:51], v[170:171], v[100:101], v[50:51] op_sel:[0,0,0] op_sel_hi:[1,0,1]
    ds_read_b128 v[152:155], v6 offset:2320
    ds_read_b128 v[156:159], v6 offset:2336
    ds_read_b128 v[160:163], v6 offset:2352
    ds_read_b128 v[164:167], v6 offset:2368
    ds_read_b128 v[168:171], v6 offset:2384
    s_waitcnt lgkmcnt(10)
    v_pk_fma_f32 v[32:33], v[112:113], v[100:101], v[32:33] op_sel:[0,1,0] op_sel_hi:[1,1,1]
    v_pk_fma_f32 v[34:35], v[114:115], v[100:101], v[34:35] op_sel:[0,1,0] op_sel_hi:[1,1,1]
    v_pk_fma_f32 v[36:37], v[116:117], v[100:101], v[36:37] op_sel:[0,1,0] op_sel_hi:[1,1,1]
    v_pk_fma_f32 v[38:39], v[118:119], v[100:101], v[38:39] op_sel:[0,1,0] op_sel_hi:[1,1,1]
    v_pk_fma_f32 v[40:41], v[120:121], v[100:101], v[40:41] op_sel:[0,1,0] op_sel_hi:[1,1,1]
    v_pk_fma_f32 v[42:43], v[122:123], v[100:101], v[42:43] op_sel:[0,1,0] op_sel_hi:[1,1,1]
    v_pk_fma_f32 v[44:45], v[124:125], v[100:101], v[44:45] op_sel:[0,1,0] op_sel_hi:[1,1,1]
    v_pk_fma_f32 v[46:47], v[126:127], v[100:101], v[46:47] op_sel:[0,1,0] op_sel_hi:[1,1,1]
    v_pk_fma_f32 v[48:49], v[128:129], v[100:101], v[48:49] op_sel:[0,1,0] op_sel_hi:[1,1,1]
    v_pk_fma_f32 v[50:51], v[130:131], v[100:101], v[50:51] op_sel:[0,1,0] op_sel_hi:[1,1,1]
    ds_read_b128 v[112:115], v6 offset:2400
    ds_read_b128 v[116:119], v6 offset:2416
    ds_read_b128 v[120:123], v6 offset:2432
    ds_read_b128 v[124:127], v6 offset:2448
    ds_read_b128 v[128:131], v6 offset:2464
    s_waitcnt lgkmcnt(10)
    v_pk_fma_f32 v[32:33], v[132:133], v[102:103], v[32:33] op_sel:[0,0,0] op_sel_hi:[1,0,1]
    v_pk_fma_f32 v[34:35], v[134:135], v[102:103], v[34:35] op_sel:[0,0,0] op_sel_hi:[1,0,1]
    v_pk_fma_f32 v[36:37], v[136:137], v[102:103], v[36:37] op_sel:[0,0,0] op_sel_hi:[1,0,1]
    v_pk_fma_f32 v[38:39], v[138:139], v[102:103], v[38:39] op_sel:[0,0,0] op_sel_hi:[1,0,1]
    v_pk_fma_f32 v[40:41], v[140:141], v[102:103], v[40:41] op_sel:[0,0,0] op_sel_hi:[1,0,1]
    v_pk_fma_f32 v[42:43], v[142:143], v[102:103], v[42:43] op_sel:[0,0,0] op_sel_hi:[1,0,1]
    v_pk_fma_f32 v[44:45], v[144:145], v[102:103], v[44:45] op_sel:[0,0,0] op_sel_hi:[1,0,1]
    v_pk_fma_f32 v[46:47], v[146:147], v[102:103], v[46:47] op_sel:[0,0,0] op_sel_hi:[1,0,1]
    v_pk_fma_f32 v[48:49], v[148:149], v[102:103], v[48:49] op_sel:[0,0,0] op_sel_hi:[1,0,1]
    v_pk_fma_f32 v[50:51], v[150:151], v[102:103], v[50:51] op_sel:[0,0,0] op_sel_hi:[1,0,1]
    ds_read_b128 v[132:135], v6 offset:2480
    ds_read_b128 v[136:139], v6 offset:2496
    ds_read_b128 v[140:143], v6 offset:2512
    ds_read_b128 v[144:147], v6 offset:2528
    ds_read_b128 v[148:151], v6 offset:2544
    s_waitcnt lgkmcnt(10)
    v_pk_fma_f32 v[32:33], v[152:153], v[102:103], v[32:33] op_sel:[0,1,0] op_sel_hi:[1,1,1]
    v_pk_fma_f32 v[34:35], v[154:155], v[102:103], v[34:35] op_sel:[0,1,0] op_sel_hi:[1,1,1]
    v_pk_fma_f32 v[36:37], v[156:157], v[102:103], v[36:37] op_sel:[0,1,0] op_sel_hi:[1,1,1]
    v_pk_fma_f32 v[38:39], v[158:159], v[102:103], v[38:39] op_sel:[0,1,0] op_sel_hi:[1,1,1]
    v_pk_fma_f32 v[40:41], v[160:161], v[102:103], v[40:41] op_sel:[0,1,0] op_sel_hi:[1,1,1]
    v_pk_fma_f32 v[42:43], v[162:163], v[102:103], v[42:43] op_sel:[0,1,0] op_sel_hi:[1,1,1]
    v_pk_fma_f32 v[44:45], v[164:165], v[102:103], v[44:45] op_sel:[0,1,0] op_sel_hi:[1,1,1]
    v_pk_fma_f32 v[46:47], v[166:167], v[102:103], v[46:47] op_sel:[0,1,0] op_sel_hi:[1,1,1]
    v_pk_fma_f32 v[48:49], v[168:169], v[102:103], v[48:49] op_sel:[0,1,0] op_sel_hi:[1,1,1]
    v_pk_fma_f32 v[50:51], v[170:171], v[102:103], v[50:51] op_sel:[0,1,0] op_sel_hi:[1,1,1]
    ds_read_b128 v[152:155], v6 offset:2560
    ds_read_b128 v[156:159], v6 offset:2576
    ds_read_b128 v[160:163], v6 offset:2592
    ds_read_b128 v[164:167], v6 offset:2608
    ds_read_b128 v[168:171], v6 offset:2624
    s_waitcnt lgkmcnt(10)
    v_pk_fma_f32 v[32:33], v[112:113], v[104:105], v[32:33] op_sel:[0,0,0] op_sel_hi:[1,0,1]
    v_pk_fma_f32 v[34:35], v[114:115], v[104:105], v[34:35] op_sel:[0,0,0] op_sel_hi:[1,0,1]
    v_pk_fma_f32 v[36:37], v[116:117], v[104:105], v[36:37] op_sel:[0,0,0] op_sel_hi:[1,0,1]
    v_pk_fma_f32 v[38:39], v[118:119], v[104:105], v[38:39] op_sel:[0,0,0] op_sel_hi:[1,0,1]
    v_pk_fma_f32 v[40:41], v[120:121], v[104:105], v[40:41] op_sel:[0,0,0] op_sel_hi:[1,0,1]
    v_pk_fma_f32 v[42:43], v[122:123], v[104:105], v[42:43] op_sel:[0,0,0] op_sel_hi:[1,0,1]
    v_pk_fma_f32 v[44:45], v[124:125], v[104:105], v[44:45] op_sel:[0,0,0] op_sel_hi:[1,0,1]
    v_pk_fma_f32 v[46:47], v[126:127], v[104:105], v[46:47] op_sel:[0,0,0] op_sel_hi:[1,0,1]
    v_pk_fma_f32 v[48:49], v[128:129], v[104:105], v[48:49] op_sel:[0,0,0] op_sel_hi:[1,0,1]
    v_pk_fma_f32 v[50:51], v[130:131], v[104:105], v[50:51] op_sel:[0,0,0] op_sel_hi:[1,0,1]
    ds_read_b128 v[112:115], v6 offset:2640
    ds_read_b128 v[116:119], v6 offset:2656
    ds_read_b128 v[120:123], v6 offset:2672
    ds_read_b128 v[124:127], v6 offset:2688
    ds_read_b128 v[128:131], v6 offset:2704
    s_waitcnt lgkmcnt(10)
    v_pk_fma_f32 v[32:33], v[132:133], v[104:105], v[32:33] op_sel:[0,1,0] op_sel_hi:[1,1,1]
    v_pk_fma_f32 v[34:35], v[134:135], v[104:105], v[34:35] op_sel:[0,1,0] op_sel_hi:[1,1,1]
    v_pk_fma_f32 v[36:37], v[136:137], v[104:105], v[36:37] op_sel:[0,1,0] op_sel_hi:[1,1,1]
    v_pk_fma_f32 v[38:39], v[138:139], v[104:105], v[38:39] op_sel:[0,1,0] op_sel_hi:[1,1,1]
    v_pk_fma_f32 v[40:41], v[140:141], v[104:105], v[40:41] op_sel:[0,1,0] op_sel_hi:[1,1,1]
    v_pk_fma_f32 v[42:43], v[142:143], v[104:105], v[42:43] op_sel:[0,1,0] op_sel_hi:[1,1,1]
    v_pk_fma_f32 v[44:45], v[144:145], v[104:105], v[44:45] op_sel:[0,1,0] op_sel_hi:[1,1,1]
    v_pk_fma_f32 v[46:47], v[146:147], v[104:105], v[46:47] op_sel:[0,1,0] op_sel_hi:[1,1,1]
    v_pk_fma_f32 v[48:49], v[148:149], v[104:105], v[48:49] op_sel:[0,1,0] op_sel_hi:[1,1,1]
    v_pk_fma_f32 v[50:51], v[150:151], v[104:105], v[50:51] op_sel:[0,1,0] op_sel_hi:[1,1,1]
    ds_read_b128 v[132:135], v6 offset:2720
    ds_read_b128 v[136:139], v6 offset:2736
    ds_read_b128 v[140:143], v6 offset:2752
    ds_read_b128 v[144:147], v6 offset:2768
    ds_read_b128 v[148:151], v6 offset:2784
    s_waitcnt lgkmcnt(10)
    v_pk_fma_f32 v[32:33], v[152:153], v[106:107], v[32:33] op_sel:[0,0,0] op_sel_hi:[1,0,1]
    v_pk_fma_f32 v[34:35], v[154:155], v[106:107], v[34:35] op_sel:[0,0,0] op_sel_hi:[1,0,1]
    v_pk_fma_f32 v[36:37], v[156:157], v[106:107], v[36:37] op_sel:[0,0,0] op_sel_hi:[1,0,1]
    v_pk_fma_f32 v[38:39], v[158:159], v[106:107], v[38:39] op_sel:[0,0,0] op_sel_hi:[1,0,1]
    v_pk_fma_f32 v[40:41], v[160:161], v[106:107], v[40:41] op_sel:[0,0,0] op_sel_hi:[1,0,1]
    v_pk_fma_f32 v[42:43], v[162:163], v[106:107], v[42:43] op_sel:[0,0,0] op_sel_hi:[1,0,1]
    v_pk_fma_f32 v[44:45], v[164:165], v[106:107], v[44:45] op_sel:[0,0,0] op_sel_hi:[1,0,1]
    v_pk_fma_f32 v[46:47], v[166:167], v[106:107], v[46:47] op_sel:[0,0,0] op_sel_hi:[1,0,1]
    v_pk_fma_f32 v[48:49], v[168:169], v[106:107], v[48:49] op_sel:[0,0,0] op_sel_hi:[1,0,1]
    v_pk_fma_f32 v[50:51], v[170:171], v[106:107], v[50:51] op_sel:[0,0,0] op_sel_hi:[1,0,1]
    ds_read_b128 v[152:155], v6 offset:2800
    ds_read_b128 v[156:159], v6 offset:2816
    ds_read_b128 v[160:163], v6 offset:2832
    ds_read_b128 v[164:167], v6 offset:2848
    ds_read_b128 v[168:171], v6 offset:2864
    s_waitcnt lgkmcnt(10)
    v_pk_fma_f32 v[32:33], v[112:113], v[106:107], v[32:33] op_sel:[0,1,0] op_sel_hi:[1,1,1]
    v_pk_fma_f32 v[34:35], v[114:115], v[106:107], v[34:35] op_sel:[0,1,0] op_sel_hi:[1,1,1]
    v_pk_fma_f32 v[36:37], v[116:117], v[106:107], v[36:37] op_sel:[0,1,0] op_sel_hi:[1,1,1]
    v_pk_fma_f32 v[38:39], v[118:119], v[106:107], v[38:39] op_sel:[0,1,0] op_sel_hi:[1,1,1]
    v_pk_fma_f32 v[40:41], v[120:121], v[106:107], v[40:41] op_sel:[0,1,0] op_sel_hi:[1,1,1]
    v_pk_fma_f32 v[42:43], v[122:123], v[106:107], v[42:43] op_sel:[0,1,0] op_sel_hi:[1,1,1]
    v_pk_fma_f32 v[44:45], v[124:125], v[106:107], v[44:45] op_sel:[0,1,0] op_sel_hi:[1,1,1]
    v_pk_fma_f32 v[46:47], v[126:127], v[106:107], v[46:47] op_sel:[0,1,0] op_sel_hi:[1,1,1]
    v_pk_fma_f32 v[48:49], v[128:129], v[106:107], v[48:49] op_sel:[0,1,0] op_sel_hi:[1,1,1]
    v_pk_fma_f32 v[50:51], v[130:131], v[106:107], v[50:51] op_sel:[0,1,0] op_sel_hi:[1,1,1]
    s_waitcnt lgkmcnt(5)
    v_pk_fma_f32 v[32:33], v[132:133], v[108:109], v[32:33] op_sel:[0,0,0] op_sel_hi:[1,0,1]
    v_pk_fma_f32 v[34:35], v[134:135], v[108:109], v[34:35] op_sel:[0,0,0] op_sel_hi:[1,0,1]
    v_pk_fma_f32 v[36:37], v[136:137], v[108:109], v[36:37] op_sel:[0,0,0] op_sel_hi:[1,0,1]
    v_pk_fma_f32 v[38:39], v[138:139], v[108:109], v[38:39] op_sel:[0,0,0] op_sel_hi:[1,0,1]
    v_pk_fma_f32 v[40:41], v[140:141], v[108:109], v[40:41] op_sel:[0,0,0] op_sel_hi:[1,0,1]
    v_pk_fma_f32 v[42:43], v[142:143], v[108:109], v[42:43] op_sel:[0,0,0] op_sel_hi:[1,0,1]
    v_pk_fma_f32 v[44:45], v[144:145], v[108:109], v[44:45] op_sel:[0,0,0] op_sel_hi:[1,0,1]
    v_pk_fma_f32 v[46:47], v[146:147], v[108:109], v[46:47] op_sel:[0,0,0] op_sel_hi:[1,0,1]
    v_pk_fma_f32 v[48:49], v[148:149], v[108:109], v[48:49] op_sel:[0,0,0] op_sel_hi:[1,0,1]
    v_pk_fma_f32 v[50:51], v[150:151], v[108:109], v[50:51] op_sel:[0,0,0] op_sel_hi:[1,0,1]
    s_waitcnt lgkmcnt(0)
    v_pk_fma_f32 v[32:33], v[152:153], v[108:109], v[32:33] op_sel:[0,1,0] op_sel_hi:[1,1,1]
    v_pk_fma_f32 v[34:35], v[154:155], v[108:109], v[34:35] op_sel:[0,1,0] op_sel_hi:[1,1,1]
    v_pk_fma_f32 v[36:37], v[156:157], v[108:109], v[36:37] op_sel:[0,1,0] op_sel_hi:[1,1,1]
    v_pk_fma_f32 v[38:39], v[158:159], v[108:109], v[38:39] op_sel:[0,1,0] op_sel_hi:[1,1,1]
    v_pk_fma_f32 v[40:41], v[160:161], v[108:109], v[40:41] op_sel:[0,1,0] op_sel_hi:[1,1,1]
    v_pk_fma_f32 v[42:43], v[162:163], v[108:109], v[42:43] op_sel:[0,1,0] op_sel_hi:[1,1,1]
    v_pk_fma_f32 v[44:45], v[164:165], v[108:109], v[44:45] op_sel:[0,1,0] op_sel_hi:[1,1,1]
    v_pk_fma_f32 v[46:47], v[166:167], v[108:109], v[46:47] op_sel:[0,1,0] op_sel_hi:[1,1,1]
    v_pk_fma_f32 v[48:49], v[168:169], v[108:109], v[48:49] op_sel:[0,1,0] op_sel_hi:[1,1,1]
    v_pk_fma_f32 v[50:51], v[170:171], v[108:109], v[50:51] op_sel:[0,1,0] op_sel_hi:[1,1,1]
    v_cvt_pk_bf16_f32 v8, v50, v50
    v_lshlrev_b32 v50, 16, v8
    v_add_f32 v50, 0x358637bd, v50
    v_cvt_pk_bf16_f32 v8, v50, v50
    v_lshlrev_b32 v50, 16, v8
    v_rcp_f32 v51, v50
    s_nop 0
    v_cvt_pk_bf16_f32 v8, v32, v33
    v_lshlrev_b32 v32, 16, v8
    v_and_b32 v33, 0xffff0000, v8
    v_mul_f32 v9, v32, v51
    v_mul_f32 v10, v33, v51
    v_fma_f32 v11, -v9, v50, v32
    v_fma_f32 v12, -v10, v50, v33
    v_fma_f32 v9, v11, v51, v9
    v_fma_f32 v10, v12, v51, v10
    v_cvt_pk_bf16_f32 v20, v9, v10
    v_cvt_pk_bf16_f32 v8, v34, v35
    v_lshlrev_b32 v34, 16, v8
    v_and_b32 v35, 0xffff0000, v8
    v_mul_f32 v9, v34, v51
    v_mul_f32 v10, v35, v51
    v_fma_f32 v11, -v9, v50, v34
    v_fma_f32 v12, -v10, v50, v35
    v_fma_f32 v9, v11, v51, v9
    v_fma_f32 v10, v12, v51, v10
    v_cvt_pk_bf16_f32 v21, v9, v10
    v_cvt_pk_bf16_f32 v8, v36, v37
    v_lshlrev_b32 v36, 16, v8
    v_and_b32 v37, 0xffff0000, v8
    v_mul_f32 v9, v36, v51
    v_mul_f32 v10, v37, v51
    v_fma_f32 v11, -v9, v50, v36
    v_fma_f32 v12, -v10, v50, v37
    v_fma_f32 v9, v11, v51, v9
    v_fma_f32 v10, v12, v51, v10
    v_cvt_pk_bf16_f32 v22, v9, v10
    v_cvt_pk_bf16_f32 v8, v38, v39
    v_lshlrev_b32 v38, 16, v8
    v_and_b32 v39, 0xffff0000, v8
    v_mul_f32 v9, v38, v51
    v_mul_f32 v10, v39, v51
    v_fma_f32 v11, -v9, v50, v38
    v_fma_f32 v12, -v10, v50, v39
    v_fma_f32 v9, v11, v51, v9
    v_fma_f32 v10, v12, v51, v10
    v_cvt_pk_bf16_f32 v23, v9, v10
    v_cvt_pk_bf16_f32 v8, v40, v41
    v_lshlrev_b32 v40, 16, v8
    v_and_b32 v41, 0xffff0000, v8
    v_mul_f32 v9, v40, v51
    v_mul_f32 v10, v41, v51
    v_fma_f32 v11, -v9, v50, v40
    v_fma_f32 v12, -v10, v50, v41
    v_fma_f32 v9, v11, v51, v9
    v_fma_f32 v10, v12, v51, v10
    v_cvt_pk_bf16_f32 v24, v9, v10
    v_cvt_pk_bf16_f32 v8, v42, v43
    v_lshlrev_b32 v42, 16, v8
    v_and_b32 v43, 0xffff0000, v8
    v_mul_f32 v9, v42, v51
    v_mul_f32 v10, v43, v51
    v_fma_f32 v11, -v9, v50, v42
    v_fma_f32 v12, -v10, v50, v43
    v_fma_f32 v9, v11, v51, v9
    v_fma_f32 v10, v12, v51, v10
    v_cvt_pk_bf16_f32 v25, v9, v10
    v_cvt_pk_bf16_f32 v8, v44, v45
    v_lshlrev_b32 v44, 16, v8
    v_and_b32 v45, 0xffff0000, v8
    v_mul_f32 v9, v44, v51
    v_mul_f32 v10, v45, v51
    v_fma_f32 v11, -v9, v50, v44
    v_fma_f32 v12, -v10, v50, v45
    v_fma_f32 v9, v11, v51, v9
    v_fma_f32 v10, v12, v51, v10
    v_cvt_pk_bf16_f32 v26, v9, v10
    v_cvt_pk_bf16_f32 v8, v46, v47
    v_lshlrev_b32 v46, 16, v8
    v_and_b32 v47, 0xffff0000, v8
    v_mul_f32 v9, v46, v51
    v_mul_f32 v10, v47, v51
    v_fma_f32 v11, -v9, v50, v46
    v_fma_f32 v12, -v10, v50, v47
    v_fma_f32 v9, v11, v51, v9
    v_fma_f32 v10, v12, v51, v10
    v_cvt_pk_bf16_f32 v27, v9, v10
    v_cvt_pk_bf16_f32 v8, v48, v49
    v_lshlrev_b32 v48, 16, v8
    v_and_b32 v49, 0xffff0000, v8
    v_mul_f32 v9, v48, v51
    v_mul_f32 v10, v49, v51
    v_fma_f32 v11, -v9, v50, v48
    v_fma_f32 v12, -v10, v50, v49
    v_fma_f32 v9, v11, v51, v9
    v_fma_f32 v10, v12, v51, v10
    v_cvt_pk_bf16_f32 v28, v9, v10
    s_mov_b32 s29, 1152
    v_mul_lo_u32 v4, v3, s29
    buffer_store_dwordx4 v[20:23], v4, s[20:23], s30 offen
    buffer_store_dwordx4 v[24:27], v4, s[20:23], s30 offen offset:16
    buffer_store_dword v28, v4, s[20:23], s30 offen offset:32
o_kernel_end:
    s_endpgm
.section .rodata,"a"
.p2align 6
.amdhsa_kernel o_kernel
  .amdhsa_next_free_vgpr 176
  .amdhsa_next_free_sgpr 102
  .amdhsa_accum_offset 176
  .amdhsa_group_segment_fixed_size 0
  .amdhsa_kernarg_size 96
  .amdhsa_user_sgpr_count 2
  .amdhsa_user_sgpr_kernarg_segment_ptr 1
  .amdhsa_system_sgpr_workgroup_id_x 1
.end_amdhsa_kernel
.text
.globl g2a_kernel
.p2align 8
.type g2a_kernel,@function
g2a_kernel:
    s_cmp_ge_u32 s2, 192
    s_cbranch_scc1 g2a_kernel_end
    s_load_dwordx2 s[4:5], s[0:1], 88
    s_load_dwordx2 s[6:7], s[0:1], 88
    s_load_dwordx2 s[64:65], s[0:1], 88
    s_load_dwordx2 s[66:67], s[0:1], 0
    v_and_b32 v1, 63, v0
    v_lshrrev_b32 v4, 6, v0
    s_nop 0
    v_readfirstlane_b32 s24, v4
    s_lshl_b32 s25, s24, 10
    s_waitcnt lgkmcnt(0)
    s_and_b32 s28, s2, 7
    s_lshr_b32 s29, s2, 3
    s_mul_hi_u32 s30, s29, 0x2aaaaaab
    s_mul_i32 s26, s30, 6
    s_sub_u32 s26, s29, s26
    s_lshl_b32 s27, s28, 2
    s_add_u32 s27, s27, s30
    s_add_u32 s8, s4, 0x1cf0000
    s_addc_u32 s9, s5, 0
    s_mov_b32 s10, 0xa2000
    s_mov_b32 s11, 0x00020000
    s_add_u32 s12, s6, 0x900000
    s_addc_u32 s13, s7, 0
    s_mov_b32 s14, 0x240000
    s_mov_b32 s15, 0x00020000
    s_add_u32 s16, s64, 0xb40000
    s_addc_u32 s17, s65, 0
    s_mov_b32 s18, 0x240000
    s_mov_b32 s19, 0x00020000
    s_mov_b32 s20, s66
    s_mov_b32 s21, s67
    s_mov_b32 s22, 0x240000
    s_mov_b32 s23, 0x00020000
    v_lshrrev_b32 v4, 3, v1
    v_and_b32 v5, 7, v1
    v_xor_b32 v5, v5, v4
    v_lshlrev_b32 v5, 4, v5
    s_mov_b32 s28, 1152
    v_mul_lo_u32 v2, v4, s28
    v_add_u32 v2, v2, v5
    s_mov_b32 s28, 1152
    v_mul_lo_u32 v3, v4, s28
    v_add_u32 v3, v3, v5
    s_add_u32 s28, s24, 0
    s_lshl_b32 s29, s28, 3
    s_mul_i32 s30, s26, 96
    s_add_u32 s29, s29, s30
    s_mul_i32 s29, s29, 1152
    s_mov_b32 s32, s29
    s_add_u32 s28, s24, 4
    s_lshl_b32 s29, s28, 3
    s_mul_i32 s30, s26, 96
    s_add_u32 s29, s29, s30
    s_mul_i32 s29, s29, 1152
    s_mov_b32 s33, s29
    s_add_u32 s28, s24, 8
    s_lshl_b32 s29, s28, 3
    s_mul_i32 s30, s26, 96
    s_add_u32 s29, s29, s30
    s_mul_i32 s29, s29, 1152
    s_mov_b32 s34, s29
    s_add_u32 s28, s24, 0
    s_lshl_b32 s29, s28, 3
    s_mul_i32 s30, s27, 64
    s_add_u32 s29, s29, s30
    s_mul_i32 s29, s29, 1152
    s_mov_b32 s48, s29
    s_add_u32 s28, s24, 4
    s_lshl_b32 s29, s28, 3
    s_mul_i32 s30, s27, 64
    s_add_u32 s29, s29, s30
    s_mul_i32 s29, s29, 1152
    s_mov_b32 s49, s29
    s_and_b32 s28, s24, 1
    s_lshr_b32 s29, s24, 1
    s_mul_i32 s28, s28, 6144
    s_mul_i32 s29, s29, 4096
    v_and_b32 v4, 15, v1
    v_lshlrev_b32 v4, 7, v4
    v_lshrrev_b32 v5, 4, v1
    v_and_b32 v6, 7, v1
    v_xor_b32 v5, v5, v6
    v_lshl_add_u32 v4, v5, 4, v4
    v_add_u32 v6, s28, v4
    v_xor_b32 v7, 64, v6
    v_add_u32 v8, 0x10000, v6
    v_add_u32 v9, 0x10000, v7
    v_add_u32 v10, s29, v4
    v_xor_b32 v11, 64, v10
    v_add_u32 v12, 0x10000, v10
    v_add_u32 v13, 0x10000, v11
    v_mov_b32 v16, 0
    v_mov_b32 v17, 0
    v_mov_b32 v18, 0
    v_mov_b32 v19, 0
    v_mov_b32 v20, 0
    v_mov_b32 v21, 0
    v_mov_b32 v22, 0
    v_mov_b32 v23, 0
    v_mov_b32 v24, 0
    v_mov_b32 v25, 0
    v_mov_b32 v26, 0
    v_mov_b32 v27, 0
    v_mov_b32 v28, 0
    v_mov_b32 v29, 0
    v_mov_b32 v30, 0
    v_mov_b32 v31, 0
    v_mov_b32 v32, 0
    v_mov_b32 v33, 0
    v_mov_b32 v34, 0
    v_mov_b32 v35, 0
    v_mov_b32 v36, 0
    v_mov_b32 v37, 0
    v_mov_b32 v38, 0
    v_mov_b32 v39, 0
    s_add_u32 m0, s25, 0
    s_nop 0
    buffer_load_dwordx4 v2, s[8:11], s32 offen lds
    s_add_u32 m0, s25, 4096
    s_nop 0
    buffer_load_dwordx4 v2, s[8:11], s33 offen lds
    s_add_u32 m0, s25, 8192
    s_nop 0
    buffer_load_dwordx4 v2, s[8:11], s34 offen lds
    s_add_u32 m0, s25, 12288
    s_nop 0
    buffer_load_dwordx4 v3, s[12:15], s48 offen lds
    s_add_u32 m0, s25, 16384
    s_nop 0
    buffer_load_dwordx4 v3, s[12:15], s49 offen lds
    s_add_u32 s8, s8, 128
    s_addc_u32 s9, s9, 0
    s_add_u32 s12, s12, 128
    s_addc_u32 s13, s13, 0
    s_add_u32 m0, s25, 20480
    s_nop 0
    buffer_load_dwordx4 v2, s[8:11], s32 offen lds
    s_add_u32 m0, s25, 24576
    s_nop 0
    buffer_load_dwordx4 v2, s[8:11], s33 offen lds
    s_add_u32 m0, s25, 28672
    s_nop 0
    buffer_load_dwordx4 v2, s[8:11], s34 offen lds
    s_add_u32 m0, s25, 32768
    s_nop 0
    buffer_load_dwordx4 v3, s[12:15], s48 offen lds
    s_add_u32 m0, s25, 36864
    s_nop 0
    buffer_load_dwordx4 v3, s[12:15], s49 offen lds
    s_add_u32 s8, s8, 128
    s_addc_u32 s9, s9, 0
    s_add_u32 s12, s12, 128
    s_addc_u32 s13, s13, 0
    s_add_u32 m0, s25, 40960
    s_nop 0
    buffer_load_dwordx4 v2, s[8:11], s32 offen lds
    s_add_u32 m0, s25, 45056
    s_nop 0
    buffer_load_dwordx4 v2, s[8:11], s33 offen lds
    s_add_u32 m0, s25, 49152
    s_nop 0
    buffer_load_dwordx4 v2, s[8:11], s34 offen lds
    s_add_u32 m0, s25, 53248
    s_nop 0
    buffer_load_dwordx4 v3, s[12:15], s48 offen lds
    s_add_u32 m0, s25, 57344
    s_nop 0
    buffer_load_dwordx4 v3, s[12:15], s49 offen lds
    s_add_u32 s8, s8, 128
    s_addc_u32 s9, s9, 0
    s_add_u32 s12, s12, 128
    s_addc_u32 s13, s13, 0
    s_add_u32 m0, s25, 61440
    s_nop 0
    buffer_load_dwordx4 v2, s[8:11], s32 offen lds
    s_add_u32 m0, s25, 65536
    s_nop 0
    buffer_load_dwordx4 v2, s[8:11], s33 offen lds
    s_add_u32 m0, s25, 69632
    s_nop 0
    buffer_load_dwordx4 v2, s[8:11], s34 offen lds
    s_add_u32 m0, s25, 73728
    s_nop 0
    buffer_load_dwordx4 v3, s[12:15], s48 offen lds
    s_add_u32 m0, s25, 77824
    s_nop 0
    buffer_load_dwordx4 v3, s[12:15], s49 offen lds
    s_add_u32 s8, s8, 128
    s_addc_u32 s9, s9, 0
    s_add_u32 s12, s12, 128
    s_addc_u32 s13, s13, 0
    s_waitcnt vmcnt(15)
    s_barrier
    ds_read_b128 v[40:43], v6 offset:0
    ds_read_b128 v[44:47], v6 offset:2048
    ds_read_b128 v[48:51], v6 offset:4096
    ds_read_b128 v[52:55], v10 offset:12288
    ds_read_b128 v[56:59], v10 offset:14336
    ds_read_b128 v[60:63], v7 offset:0
    ds_read_b128 v[64:67], v7 offset:2048
    ds_read_b128 v[68:71], v7 offset:4096
    ds_read_b128 v[72:75], v11 offset:12288
    ds_read_b128 v[76:79], v11 offset:14336
    s_waitcnt lgkmcnt(5)
    v_mfma_f32_16x16x32_bf16 v[16:19], v[40:43], v[52:55], v[16:19]
    v_mfma_f32_16x16x32_bf16 v[20:23], v[40:43], v[56:59], v[20:23]
    v_mfma_f32_16x16x32_bf16 v[24:27], v[44:47], v[52:55], v[24:27]
    v_mfma_f32_16x16x32_bf16 v[28:31], v[44:47], v[56:59], v[28:31]
    v_mfma_f32_16x16x32_bf16 v[32:35], v[48:51], v[52:55], v[32:35]
    v_mfma_f32_16x16x32_bf16 v[36:39], v[48:51], v[56:59], v[36:39]
    s_waitcnt lgkmcnt(0)
    s_waitcnt vmcnt(10)
    s_barrier
    ds_read_b128 v[40:43], v6 offset:20480
    ds_read_b128 v[44:47], v6 offset:22528
    ds_read_b128 v[48:51], v6 offset:24576
    ds_read_b128 v[52:55], v10 offset:32768
    ds_read_b128 v[56:59], v10 offset:34816
    s_add_u32 m0, s25, 0
    s_nop 0
    buffer_load_dwordx4 v2, s[8:11], s32 offen lds
    v_mfma_f32_16x16x32_bf16 v[16:19], v[60:63], v[72:75], v[16:19]
    s_add_u32 m0, s25, 4096
    s_nop 0
    buffer_load_dwordx4 v2, s[8:11], s33 offen lds
    v_mfma_f32_16x16x32_bf16 v[20:23], v[60:63], v[76:79], v[20:23]
    s_add_u32 m0, s25, 8192
    s_nop 0
    buffer_load_dwordx4 v2, s[8:11], s34 offen lds
    v_mfma_f32_16x16x32_bf16 v[24:27], v[64:67], v[72:75], v[24:27]
    s_add_u32 m0, s25, 12288
    s_nop 0
    buffer_load_dwordx4 v3, s[12:15], s48 offen lds
    v_mfma_f32_16x16x32_bf16 v[28:31], v[64:67], v[76:79], v[28:31]
    s_add_u32 m0, s25, 16384
    s_nop 0
    buffer_load_dwordx4 v3, s[12:15], s49 offen lds
    v_mfma_f32_16x16x32_bf16 v[32:35], v[68:71], v[72:75], v[32:35]
    s_add_u32 s8, s8, 128
    s_addc_u32 s9, s9, 0
    s_add_u32 s12, s12, 128
    s_addc_u32 s13, s13, 0
    v_mfma_f32_16x16x32_bf16 v[36:39], v[68:71], v[76:79], v[36:39]
    ds_read_b128 v[60:63], v7 offset:20480
    ds_read_b128 v[64:67], v7 offset:22528
    ds_read_b128 v[68:71], v7 offset:24576
    ds_read_b128 v[72:75], v11 offset:32768
    ds_read_b128 v[76:79], v11 offset:34816
    s_waitcnt lgkmcnt(5)
    v_mfma_f32_16x16x32_bf16 v[16:19], v[40:43], v[52:55], v[16:19]
    v_mfma_f32_16x16x32_bf16 v[20:23], v[40:43], v[56:59], v[20:23]
    v_mfma_f32_16x16x32_bf16 v[24:27], v[44:47], v[52:55], v[24:27]
    v_mfma_f32_16x16x32_bf16 v[28:31], v[44:47], v[56:59], v[28:31]
    v_mfma_f32_16x16x32_bf16 v[32:35], v[48:51], v[52:55], v[32:35]
    v_mfma_f32_16x16x32_bf16 v[36:39], v[48:51], v[56:59], v[36:39]
    s_waitcnt lgkmcnt(0)
    s_waitcnt vmcnt(10)
    s_barrier
    ds_read_b128 v[40:43], v6 offset:40960
    ds_read_b128 v[44:47], v6 offset:43008
    ds_read_b128 v[48:51], v6 offset:45056
    ds_read_b128 v[52:55], v10 offset:53248
    ds_read_b128 v[56:59], v10 offset:55296
    s_add_u32 m0, s25, 20480
    s_nop 0
    buffer_load_dwordx4 v2, s[8:11], s32 offen lds
    v_mfma_f32_16x16x32_bf16 v[16:19], v[60:63], v[72:75], v[16:19]
    s_add_u32 m0, s25, 24576
    s_nop 0
    buffer_load_dwordx4 v2, s[8:11], s33 offen lds
    v_mfma_f32_16x16x32_bf16 v[20:23], v[60:63], v[76:79], v[20:23]
    s_add_u32 m0, s25, 28672
    s_nop 0
    buffer_load_dwordx4 v2, s[8:11], s34 offen lds
    v_mfma_f32_16x16x32_bf16 v[24:27], v[64:67], v[72:75], v[24:27]
    s_add_u32 m0, s25, 32768
    s_nop 0
    buffer_load_dwordx4 v3, s[12:15], s48 offen lds
    v_mfma_f32_16x16x32_bf16 v[28:31], v[64:67], v[76:79], v[28:31]
    s_add_u32 m0, s25, 36864
    s_nop 0
    buffer_load_dwordx4 v3, s[12:15], s49 offen lds
    v_mfma_f32_16x16x32_bf16 v[32:35], v[68:71], v[72:75], v[32:35]
    s_add_u32 s8, s8, 128
    s_addc_u32 s9, s9, 0
    s_add_u32 s12, s12, 128
    s_addc_u32 s13, s13, 0
    v_mfma_f32_16x16x32_bf16 v[36:39], v[68:71], v[76:79], v[36:39]
    ds_read_b128 v[60:63], v7 offset:40960
    ds_read_b128 v[64:67], v7 offset:43008
    ds_read_b128 v[68:71], v7 offset:45056
    ds_read_b128 v[72:75], v11 offset:53248
    ds_read_b128 v[76:79], v11 offset:55296
    s_waitcnt lgkmcnt(5)
    v_mfma_f32_16x16x32_bf16 v[16:19], v[40:43], v[52:55], v[16:19]
    v_mfma_f32_16x16x32_bf16 v[20:23], v[40:43], v[56:59], v[20:23]
    v_mfma_f32_16x16x32_bf16 v[24:27], v[44:47], v[52:55], v[24:27]
    v_mfma_f32_16x16x32_bf16 v[28:31], v[44:47], v[56:59], v[28:31]
    v_mfma_f32_16x16x32_bf16 v[32:35], v[48:51], v[52:55], v[32:35]
    v_mfma_f32_16x16x32_bf16 v[36:39], v[48:51], v[56:59], v[36:39]
    s_waitcnt lgkmcnt(0)
    s_waitcnt vmcnt(10)
    s_barrier
    ds_read_b128 v[40:43], v6 offset:61440
    ds_read_b128 v[44:47], v6 offset:63488
    ds_read_b128 v[48:51], v8 offset:0
    ds_read_b128 v[52:55], v12 offset:8192
    ds_read_b128 v[56:59], v12 offset:10240
    s_add_u32 m0, s25, 40960
    s_nop 0
    buffer_load_dwordx4 v2, s[8:11], s32 offen lds
    v_mfma_f32_16x16x32_bf16 v[16:19], v[60:63], v[72:75], v[16:19]
    s_add_u32 m0, s25, 45056
    s_nop 0
    buffer_load_dwordx4 v2, s[8:11], s33 offen lds
    v_mfma_f32_16x16x32_bf16 v[20:23], v[60:63], v[76:79], v[20:23]
    s_add_u32 m0, s25, 49152
    s_nop 0
    buffer_load_dwordx4 v2, s[8:11], s34 offen lds
    v_mfma_f32_16x16x32_bf16 v[24:27], v[64:67], v[72:75], v[24:27]
    s_add_u32 m0, s25, 53248
    s_nop 0
    buffer_load_dwordx4 v3, s[12:15], s48 offen lds
    v_mfma_f32_16x16x32_bf16 v[28:31], v[64:67], v[76:79], v[28:31]
    s_add_u32 m0, s25, 57344
    s_nop 0
    buffer_load_dwordx4 v3, s[12:15], s49 offen lds
    v_mfma_f32_16x16x32_bf16 v[32:35], v[68:71], v[72:75], v[32:35]
    s_add_u32 s8, s8, 128
    s_addc_u32 s9, s9, 0
    s_add_u32 s12, s12, 128
    s_addc_u32 s13, s13, 0
    v_mfma_f32_16x16x32_bf16 v[36:39], v[68:71], v[76:79], v[36:39]
    ds_read_b128 v[60:63], v7 offset:61440
    ds_read_b128 v[64:67], v7 offset:63488
    ds_read_b128 v[68:71], v9 offset:0
    ds_read_b128 v[72:75], v13 offset:8192
    ds_read_b128 v[76:79], v13 offset:10240
    s_waitcnt lgkmcnt(5)
    v_mfma_f32_16x16x32_bf16 v[16:19], v[40:43], v[52:55], v[16:19]
    v_mfma_f32_16x16x32_bf16 v[20:23], v[40:43], v[56:59], v[20:23]
    v_mfma_f32_16x16x32_bf16 v[24:27], v[44:47], v[52:55], v[24:27]
    v_mfma_f32_16x16x32_bf16 v[28:31], v[44:47], v[56:59], v[28:31]
    v_mfma_f32_16x16x32_bf16 v[32:35], v[48:51], v[52:55], v[32:35]
    v_mfma_f32_16x16x32_bf16 v[36:39], v[48:51], v[56:59], v[36:39]
    s_waitcnt lgkmcnt(0)
    s_waitcnt vmcnt(10)
    s_barrier
    ds_read_b128 v[40:43], v6 offset:0
    ds_read_b128 v[44:47], v6 offset:2048
    ds_read_b128 v[48:51], v6 offset:4096
    ds_read_b128 v[52:55], v10 offset:12288
    ds_read_b128 v[56:59], v10 offset:14336
    s_add_u32 m0, s25, 61440
    s_nop 0
    buffer_load_dwordx4 v2, s[8:11], s32 offen lds
    v_mfma_f32_16x16x32_bf16 v[16:19], v[60:63], v[72:75], v[16:19]
    s_add_u32 m0, s25, 65536
    s_nop 0
    buffer_load_dwordx4 v2, s[8:11], s33 offen lds
    v_mfma_f32_16x16x32_bf16 v[20:23], v[60:63], v[76:79], v[20:23]
    s_add_u32 m0, s25, 69632
    s_nop 0
    buffer_load_dwordx4 v2, s[8:11], s34 offen lds
    v_mfma_f32_16x16x32_bf16 v[24:27], v[64:67], v[72:75], v[24:27]
    s_add_u32 m0, s25, 73728
    s_nop 0
    buffer_load_dwordx4 v3, s[12:15], s48 offen lds
    v_mfma_f32_16x16x32_bf16 v[28:31], v[64:67], v[76:79], v[28:31]
    s_add_u32 m0, s25, 77824
    s_nop 0
    buffer_load_dwordx4 v3, s[12:15], s49 offen lds
    v_mfma_f32_16x16x32_bf16 v[32:35], v[68:71], v[72:75], v[32:35]
    s_add_u32 s8, s8, 128
    s_addc_u32 s9, s9, 0
    s_add_u32 s12, s12, 128
    s_addc_u32 s13, s13, 0
    v_mfma_f32_16x16x32_bf16 v[36:39], v[68:71], v[76:79], v[36:39]
    ds_read_b128 v[60:63], v7 offset:0
    ds_read_b128 v[64:67], v7 offset:2048
    ds_read_b128 v[68:71], v7 offset:4096
    ds_read_b128 v[72:75], v11 offset:12288
    ds_read_b128 v[76:79], v11 offset:14336
    s_waitcnt lgkmcnt(5)
    v_mfma_f32_16x16x32_bf16 v[16:19], v[40:43], v[52:55], v[16:19]
    v_mfma_f32_16x16x32_bf16 v[20:23], v[40:43], v[56:59], v[20:23]
    v_mfma_f32_16x16x32_bf16 v[24:27], v[44:47], v[52:55], v[24:27]
    v_mfma_f32_16x16x32_bf16 v[28:31], v[44:47], v[56:59], v[28:31]
    v_mfma_f32_16x16x32_bf16 v[32:35], v[48:51], v[52:55], v[32:35]
    v_mfma_f32_16x16x32_bf16 v[36:39], v[48:51], v[56:59], v[36:39]
    s_waitcnt lgkmcnt(0)
    s_waitcnt vmcnt(10)
    s_barrier
    ds_read_b128 v[40:43], v6 offset:20480
    ds_read_b128 v[44:47], v6 offset:22528
    ds_read_b128 v[48:51], v6 offset:24576
    ds_read_b128 v[52:55], v10 offset:32768
    ds_read_b128 v[56:59], v10 offset:34816
    s_add_u32 m0, s25, 0
    s_nop 0
    buffer_load_dwordx4 v2, s[8:11], s32 offen lds
    v_mfma_f32_16x16x32_bf16 v[16:19], v[60:63], v[72:75], v[16:19]
    s_add_u32 m0, s25, 4096
    s_nop 0
    buffer_load_dwordx4 v2, s[8:11], s33 offen lds
    v_mfma_f32_16x16x32_bf16 v[20:23], v[60:63], v[76:79], v[20:23]
    s_add_u32 m0, s25, 8192
    s_nop 0
    buffer_load_dwordx4 v2, s[8:11], s34 offen lds
    v_mfma_f32_16x16x32_bf16 v[24:27], v[64:67], v[72:75], v[24:27]
    s_add_u32 m0, s25, 12288
    s_nop 0
    buffer_load_dwordx4 v3, s[12:15], s48 offen lds
    v_mfma_f32_16x16x32_bf16 v[28:31], v[64:67], v[76:79], v[28:31]
    s_add_u32 m0, s25, 16384
    s_nop 0
    buffer_load_dwordx4 v3, s[12:15], s49 offen lds
    v_mfma_f32_16x16x32_bf16 v[32:35], v[68:71], v[72:75], v[32:35]
    s_add_u32 s8, s8, 128
    s_addc_u32 s9, s9, 0
    s_add_u32 s12, s12, 128
    s_addc_u32 s13, s13, 0
    v_mfma_f32_16x16x32_bf16 v[36:39], v[68:71], v[76:79], v[36:39]
    ds_read_b128 v[60:63], v7 offset:20480
    ds_read_b128 v[64:67], v7 offset:22528
    ds_read_b128 v[68:71], v7 offset:24576
    ds_read_b128 v[72:75], v11 offset:32768
    ds_read_b128 v[76:79], v11 offset:34816
    s_waitcnt lgkmcnt(5)
    v_mfma_f32_16x16x32_bf16 v[16:19], v[40:43], v[52:55], v[16:19]
    v_mfma_f32_16x16x32_bf16 v[20:23], v[40:43], v[56:59], v[20:23]
    v_mfma_f32_16x16x32_bf16 v[24:27], v[44:47], v[52:55], v[24:27]
    v_mfma_f32_16x16x32_bf16 v[28:31], v[44:47], v[56:59], v[28:31]
    v_mfma_f32_16x16x32_bf16 v[32:35], v[48:51], v[52:55], v[32:35]
    v_mfma_f32_16x16x32_bf16 v[36:39], v[48:51], v[56:59], v[36:39]
    s_waitcnt lgkmcnt(0)
    s_waitcnt vmcnt(10)
    s_barrier
    ds_read_b128 v[40:43], v6 offset:40960
    ds_read_b128 v[44:47], v6 offset:43008
    ds_read_b128 v[48:51], v6 offset:45056
    ds_read_b128 v[52:55], v10 offset:53248
    ds_read_b128 v[56:59], v10 offset:55296
    v_mfma_f32_16x16x32_bf16 v[16:19], v[60:63], v[72:75], v[16:19]
    v_mfma_f32_16x16x32_bf16 v[20:23], v[60:63], v[76:79], v[20:23]
    v_mfma_f32_16x16x32_bf16 v[24:27], v[64:67], v[72:75], v[24:27]
    v_mfma_f32_16x16x32_bf16 v[28:31], v[64:67], v[76:79], v[28:31]
    v_mfma_f32_16x16x32_bf16 v[32:35], v[68:71], v[72:75], v[32:35]
    v_mfma_f32_16x16x32_bf16 v[36:39], v[68:71], v[76:79], v[36:39]
    ds_read_b128 v[60:63], v7 offset:40960
    ds_read_b128 v[64:67], v7 offset:43008
    ds_read_b128 v[68:71], v7 offset:45056
    ds_read_b128 v[72:75], v11 offset:53248
    ds_read_b128 v[76:79], v11 offset:55296
    s_waitcnt lgkmcnt(5)
    v_mfma_f32_16x16x32_bf16 v[16:19], v[40:43], v[52:55], v[16:19]
    v_mfma_f32_16x16x32_bf16 v[20:23], v[40:43], v[56:59], v[20:23]
    v_mfma_f32_16x16x32_bf16 v[24:27], v[44:47], v[52:55], v[24:27]
    v_mfma_f32_16x16x32_bf16 v[28:31], v[44:47], v[56:59], v[28:31]
    v_mfma_f32_16x16x32_bf16 v[32:35], v[48:51], v[52:55], v[32:35]
    v_mfma_f32_16x16x32_bf16 v[36:39], v[48:51], v[56:59], v[36:39]
    s_waitcnt lgkmcnt(0)
    s_waitcnt vmcnt(5)
    s_barrier
    ds_read_b128 v[40:43], v6 offset:61440
    ds_read_b128 v[44:47], v6 offset:63488
    ds_read_b128 v[48:51], v8 offset:0
    ds_read_b128 v[52:55], v12 offset:8192
    ds_read_b128 v[56:59], v12 offset:10240
    v_mfma_f32_16x16x32_bf16 v[16:19], v[60:63], v[72:75], v[16:19]
    v_mfma_f32_16x16x32_bf16 v[20:23], v[60:63], v[76:79], v[20:23]
    v_mfma_f32_16x16x32_bf16 v[24:27], v[64:67], v[72:75], v[24:27]
    v_mfma_f32_16x16x32_bf16 v[28:31], v[64:67], v[76:79], v[28:31]
    v_mfma_f32_16x16x32_bf16 v[32:35], v[68:71], v[72:75], v[32:35]
    v_mfma_f32_16x16x32_bf16 v[36:39], v[68:71], v[76:79], v[36:39]
    ds_read_b128 v[60:63], v7 offset:61440
    ds_read_b128 v[64:67], v7 offset:63488
    ds_read_b128 v[68:71], v9 offset:0
    ds_read_b128 v[72:75], v13 offset:8192
    ds_read_b128 v[76:79], v13 offset:10240
    s_waitcnt lgkmcnt(5)
    v_mfma_f32_16x16x32_bf16 v[16:19], v[40:43], v[52:55], v[16:19]
    v_mfma_f32_16x16x32_bf16 v[20:23], v[40:43], v[56:59], v[20:23]
    v_mfma_f32_16x16x32_bf16 v[24:27], v[44:47], v[52:55], v[24:27]
    v_mfma_f32_16x16x32_bf16 v[28:31], v[44:47], v[56:59], v[28:31]
    v_mfma_f32_16x16x32_bf16 v[32:35], v[48:51], v[52:55], v[32:35]
    v_mfma_f32_16x16x32_bf16 v[36:39], v[48:51], v[56:59], v[36:39]
    s_waitcnt lgkmcnt(0)
    s_waitcnt vmcnt(0)
    s_barrier
    ds_read_b128 v[40:43], v6 offset:0
    ds_read_b128 v[44:47], v6 offset:2048
    ds_read_b128 v[48:51], v6 offset:4096
    ds_read_b128 v[52:55], v10 offset:12288
    ds_read_b128 v[56:59], v10 offset:14336
    v_mfma_f32_16x16x32_bf16 v[16:19], v[60:63], v[72:75], v[16:19]
    v_mfma_f32_16x16x32_bf16 v[20:23], v[60:63], v[76:79], v[20:23]
    v_mfma_f32_16x16x32_bf16 v[24:27], v[64:67], v[72:75], v[24:27]
    v_mfma_f32_16x16x32_bf16 v[28:31], v[64:67], v[76:79], v[28:31]
    v_mfma_f32_16x16x32_bf16 v[32:35], v[68:71], v[72:75], v[32:35]
    v_mfma_f32_16x16x32_bf16 v[36:39], v[68:71], v[76:79], v[36:39]
    ds_read_b128 v[60:63], v7 offset:0
    ds_read_b128 v[64:67], v7 offset:2048
    ds_read_b128 v[68:71], v7 offset:4096
    ds_read_b128 v[72:75], v11 offset:12288
    ds_read_b128 v[76:79], v11 offset:14336
    s_waitcnt lgkmcnt(5)
    v_mfma_f32_16x16x32_bf16 v[16:19], v[40:43], v[52:55], v[16:19]
    v_mfma_f32_16x16x32_bf16 v[20:23], v[40:43], v[56:59], v[20:23]
    v_mfma_f32_16x16x32_bf16 v[24:27], v[44:47], v[52:55], v[24:27]
    v_mfma_f32_16x16x32_bf16 v[28:31], v[44:47], v[56:59], v[28:31]
    v_mfma_f32_16x16x32_bf16 v[32:35], v[48:51], v[52:55], v[32:35]
    v_mfma_f32_16x16x32_bf16 v[36:39], v[48:51], v[56:59], v[36:39]
    s_waitcnt lgkmcnt(0)
    v_mfma_f32_16x16x32_bf16 v[16:19], v[60:63], v[72:75], v[16:19]
    v_mfma_f32_16x16x32_bf16 v[20:23], v[60:63], v[76:79], v[20:23]
    v_mfma_f32_16x16x32_bf16 v[24:27], v[64:67], v[72:75], v[24:27]
    v_mfma_f32_16x16x32_bf16 v[28:31], v[64:67], v[76:79], v[28:31]
    v_mfma_f32_16x16x32_bf16 v[32:35], v[68:71], v[72:75], v[32:35]
    v_mfma_f32_16x16x32_bf16 v[36:39], v[68:71], v[76:79], v[36:39]
    s_nop 7
    s_nop 7
    s_mul_i32 s28, s27, 64
    s_lshr_b32 s29, s24, 1
    s_mul_i32 s29, s29, 32
    s_add_u32 s28, s28, s29
    s_mul_i32 s29, s26, 96
    s_and_b32 s30, s24, 1
    s_mul_i32 s30, s30, 48
    s_add_u32 s29, s29, s30
    s_lshl_b32 s29, s29, 1
    v_and_b32 v4, 15, v1
    v_add_u32 v4, s28, v4
    s_mov_b32 s30, 1152
    v_mul_lo_u32 v4, v4, s30
    v_lshrrev_b32 v5, 4, v1
    v_lshlrev_b32 v5, 3, v5
    v_add_u32 v4, v4, v5
    v_add_u32 v4, s29, v4
    s_mov_b32 s31, 0
    v_cvt_pk_bf16_f32 v40, v16, v17
    v_cvt_pk_bf16_f32 v41, v18, v19
    buffer_load_dwordx2 v[42:43], v4, s[20:23], s31 offen
    s_waitcnt vmcnt(0)
    v_lshlrev_b32 v44, 16, v40
    v_and_b32 v45, 0xffff0000, v40
    v_lshlrev_b32 v46, 16, v42
    v_and_b32 v47, 0xffff0000, v42
    v_add_f32 v44, v44, v46
    v_add_f32 v45, v45, v47
    v_cvt_pk_bf16_f32 v40, v44, v45
    v_lshlrev_b32 v44, 16, v41
    v_and_b32 v45, 0xffff0000, v41
    v_lshlrev_b32 v46, 16, v43
    v_and_b32 v47, 0xffff0000, v43
    v_add_f32 v44, v44, v46
    v_add_f32 v45, v45, v47
    v_cvt_pk_bf16_f32 v41, v44, v45
    buffer_store_dwordx2 v[40:41], v4, s[16:19], s31 offen
    s_mov_b32 s31, 32
    v_cvt_pk_bf16_f32 v40, v24, v25
    v_cvt_pk_bf16_f32 v41, v26, v27
    buffer_load_dwordx2 v[42:43], v4, s[20:23], s31 offen
    s_waitcnt vmcnt(0)
    v_lshlrev_b32 v44, 16, v40
    v_and_b32 v45, 0xffff0000, v40
    v_lshlrev_b32 v46, 16, v42
    v_and_b32 v47, 0xffff0000, v42
    v_add_f32 v44, v44, v46
    v_add_f32 v45, v45, v47
    v_cvt_pk_bf16_f32 v40, v44, v45
    v_lshlrev_b32 v44, 16, v41
    v_and_b32 v45, 0xffff0000, v41
    v_lshlrev_b32 v46, 16, v43
    v_and_b32 v47, 0xffff0000, v43
    v_add_f32 v44, v44, v46
    v_add_f32 v45, v45, v47
    v_cvt_pk_bf16_f32 v41, v44, v45
    buffer_store_dwordx2 v[40:41], v4, s[16:19], s31 offen
    s_mov_b32 s31, 64
    v_cvt_pk_bf16_f32 v40, v32, v33
    v_cvt_pk_bf16_f32 v41, v34, v35
    buffer_load_dwordx2 v[42:43], v4, s[20:23], s31 offen
    s_waitcnt vmcnt(0)
    v_lshlrev_b32 v44, 16, v40
    v_and_b32 v45, 0xffff0000, v40
    v_lshlrev_b32 v46, 16, v42
    v_and_b32 v47, 0xffff0000, v42
    v_add_f32 v44, v44, v46
    v_add_f32 v45, v45, v47
    v_cvt_pk_bf16_f32 v40, v44, v45
    v_lshlrev_b32 v44, 16, v41
    v_and_b32 v45, 0xffff0000, v41
    v_lshlrev_b32 v46, 16, v43
    v_and_b32 v47, 0xffff0000, v43
    v_add_f32 v44, v44, v46
    v_add_f32 v45, v45, v47
    v_cvt_pk_bf16_f32 v41, v44, v45
    buffer_store_dwordx2 v[40:41], v4, s[16:19], s31 offen
    s_mov_b32 s31, 18432
    v_cvt_pk_bf16_f32 v40, v20, v21
    v_cvt_pk_bf16_f32 v41, v22, v23
    buffer_load_dwordx2 v[42:43], v4, s[20:23], s31 offen
    s_waitcnt vmcnt(0)
    v_lshlrev_b32 v44, 16, v40
    v_and_b32 v45, 0xffff0000, v40
    v_lshlrev_b32 v46, 16, v42
    v_and_b32 v47, 0xffff0000, v42
    v_add_f32 v44, v44, v46
    v_add_f32 v45, v45, v47
    v_cvt_pk_bf16_f32 v40, v44, v45
    v_lshlrev_b32 v44, 16, v41
    v_and_b32 v45, 0xffff0000, v41
    v_lshlrev_b32 v46, 16, v43
    v_and_b32 v47, 0xffff0000, v43
    v_add_f32 v44, v44, v46
    v_add_f32 v45, v45, v47
    v_cvt_pk_bf16_f32 v41, v44, v45
    buffer_store_dwordx2 v[40:41], v4, s[16:19], s31 offen
    s_mov_b32 s31, 18464
    v_cvt_pk_bf16_f32 v40, v28, v29
    v_cvt_pk_bf16_f32 v41, v30, v31
    buffer_load_dwordx2 v[42:43], v4, s[20:23], s31 offen
    s_waitcnt vmcnt(0)
    v_lshlrev_b32 v44, 16, v40
    v_and_b32 v45, 0xffff0000, v40
    v_lshlrev_b32 v46, 16, v42
    v_and_b32 v47, 0xffff0000, v42
    v_add_f32 v44, v44, v46
    v_add_f32 v45, v45, v47
    v_cvt_pk_bf16_f32 v40, v44, v45
    v_lshlrev_b32 v44, 16, v41
    v_and_b32 v45, 0xffff0000, v41
    v_lshlrev_b32 v46, 16, v43
    v_and_b32 v47, 0xffff0000, v43
    v_add_f32 v44, v44, v46
    v_add_f32 v45, v45, v47
    v_cvt_pk_bf16_f32 v41, v44, v45
    buffer_store_dwordx2 v[40:41], v4, s[16:19], s31 offen
    s_mov_b32 s31, 18496
    v_cvt_pk_bf16_f32 v40, v36, v37
    v_cvt_pk_bf16_f32 v41, v38, v39
    buffer_load_dwordx2 v[42:43], v4, s[20:23], s31 offen
    s_waitcnt vmcnt(0)
    v_lshlrev_b32 v44, 16, v40
    v_and_b32 v45, 0xffff0000, v40
    v_lshlrev_b32 v46, 16, v42
    v_and_b32 v47, 0xffff0000, v42
    v_add_f32 v44, v44, v46
    v_add_f32 v45, v45, v47
    v_cvt_pk_bf16_f32 v40, v44, v45
    v_lshlrev_b32 v44, 16, v41
    v_and_b32 v45, 0xffff0000, v41
    v_lshlrev_b32 v46, 16, v43
    v_and_b32 v47, 0xffff0000, v43
    v_add_f32 v44, v44, v46
    v_add_f32 v45, v45, v47
    v_cvt_pk_bf16_f32 v41, v44, v45
    buffer_store_dwordx2 v[40:41], v4, s[16:19], s31 offen
g2a_kernel_end:
    s_endpgm
.section .rodata,"a"
.p2align 6
.amdhsa_kernel g2a_kernel
  .amdhsa_next_free_vgpr 88
  .amdhsa_next_free_sgpr 102
  .amdhsa_accum_offset 88
  .amdhsa_group_segment_fixed_size 0
  .amdhsa_kernarg_size 96
  .amdhsa_user_sgpr_count 2
  .amdhsa_user_sgpr_kernarg_segment_ptr 1
  .amdhsa_system_sgpr_workgroup_id_x 1
.end_amdhsa_kernel
.text
.globl ln2_kernel
.p2align 8
.type ln2_kernel,@function
ln2_kernel:
    s_load_dwordx2 s[4:5], s[0:1], 0
    s_load_dwordx2 s[6:7], s[0:1], 88
    s_load_dwordx2 s[8:9], s[0:1], 72
    v_lshrrev_b32 v1, 6, v0
    v_and_b32 v2, 63, v0
    s_nop 0
    v_readfirstlane_b32 s3, v1
    s_lshl_b32 s10, s2, 2
    s_add_u32 s10, s10, s3
    s_cmp_ge_u32 s10, 2048
    s_cbranch_scc1 ln2_kernel_end
    s_waitcnt lgkmcnt(0)
    s_add_u32 s12, s6, 0xb40000
    s_addc_u32 s13, s7, 0
    s_mov_b32 s14, 0x240000
    s_mov_b32 s15, 0x00020000
    s_mov_b32 s16, s6
    s_mov_b32 s17, s7
    s_mov_b32 s18, 0x240000
    s_mov_b32 s19, 0x00020000
    s_mul_i32 s11, s10, 1152
    v_lshlrev_b32 v3, 4, v2
    v_cmp_gt_u32 s[32:33], 8, v2
    v_mov_b32 v12, 0
    v_mov_b32 v13, 0
    v_mov_b32 v14, 0
    v_mov_b32 v15, 0
    v_mov_b32 v16, 0
    v_mov_b32 v17, 0
    v_mov_b32 v18, 0
    v_mov_b32 v19, 0
    buffer_load_dwordx4 v[4:7], v3, s[12:15], s11 offen
    s_mov_b64 exec, s[32:33]
    buffer_load_dwordx4 v[12:15], v3, s[12:15], s11 offen offset:1024
    s_mov_b64 exec, -1
    s_waitcnt vmcnt(0)
    v_lshlrev_b32 v20, 16, v4
    v_and_b32 v21, 0xffff0000, v4
    v_lshlrev_b32 v22, 16, v5
    v_and_b32 v23, 0xffff0000, v5
    v_lshlrev_b32 v24, 16, v6
    v_and_b32 v25, 0xffff0000, v6
    v_lshlrev_b32 v26, 16, v7
    v_and_b32 v27, 0xffff0000, v7
    v_lshlrev_b32 v28, 16, v12
    v_and_b32 v29, 0xffff0000, v12
    v_lshlrev_b32 v30, 16, v13
    v_and_b32 v31, 0xffff0000, v13
    v_lshlrev_b32 v32, 16, v14
    v_and_b32 v33, 0xffff0000, v14
    v_lshlrev_b32 v34, 16, v15
    v_and_b32 v35, 0xffff0000, v15
    v_add_f32 v36, v20, v21
    v_add_f32 v36, v36, v22
    v_add_f32 v36, v36, v23
    v_add_f32 v36, v36, v24
    v_add_f32 v36, v36, v25
    v_add_f32 v36, v36, v26
    v_add_f32 v36, v36, v27
    v_add_f32 v36, v36, v28
    v_add_f32 v36, v36, v29
    v_add_f32 v36, v36, v30
    v_add_f32 v36, v36, v31
    v_add_f32 v36, v36, v32
    v_add_f32 v36, v36, v33
    v_add_f32 v36, v36, v34
    v_add_f32 v36, v36, v35
    s_nop 1
    v_add_f32_dpp v36, v36, v36 row_shr:1 row_mask:0xf bank_mask:0xf
    s_nop 1
    v_add_f32_dpp v36, v36, v36 row_shr:2 row_mask:0xf bank_mask:0xf
    s_nop 1
    v_add_f32_dpp v36, v36, v36 row_shr:4 row_mask:0xf bank_mask:0xf
    s_nop 1
    v_add_f32_dpp v36, v36, v36 row_shr:8 row_mask:0xf bank_mask:0xf
    s_nop 1
    v_add_f32_dpp v36, v36, v36 row_bcast:15 row_mask:0xa bank_mask:0xf
    s_nop 1
    v_add_f32_dpp v36, v36, v36 row_bcast:31 row_mask:0xc bank_mask:0xf
    s_nop 0
    v_readlane_b32 s34, v36, 63
    s_nop 1
    v_mov_b32 v37, s34
    v_mul_f32 v37, 0x3ae38e39, v37
    v_sub_f32 v38, v20, v37
    v_mul_f32 v36, v38, v38
    v_sub_f32 v38, v21, v37
    v_fmac_f32 v36, v38, v38
    v_sub_f32 v38, v22, v37
    v_fmac_f32 v36, v38, v38
    v_sub_f32 v38, v23, v37
    v_fmac_f32 v36, v38, v38
    v_sub_f32 v38, v24, v37
    v_fmac_f32 v36, v38, v38
    v_sub_f32 v38, v25, v37
    v_fmac_f32 v36, v38, v38
    v_sub_f32 v38, v26, v37
    v_fmac_f32 v36, v38, v38
    v_sub_f32 v38, v27, v37
    v_fmac_f32 v36, v38, v38
    s_mov_b64 exec, s[32:33]
    v_sub_f32 v38, v28, v37
    v_fmac_f32 v36, v38, v38
    v_sub_f32 v38, v29, v37
    v_fmac_f32 v36, v38, v38
    v_sub_f32 v38, v30, v37
    v_fmac_f32 v36, v38, v38
    v_sub_f32 v38, v31, v37
    v_fmac_f32 v36, v38, v38
    v_sub_f32 v38, v32, v37
    v_fmac_f32 v36, v38, v38
    v_sub_f32 v38, v33, v37
    v_fmac_f32 v36, v38, v38
    v_sub_f32 v38, v34, v37
    v_fmac_f32 v36, v38, v38
    v_sub_f32 v38, v35, v37
    v_fmac_f32 v36, v38, v38
    s_mov_b64 exec, -1
    s_nop 1
    v_add_f32_dpp v36, v36, v36 row_shr:1 row_mask:0xf bank_mask:0xf
    s_nop 1
    v_add_f32_dpp v36, v36, v36 row_shr:2 row_mask:0xf bank_mask:0xf
    s_nop 1
    v_add_f32_dpp v36, v36, v36 row_shr:4 row_mask:0xf bank_mask:0xf
    s_nop 1
    v_add_f32_dpp v36, v36, v36 row_shr:8 row_mask:0xf bank_mask:0xf
    s_nop 1
    v_add_f32_dpp v36, v36, v36 row_bcast:15 row_mask:0xa bank_mask:0xf
    s_nop 1
    v_add_f32_dpp v36, v36, v36 row_bcast:31 row_mask:0xc bank_mask:0xf
    s_nop 0
    v_readlane_b32 s34, v36, 63
    s_nop 1
    v_mov_b32 v38, s34
    v_mul_f32 v38, 0x3ae38e39, v38
    v_cvt_pk_bf16_f32 v39, v37, v38
    v_lshlrev_b32 v37, 16, v39
    v_and_b32 v38, 0xffff0000, v39
    v_add_f32 v38, 0x3727c5ac, v38
    v_cvt_pk_bf16_f32 v39, v38, v38
    v_lshlrev_b32 v38, 16, v39
    v_sqrt_f32 v38, v38
    s_nop 0
    v_cvt_pk_bf16_f32 v39, v38, v38
    v_lshlrev_b32 v38, 16, v39
    v_rcp_f32 v39, v38
    s_nop 0
    v_sub_f32 v40, v20, v37
    v_sub_f32 v41, v21, v37
    v_cvt_pk_bf16_f32 v42, v40, v41
    v_lshlrev_b32 v40, 16, v42
    v_and_b32 v41, 0xffff0000, v42
    v_mul_f32 v42, v40, v39
    v_mul_f32 v43, v41, v39
    v_fma_f32 v44, -v42, v38, v40
    v_fma_f32 v45, -v43, v38, v41
    v_fma_f32 v42, v44, v39, v42
    v_fma_f32 v43, v45, v39, v43
    v_cvt_pk_bf16_f32 v4, v42, v43
    v_sub_f32 v40, v22, v37
    v_sub_f32 v41, v23, v37
    v_cvt_pk_bf16_f32 v42, v40, v41
    v_lshlrev_b32 v40, 16, v42
    v_and_b32 v41, 0xffff0000, v42
    v_mul_f32 v42, v40, v39
    v_mul_f32 v43, v41, v39
    v_fma_f32 v44, -v42, v38, v40
    v_fma_f32 v45, -v43, v38, v41
    v_fma_f32 v42, v44, v39, v42
    v_fma_f32 v43, v45, v39, v43
    v_cvt_pk_bf16_f32 v5, v42, v43
    v_sub_f32 v40, v24, v37
    v_sub_f32 v41, v25, v37
    v_cvt_pk_bf16_f32 v42, v40, v41
    v_lshlrev_b32 v40, 16, v42
    v_and_b32 v41, 0xffff0000, v42
    v_mul_f32 v42, v40, v39
    v_mul_f32 v43, v41, v39
    v_fma_f32 v44, -v42, v38, v40
    v_fma_f32 v45, -v43, v38, v41
    v_fma_f32 v42, v44, v39, v42
    v_fma_f32 v43, v45, v39, v43
    v_cvt_pk_bf16_f32 v6, v42, v43
    v_sub_f32 v40, v26, v37
    v_sub_f32 v41, v27, v37
    v_cvt_pk_bf16_f32 v42, v40, v41
    v_lshlrev_b32 v40, 16, v42
    v_and_b32 v41, 0xffff0000, v42
    v_mul_f32 v42, v40, v39
    v_mul_f32 v43, v41, v39
    v_fma_f32 v44, -v42, v38, v40
    v_fma_f32 v45, -v43, v38, v41
    v_fma_f32 v42, v44, v39, v42
    v_fma_f32 v43, v45, v39, v43
    v_cvt_pk_bf16_f32 v7, v42, v43
    v_sub_f32 v40, v28, v37
    v_sub_f32 v41, v29, v37
    v_cvt_pk_bf16_f32 v42, v40, v41
    v_lshlrev_b32 v40, 16, v42
    v_and_b32 v41, 0xffff0000, v42
    v_mul_f32 v42, v40, v39
    v_mul_f32 v43, v41, v39
    v_fma_f32 v44, -v42, v38, v40
    v_fma_f32 v45, -v43, v38, v41
    v_fma_f32 v42, v44, v39, v42
    v_fma_f32 v43, v45, v39, v43
    v_cvt_pk_bf16_f32 v12, v42, v43
    v_sub_f32 v40, v30, v37
    v_sub_f32 v41, v31, v37
    v_cvt_pk_bf16_f32 v42, v40, v41
    v_lshlrev_b32 v40, 16, v42
    v_and_b32 v41, 0xffff0000, v42
    v_mul_f32 v42, v40, v39
    v_mul_f32 v43, v41, v39
    v_fma_f32 v44, -v42, v38, v40
    v_fma_f32 v45, -v43, v38, v41
    v_fma_f32 v42, v44, v39, v42
    v_fma_f32 v43, v45, v39, v43
    v_cvt_pk_bf16_f32 v13, v42, v43
    v_sub_f32 v40, v32, v37
    v_sub_f32 v41, v33, v37
    v_cvt_pk_bf16_f32 v42, v40, v41
    v_lshlrev_b32 v40, 16, v42
    v_and_b32 v41, 0xffff0000, v42
    v_mul_f32 v42, v40, v39
    v_mul_f32 v43, v41, v39
    v_fma_f32 v44, -v42, v38, v40
    v_fma_f32 v45, -v43, v38, v41
    v_fma_f32 v42, v44, v39, v42
    v_fma_f32 v43, v45, v39, v43
    v_cvt_pk_bf16_f32 v14, v42, v43
    v_sub_f32 v40, v34, v37
    v_sub_f32 v41, v35, v37
    v_cvt_pk_bf16_f32 v42, v40, v41
    v_lshlrev_b32 v40, 16, v42
    v_and_b32 v41, 0xffff0000, v42
    v_mul_f32 v42, v40, v39
    v_mul_f32 v43, v41, v39
    v_fma_f32 v44, -v42, v38, v40
    v_fma_f32 v45, -v43, v38, v41
    v_fma_f32 v42, v44, v39, v42
    v_fma_f32 v43, v45, v39, v43
    v_cvt_pk_bf16_f32 v15, v42, v43
    buffer_store_dwordx4 v[4:7], v3, s[16:19], s11 offen
    s_mov_b64 exec, s[32:33]
    buffer_store_dwordx4 v[12:15], v3, s[16:19], s11 offen offset:1024
    s_mov_b64 exec, -1
ln2_kernel_end:
    s_endpgm
.section .rodata,"a"
.p2align 6
.amdhsa_kernel ln2_kernel
  .amdhsa_next_free_vgpr 64
  .amdhsa_next_free_sgpr 102
  .amdhsa_accum_offset 64
  .amdhsa_group_segment_fixed_size 0
  .amdhsa_kernarg_size 96
  .amdhsa_user_sgpr_count 2
  .amdhsa_user_sgpr_kernarg_segment_ptr 1
  .amdhsa_system_sgpr_workgroup_id_x 1
.end_amdhsa_kernel
.text
.globl g3_kernel
.p2align 8
.type g3_kernel,@function
g3_kernel:
    s_cmp_ge_u32 s2, 192
    s_cbranch_scc1 g3_kernel_end
    s_load_dwordx2 s[4:5], s[0:1], 88
    s_load_dwordx2 s[6:7], s[0:1], 56
    s_load_dwordx2 s[64:65], s[0:1], 88
    v_and_b32 v1, 63, v0
    v_lshrrev_b32 v4, 6, v0
    s_nop 0
    v_readfirstlane_b32 s24, v4
    s_lshl_b32 s25, s24, 10
    s_waitcnt lgkmcnt(0)
    s_and_b32 s28, s2, 7
    s_lshr_b32 s29, s2, 3
    s_mul_hi_u32 s30, s29, 0x15555556
    s_mul_i32 s31, s30, 12
    s_sub_u32 s31, s29, s31
    s_lshl_b32 s26, s28, 1
    s_add_u32 s26, s26, s30
    s_mul_hi_u32 s30, s31, 0x2aaaaaab
    s_mul_i32 s27, s30, 6
    s_sub_u32 s27, s31, s27
    s_load_dwordx2 s[6:7], s[0:1], 64
    s_cmp_eq_u32 s30, 0
    s_cbranch_scc1 g3_kernel_re
    s_waitcnt lgkmcnt(0)
    s_add_u32 s64, s64, 0x240000
    s_addc_u32 s65, s65, 0
    s_branch g3_kernel_go
g3_kernel_re:
    s_waitcnt lgkmcnt(0)
    s_load_dwordx2 s[6:7], s[0:1], 56
    s_waitcnt lgkmcnt(0)
g3_kernel_go:
    s_mov_b32 s8, s4
    s_mov_b32 s9, s5
    s_mov_b32 s10, 0x240000
    s_mov_b32 s11, 0x00020000
    s_mov_b32 s12, s6
    s_mov_b32 s13, s7
    s_mov_b32 s14, 0xa2000
    s_mov_b32 s15, 0x00020000
    s_add_u32 s16, s64, 0x1200000
    s_addc_u32 s17, s65, 0
    s_mov_b32 s18, 0x240000
    s_mov_b32 s19, 0x00020000
    v_lshrrev_b32 v4, 3, v1
    v_and_b32 v5, 7, v1
    v_xor_b32 v5, v5, v4
    v_lshlrev_b32 v5, 4, v5
    s_mov_b32 s28, 1152
    v_mul_lo_u32 v2, v4, s28
    v_add_u32 v2, v2, v5
    s_mov_b32 s28, 1152
    v_mul_lo_u32 v3, v4, s28
    v_add_u32 v3, v3, v5
    s_add_u32 s28, s24, 0
    s_lshl_b32 s29, s28, 3
    s_mul_i32 s30, s26, 128
    s_add_u32 s29, s29, s30
    s_mul_i32 s29, s29, 1152
    s_mov_b32 s32, s29
    s_add_u32 s28, s24, 4
    s_lshl_b32 s29, s28, 3
    s_mul_i32 s30, s26, 128
    s_add_u32 s29, s29, s30
    s_mul_i32 s29, s29, 1152
    s_mov_b32 s33, s29
    s_add_u32 s28, s24, 8
    s_lshl_b32 s29, s28, 3
    s_mul_i32 s30, s26, 128
    s_add_u32 s29, s29, s30
    s_mul_i32 s29, s29, 1152
    s_mov_b32 s34, s29
    s_add_u32 s28, s24, 12
    s_lshl_b32 s29, s28, 3
    s_mul_i32 s30, s26, 128
    s_add_u32 s29, s29, s30
    s_mul_i32 s29, s29, 1152
    s_mov_b32 s35, s29
    s_add_u32 s28, s24, 0
    s_lshl_b32 s29, s28, 3
    s_mul_i32 s30, s27, 96
    s_add_u32 s29, s29, s30
    s_mul_i32 s29, s29, 1152
    s_mov_b32 s48, s29
    s_add_u32 s28, s24, 4
    s_lshl_b32 s29, s28, 3
    s_mul_i32 s30, s27, 96
    s_add_u32 s29, s29, s30
    s_mul_i32 s29, s29, 1152
    s_mov_b32 s49, s29
    s_add_u32 s28, s24, 8
    s_lshl_b32 s29, s28, 3
    s_mul_i32 s30, s27, 96
    s_add_u32 s29, s29, s30
    s_mul_i32 s29, s29, 1152
    s_mov_b32 s50, s29
    s_and_b32 s28, s24, 1
    s_lshr_b32 s29, s24, 1
    s_mul_i32 s28, s28, 8192
    s_mul_i32 s29, s29, 6144
    v_and_b32 v4, 15, v1
    v_lshlrev_b32 v4, 7, v4
    v_lshrrev_b32 v5, 4, v1
    v_and_b32 v6, 7, v1
    v_xor_b32 v5, v5, v6
    v_lshl_add_u32 v4, v5, 4, v4
    v_add_u32 v6, s28, v4
    v_xor_b32 v7, 64, v6
    v_add_u32 v8, 0x10000, v6
    v_add_u32 v9, 0x10000, v7
    v_add_u32 v10, s29, v4
    v_xor_b32 v11, 64, v10
    v_add_u32 v12, 0x10000, v10
    v_add_u32 v13, 0x10000, v11
    v_mov_b32 v16, 0
    v_mov_b32 v17, 0
    v_mov_b32 v18, 0
    v_mov_b32 v19, 0
    v_mov_b32 v20, 0
    v_mov_b32 v21, 0
    v_mov_b32 v22, 0
    v_mov_b32 v23, 0
    v_mov_b32 v24, 0
    v_mov_b32 v25, 0
    v_mov_b32 v26, 0
    v_mov_b32 v27, 0
    v_mov_b32 v28, 0
    v_mov_b32 v29, 0
    v_mov_b32 v30, 0
    v_mov_b32 v31, 0
    v_mov_b32 v32, 0
    v_mov_b32 v33, 0
    v_mov_b32 v34, 0
    v_mov_b32 v35, 0
    v_mov_b32 v36, 0
    v_mov_b32 v37, 0
    v_mov_b32 v38, 0
    v_mov_b32 v39, 0
    v_mov_b32 v40, 0
    v_mov_b32 v41, 0
    v_mov_b32 v42, 0
    v_mov_b32 v43, 0
    v_mov_b32 v44, 0
    v_mov_b32 v45, 0
    v_mov_b32 v46, 0
    v_mov_b32 v47, 0
    v_mov_b32 v48, 0
    v_mov_b32 v49, 0
    v_mov_b32 v50, 0
    v_mov_b32 v51, 0
    v_mov_b32 v52, 0
    v_mov_b32 v53, 0
    v_mov_b32 v54, 0
    v_mov_b32 v55, 0
    v_mov_b32 v56, 0
    v_mov_b32 v57, 0
    v_mov_b32 v58, 0
    v_mov_b32 v59, 0
    v_mov_b32 v60, 0
    v_mov_b32 v61, 0
    v_mov_b32 v62, 0
    v_mov_b32 v63, 0
    s_add_u32 m0, s25, 0
    s_nop 0
    buffer_load_dwordx4 v2, s[8:11], s32 offen lds
    s_add_u32 m0, s25, 4096
    s_nop 0
    buffer_load_dwordx4 v2, s[8:11], s33 offen lds
    s_add_u32 m0, s25, 8192
    s_nop 0
    buffer_load_dwordx4 v2, s[8:11], s34 offen lds
    s_add_u32 m0, s25, 12288
    s_nop 0
    buffer_load_dwordx4 v2, s[8:11], s35 offen lds
    s_add_u32 m0, s25, 16384
    s_nop 0
    buffer_load_dwordx4 v3, s[12:15], s48 offen lds
    s_add_u32 m0, s25, 20480
    s_nop 0
    buffer_load_dwordx4 v3, s[12:15], s49 offen lds
    s_add_u32 m0, s25, 24576
    s_nop 0
    buffer_load_dwordx4 v3, s[12:15], s50 offen lds
    s_add_u32 s8, s8, 128
    s_addc_u32 s9, s9, 0
    s_add_u32 s12, s12, 128
    s_addc_u32 s13, s13, 0
    s_add_u32 m0, s25, 28672
    s_nop 0
    buffer_load_dwordx4 v2, s[8:11], s32 offen lds
    s_add_u32 m0, s25, 32768
    s_nop 0
    buffer_load_dwordx4 v2, s[8:11], s33 offen lds
    s_add_u32 m0, s25, 36864
    s_nop 0
    buffer_load_dwordx4 v2, s[8:11], s34 offen lds
    s_add_u32 m0, s25, 40960
    s_nop 0
    buffer_load_dwordx4 v2, s[8:11], s35 offen lds
    s_add_u32 m0, s25, 45056
    s_nop 0
    buffer_load_dwordx4 v3, s[12:15], s48 offen lds
    s_add_u32 m0, s25, 49152
    s_nop 0
    buffer_load_dwordx4 v3, s[12:15], s49 offen lds
    s_add_u32 m0, s25, 53248
    s_nop 0
    buffer_load_dwordx4 v3, s[12:15], s50 offen lds
    s_add_u32 s8, s8, 128
    s_addc_u32 s9, s9, 0
    s_add_u32 s12, s12, 128
    s_addc_u32 s13, s13, 0
    s_add_u32 m0, s25, 57344
    s_nop 0
    buffer_load_dwordx4 v2, s[8:11], s32 offen lds
    s_add_u32 m0, s25, 61440
    s_nop 0
    buffer_load_dwordx4 v2, s[8:11], s33 offen lds
    s_add_u32 m0, s25, 65536
    s_nop 0
    buffer_load_dwordx4 v2, s[8:11], s34 offen lds
    s_add_u32 m0, s25, 69632
    s_nop 0
    buffer_load_dwordx4 v2, s[8:11], s35 offen lds
    s_add_u32 m0, s25, 73728
    s_nop 0
    buffer_load_dwordx4 v3, s[12:15], s48 offen lds
    s_add_u32 m0, s25, 77824
    s_nop 0
    buffer_load_dwordx4 v3, s[12:15], s49 offen lds
    s_add_u32 m0, s25, 81920
    s_nop 0
    buffer_load_dwordx4 v3, s[12:15], s50 offen lds
    s_add_u32 s8, s8, 128
    s_addc_u32 s9, s9, 0
    s_add_u32 s12, s12, 128
    s_addc_u32 s13, s13, 0
    s_add_u32 m0, s25, 86016
    s_nop 0
    buffer_load_dwordx4 v2, s[8:11], s32 offen lds
    s_add_u32 m0, s25, 90112
    s_nop 0
    buffer_load_dwordx4 v2, s[8:11], s33 offen lds
    s_add_u32 m0, s25, 94208
    s_nop 0
    buffer_load_dwordx4 v2, s[8:11], s34 offen lds
    s_add_u32 m0, s25, 98304
    s_nop 0
    buffer_load_dwordx4 v2, s[8:11], s35 offen lds
    s_add_u32 m0, s25, 102400
    s_nop 0
    buffer_load_dwordx4 v3, s[12:15], s48 offen lds
    s_add_u32 m0, s25, 106496
    s_nop 0
    buffer_load_dwordx4 v3, s[12:15], s49 offen lds
    s_add_u32 m0, s25, 110592
    s_nop 0
    buffer_load_dwordx4 v3, s[12:15], s50 offen lds
    s_add_u32 s8, s8, 128
    s_addc_u32 s9, s9, 0
    s_add_u32 s12, s12, 128
    s_addc_u32 s13, s13, 0
    s_waitcnt vmcnt(21)
    s_barrier
    ds_read_b128 v[64:67], v6 offset:0
    ds_read_b128 v[68:71], v6 offset:2048
    ds_read_b128 v[72:75], v6 offset:4096
    ds_read_b128 v[76:79], v6 offset:6144
    ds_read_b128 v[80:83], v10 offset:16384
    ds_read_b128 v[84:87], v10 offset:18432
    ds_read_b128 v[88:91], v10 offset:20480
    ds_read_b128 v[92:95], v7 offset:0
    ds_read_b128 v[96:99], v7 offset:2048
    ds_read_b128 v[100:103], v7 offset:4096
    ds_read_b128 v[104:107], v7 offset:6144
    ds_read_b128 v[108:111], v11 offset:16384
    ds_read_b128 v[112:115], v11 offset:18432
    ds_read_b128 v[116:119], v11 offset:20480
    s_waitcnt lgkmcnt(7)
    v_mfma_f32_16x16x32_bf16 v[16:19], v[64:67], v[80:83], v[16:19]
    v_mfma_f32_16x16x32_bf16 v[20:23], v[64:67], v[84:87], v[20:23]
    v_mfma_f32_16x16x32_bf16 v[24:27], v[64:67], v[88:91], v[24:27]
    v_mfma_f32_16x16x32_bf16 v[28:31], v[68:71], v[80:83], v[28:31]
    v_mfma_f32_16x16x32_bf16 v[32:35], v[68:71], v[84:87], v[32:35]
    v_mfma_f32_16x16x32_bf16 v[36:39], v[68:71], v[88:91], v[36:39]
    v_mfma_f32_16x16x32_bf16 v[40:43], v[72:75], v[80:83], v[40:43]
    v_mfma_f32_16x16x32_bf16 v[44:47], v[72:75], v[84:87], v[44:47]
    v_mfma_f32_16x16x32_bf16 v[48:51], v[72:75], v[88:91], v[48:51]
    v_mfma_f32_16x16x32_bf16 v[52:55], v[76:79], v[80:83], v[52:55]
    v_mfma_f32_16x16x32_bf16 v[56:59], v[76:79], v[84:87], v[56:59]
    v_mfma_f32_16x16x32_bf16 v[60:63], v[76:79], v[88:91], v[60:63]
    s_waitcnt lgkmcnt(0)
    s_waitcnt vmcnt(14)
    s_barrier
    ds_read_b128 v[64:67], v6 offset:28672
    ds_read_b128 v[68:71], v6 offset:30720
    ds_read_b128 v[72:75], v6 offset:32768
    ds_read_b128 v[76:79], v6 offset:34816
    ds_read_b128 v[80:83], v10 offset:45056
    ds_read_b128 v[84:87], v10 offset:47104
    ds_read_b128 v[88:91], v10 offset:49152
    s_add_u32 m0, s25, 0
    s_nop 0
    buffer_load_dwordx4 v2, s[8:11], s32 offen lds
    v_mfma_f32_16x16x32_bf16 v[16:19], v[92:95], v[108:111], v[16:19]
    s_add_u32 m0, s25, 4096
    s_nop 0
    buffer_load_dwordx4 v2, s[8:11], s33 offen lds
    v_mfma_f32_16x16x32_bf16 v[20:23], v[92:95], v[112:115], v[20:23]
    s_add_u32 m0, s25, 8192
    s_nop 0
    buffer_load_dwordx4 v2, s[8:11], s34 offen lds
    v_mfma_f32_16x16x32_bf16 v[24:27], v[92:95], v[116:119], v[24:27]
    s_add_u32 m0, s25, 12288
    s_nop 0
    buffer_load_dwordx4 v2, s[8:11], s35 offen lds
    v_mfma_f32_16x16x32_bf16 v[28:31], v[96:99], v[108:111], v[28:31]
    s_add_u32 m0, s25, 16384
    s_nop 0
    buffer_load_dwordx4 v3, s[12:15], s48 offen lds
    v_mfma_f32_16x16x32_bf16 v[32:35], v[96:99], v[112:115], v[32:35]
    s_add_u32 m0, s25, 20480
    s_nop 0
    buffer_load_dwordx4 v3, s[12:15], s49 offen lds
    v_mfma_f32_16x16x32_bf16 v[36:39], v[96:99], v[116:119], v[36:39]
    s_add_u32 m0, s25, 24576
    s_nop 0
    buffer_load_dwordx4 v3, s[12:15], s50 offen lds
    v_mfma_f32_16x16x32_bf16 v[40:43], v[100:103], v[108:111], v[40:43]
    s_add_u32 s8, s8, 128
    s_addc_u32 s9, s9, 0
    s_add_u32 s12, s12, 128
    s_addc_u32 s13, s13, 0
    v_mfma_f32_16x16x32_bf16 v[44:47], v[100:103], v[112:115], v[44:47]
    v_mfma_f32_16x16x32_bf16 v[48:51], v[100:103], v[116:119], v[48:51]
    v_mfma_f32_16x16x32_bf16 v[52:55], v[104:107], v[108:111], v[52:55]
    v_mfma_f32_16x16x32_bf16 v[56:59], v[104:107], v[112:115], v[56:59]
    v_mfma_f32_16x16x32_bf16 v[60:63], v[104:107], v[116:119], v[60:63]
    ds_read_b128 v[92:95], v7 offset:28672
    ds_read_b128 v[96:99], v7 offset:30720
    ds_read_b128 v[100:103], v7 offset:32768
    ds_read_b128 v[104:107], v7 offset:34816
    ds_read_b128 v[108:111], v11 offset:45056
    ds_read_b128 v[112:115], v11 offset:47104
    ds_read_b128 v[116:119], v11 offset:49152
    s_waitcnt lgkmcnt(7)
    v_mfma_f32_16x16x32_bf16 v[16:19], v[64:67], v[80:83], v[16:19]
    v_mfma_f32_16x16x32_bf16 v[20:23], v[64:67], v[84:87], v[20:23]
    v_mfma_f32_16x16x32_bf16 v[24:27], v[64:67], v[88:91], v[24:27]
    v_mfma_f32_16x16x32_bf16 v[28:31], v[68:71], v[80:83], v[28:31]
    v_mfma_f32_16x16x32_bf16 v[32:35], v[68:71], v[84:87], v[32:35]
    v_mfma_f32_16x16x32_bf16 v[36:39], v[68:71], v[88:91], v[36:39]
    v_mfma_f32_16x16x32_bf16 v[40:43], v[72:75], v[80:83], v[40:43]
    v_mfma_f32_16x16x32_bf16 v[44:47], v[72:75], v[84:87], v[44:47]
    v_mfma_f32_16x16x32_bf16 v[48:51], v[72:75], v[88:91], v[48:51]
    v_mfma_f32_16x16x32_bf16 v[52:55], v[76:79], v[80:83], v[52:55]
    v_mfma_f32_16x16x32_bf16 v[56:59], v[76:79], v[84:87], v[56:59]
    v_mfma_f32_16x16x32_bf16 v[60:63], v[76:79], v[88:91], v[60:63]
    s_waitcnt lgkmcnt(0)
    s_waitcnt vmcnt(14)
    s_barrier
    ds_read_b128 v[64:67], v6 offset:57344
    ds_read_b128 v[68:71], v6 offset:59392
    ds_read_b128 v[72:75], v6 offset:61440
    ds_read_b128 v[76:79], v6 offset:63488
    ds_read_b128 v[80:83], v12 offset:8192
    ds_read_b128 v[84:87], v12 offset:10240
    ds_read_b128 v[88:91], v12 offset:12288
    s_add_u32 m0, s25, 28672
    s_nop 0
    buffer_load_dwordx4 v2, s[8:11], s32 offen lds
    v_mfma_f32_16x16x32_bf16 v[16:19], v[92:95], v[108:111], v[16:19]
    s_add_u32 m0, s25, 32768
    s_nop 0
    buffer_load_dwordx4 v2, s[8:11], s33 offen lds
    v_mfma_f32_16x16x32_bf16 v[20:23], v[92:95], v[112:115], v[20:23]
    s_add_u32 m0, s25, 36864
    s_nop 0
    buffer_load_dwordx4 v2, s[8:11], s34 offen lds
    v_mfma_f32_16x16x32_bf16 v[24:27], v[92:95], v[116:119], v[24:27]
    s_add_u32 m0, s25, 40960
    s_nop 0
    buffer_load_dwordx4 v2, s[8:11], s35 offen lds
    v_mfma_f32_16x16x32_bf16 v[28:31], v[96:99], v[108:111], v[28:31]
    s_add_u32 m0, s25, 45056
    s_nop 0
    buffer_load_dwordx4 v3, s[12:15], s48 offen lds
    v_mfma_f32_16x16x32_bf16 v[32:35], v[96:99], v[112:115], v[32:35]
    s_add_u32 m0, s25, 49152
    s_nop 0
    buffer_load_dwordx4 v3, s[12:15], s49 offen lds
    v_mfma_f32_16x16x32_bf16 v[36:39], v[96:99], v[116:119], v[36:39]
    s_add_u32 m0, s25, 53248
    s_nop 0
    buffer_load_dwordx4 v3, s[12:15], s50 offen lds
    v_mfma_f32_16x16x32_bf16 v[40:43], v[100:103], v[108:111], v[40:43]
    s_add_u32 s8, s8, 128
    s_addc_u32 s9, s9, 0
    s_add_u32 s12, s12, 128
    s_addc_u32 s13, s13, 0
    v_mfma_f32_16x16x32_bf16 v[44:47], v[100:103], v[112:115], v[44:47]
    v_mfma_f32_16x16x32_bf16 v[48:51], v[100:103], v[116:119], v[48:51]
    v_mfma_f32_16x16x32_bf16 v[52:55], v[104:107], v[108:111], v[52:55]
    v_mfma_f32_16x16x32_bf16 v[56:59], v[104:107], v[112:115], v[56:59]
    v_mfma_f32_16x16x32_bf16 v[60:63], v[104:107], v[116:119], v[60:63]
    ds_read_b128 v[92:95], v7 offset:57344
    ds_read_b128 v[96:99], v7 offset:59392
    ds_read_b128 v[100:103], v7 offset:61440
    ds_read_b128 v[104:107], v7 offset:63488
    ds_read_b128 v[108:111], v13 offset:8192
    ds_read_b128 v[112:115], v13 offset:10240
    ds_read_b128 v[116:119], v13 offset:12288
    s_waitcnt lgkmcnt(7)
    v_mfma_f32_16x16x32_bf16 v[16:19], v[64:67], v[80:83], v[16:19]
    v_mfma_f32_16x16x32_bf16 v[20:23], v[64:67], v[84:87], v[20:23]
    v_mfma_f32_16x16x32_bf16 v[24:27], v[64:67], v[88:91], v[24:27]
    v_mfma_f32_16x16x32_bf16 v[28:31], v[68:71], v[80:83], v[28:31]
    v_mfma_f32_16x16x32_bf16 v[32:35], v[68:71], v[84:87], v[32:35]
    v_mfma_f32_16x16x32_bf16 v[36:39], v[68:71], v[88:91], v[36:39]
    v_mfma_f32_16x16x32_bf16 v[40:43], v[72:75], v[80:83], v[40:43]
    v_mfma_f32_16x16x32_bf16 v[44:47], v[72:75], v[84:87], v[44:47]
    v_mfma_f32_16x16x32_bf16 v[48:51], v[72:75], v[88:91], v[48:51]
    v_mfma_f32_16x16x32_bf16 v[52:55], v[76:79], v[80:83], v[52:55]
    v_mfma_f32_16x16x32_bf16 v[56:59], v[76:79], v[84:87], v[56:59]
    v_mfma_f32_16x16x32_bf16 v[60:63], v[76:79], v[88:91], v[60:63]
    s_waitcnt lgkmcnt(0)
    s_waitcnt vmcnt(14)
    s_barrier
    ds_read_b128 v[64:67], v8 offset:20480
    ds_read_b128 v[68:71], v8 offset:22528
    ds_read_b128 v[72:75], v8 offset:24576
    ds_read_b128 v[76:79], v8 offset:26624
    ds_read_b128 v[80:83], v12 offset:36864
    ds_read_b128 v[84:87], v12 offset:38912
    ds_read_b128 v[88:91], v12 offset:40960
    s_add_u32 m0, s25, 57344
    s_nop 0
    buffer_load_dwordx4 v2, s[8:11], s32 offen lds
    v_mfma_f32_16x16x32_bf16 v[16:19], v[92:95], v[108:111], v[16:19]
    s_add_u32 m0, s25, 61440
    s_nop 0
    buffer_load_dwordx4 v2, s[8:11], s33 offen lds
    v_mfma_f32_16x16x32_bf16 v[20:23], v[92:95], v[112:115], v[20:23]
    s_add_u32 m0, s25, 65536
    s_nop 0
    buffer_load_dwordx4 v2, s[8:11], s34 offen lds
    v_mfma_f32_16x16x32_bf16 v[24:27], v[92:95], v[116:119], v[24:27]
    s_add_u32 m0, s25, 69632
    s_nop 0
    buffer_load_dwordx4 v2, s[8:11], s35 offen lds
    v_mfma_f32_16x16x32_bf16 v[28:31], v[96:99], v[108:111], v[28:31]
    s_add_u32 m0, s25, 73728
    s_nop 0
    buffer_load_dwordx4 v3, s[12:15], s48 offen lds
    v_mfma_f32_16x16x32_bf16 v[32:35], v[96:99], v[112:115], v[32:35]
    s_add_u32 m0, s25, 77824
    s_nop 0
    buffer_load_dwordx4 v3, s[12:15], s49 offen lds
    v_mfma_f32_16x16x32_bf16 v[36:39], v[96:99], v[116:119], v[36:39]
    s_add_u32 m0, s25, 81920
    s_nop 0
    buffer_load_dwordx4 v3, s[12:15], s50 offen lds
    v_mfma_f32_16x16x32_bf16 v[40:43], v[100:103], v[108:111], v[40:43]
    s_add_u32 s8, s8, 128
    s_addc_u32 s9, s9, 0
    s_add_u32 s12, s12, 128
    s_addc_u32 s13, s13, 0
    v_mfma_f32_16x16x32_bf16 v[44:47], v[100:103], v[112:115], v[44:47]
    v_mfma_f32_16x16x32_bf16 v[48:51], v[100:103], v[116:119], v[48:51]
    v_mfma_f32_16x16x32_bf16 v[52:55], v[104:107], v[108:111], v[52:55]
    v_mfma_f32_16x16x32_bf16 v[56:59], v[104:107], v[112:115], v[56:59]
    v_mfma_f32_16x16x32_bf16 v[60:63], v[104:107], v[116:119], v[60:63]
    ds_read_b128 v[92:95], v9 offset:20480
    ds_read_b128 v[96:99], v9 offset:22528
    ds_read_b128 v[100:103], v9 offset:24576
    ds_read_b128 v[104:107], v9 offset:26624
    ds_read_b128 v[108:111], v13 offset:36864
    ds_read_b128 v[112:115], v13 offset:38912
    ds_read_b128 v[116:119], v13 offset:40960
    s_waitcnt lgkmcnt(7)
    v_mfma_f32_16x16x32_bf16 v[16:19], v[64:67], v[80:83], v[16:19]
    v_mfma_f32_16x16x32_bf16 v[20:23], v[64:67], v[84:87], v[20:23]
    v_mfma_f32_16x16x32_bf16 v[24:27], v[64:67], v[88:91], v[24:27]
    v_mfma_f32_16x16x32_bf16 v[28:31], v[68:71], v[80:83], v[28:31]
    v_mfma_f32_16x16x32_bf16 v[32:35], v[68:71], v[84:87], v[32:35]
    v_mfma_f32_16x16x32_bf16 v[36:39], v[68:71], v[88:91], v[36:39]
    v_mfma_f32_16x16x32_bf16 v[40:43], v[72:75], v[80:83], v[40:43]
    v_mfma_f32_16x16x32_bf16 v[44:47], v[72:75], v[84:87], v[44:47]
    v_mfma_f32_16x16x32_bf16 v[48:51], v[72:75], v[88:91], v[48:51]
    v_mfma_f32_16x16x32_bf16 v[52:55], v[76:79], v[80:83], v[52:55]
    v_mfma_f32_16x16x32_bf16 v[56:59], v[76:79], v[84:87], v[56:59]
    v_mfma_f32_16x16x32_bf16 v[60:63], v[76:79], v[88:91], v[60:63]
    s_waitcnt lgkmcnt(0)
    s_waitcnt vmcnt(14)
    s_barrier
    ds_read_b128 v[64:67], v6 offset:0
    ds_read_b128 v[68:71], v6 offset:2048
    ds_read_b128 v[72:75], v6 offset:4096
    ds_read_b128 v[76:79], v6 offset:6144
    ds_read_b128 v[80:83], v10 offset:16384
    ds_read_b128 v[84:87], v10 offset:18432
    ds_read_b128 v[88:91], v10 offset:20480
    s_add_u32 m0, s25, 86016
    s_nop 0
    buffer_load_dwordx4 v2, s[8:11], s32 offen lds
    v_mfma_f32_16x16x32_bf16 v[16:19], v[92:95], v[108:111], v[16:19]
    s_add_u32 m0, s25, 90112
    s_nop 0
    buffer_load_dwordx4 v2, s[8:11], s33 offen lds
    v_mfma_f32_16x16x32_bf16 v[20:23], v[92:95], v[112:115], v[20:23]
    s_add_u32 m0, s25, 94208
    s_nop 0
    buffer_load_dwordx4 v2, s[8:11], s34 offen lds
    v_mfma_f32_16x16x32_bf16 v[24:27], v[92:95], v[116:119], v[24:27]
    s_add_u32 m0, s25, 98304
    s_nop 0
    buffer_load_dwordx4 v2, s[8:11], s35 offen lds
    v_mfma_f32_16x16x32_bf16 v[28:31], v[96:99], v[108:111], v[28:31]
    s_add_u32 m0, s25, 102400
    s_nop 0
    buffer_load_dwordx4 v3, s[12:15], s48 offen lds
    v_mfma_f32_16x16x32_bf16 v[32:35], v[96:99], v[112:115], v[32:35]
    s_add_u32 m0, s25, 106496
    s_nop 0
    buffer_load_dwordx4 v3, s[12:15], s49 offen lds
    v_mfma_f32_16x16x32_bf16 v[36:39], v[96:99], v[116:119], v[36:39]
    s_add_u32 m0, s25, 110592
    s_nop 0
    buffer_load_dwordx4 v3, s[12:15], s50 offen lds
    v_mfma_f32_16x16x32_bf16 v[40:43], v[100:103], v[108:111], v[40:43]
    s_add_u32 s8, s8, 128
    s_addc_u32 s9, s9, 0
    s_add_u32 s12, s12, 128
    s_addc_u32 s13, s13, 0
    v_mfma_f32_16x16x32_bf16 v[44:47], v[100:103], v[112:115], v[44:47]
    v_mfma_f32_16x16x32_bf16 v[48:51], v[100:103], v[116:119], v[48:51]
    v_mfma_f32_16x16x32_bf16 v[52:55], v[104:107], v[108:111], v[52:55]
    v_mfma_f32_16x16x32_bf16 v[56:59], v[104:107], v[112:115], v[56:59]
    v_mfma_f32_16x16x32_bf16 v[60:63], v[104:107], v[116:119], v[60:63]
    ds_read_b128 v[92:95], v7 offset:0
    ds_read_b128 v[96:99], v7 offset:2048
    ds_read_b128 v[100:103], v7 offset:4096
    ds_read_b128 v[104:107], v7 offset:6144
    ds_read_b128 v[108:111], v11 offset:16384
    ds_read_b128 v[112:115], v11 offset:18432
    ds_read_b128 v[116:119], v11 offset:20480
    s_waitcnt lgkmcnt(7)
    v_mfma_f32_16x16x32_bf16 v[16:19], v[64:67], v[80:83], v[16:19]
    v_mfma_f32_16x16x32_bf16 v[20:23], v[64:67], v[84:87], v[20:23]
    v_mfma_f32_16x16x32_bf16 v[24:27], v[64:67], v[88:91], v[24:27]
    v_mfma_f32_16x16x32_bf16 v[28:31], v[68:71], v[80:83], v[28:31]
    v_mfma_f32_16x16x32_bf16 v[32:35], v[68:71], v[84:87], v[32:35]
    v_mfma_f32_16x16x32_bf16 v[36:39], v[68:71], v[88:91], v[36:39]
    v_mfma_f32_16x16x32_bf16 v[40:43], v[72:75], v[80:83], v[40:43]
    v_mfma_f32_16x16x32_bf16 v[44:47], v[72:75], v[84:87], v[44:47]
    v_mfma_f32_16x16x32_bf16 v[48:51], v[72:75], v[88:91], v[48:51]
    v_mfma_f32_16x16x32_bf16 v[52:55], v[76:79], v[80:83], v[52:55]
    v_mfma_f32_16x16x32_bf16 v[56:59], v[76:79], v[84:87], v[56:59]
    v_mfma_f32_16x16x32_bf16 v[60:63], v[76:79], v[88:91], v[60:63]
    s_waitcnt lgkmcnt(0)
    s_waitcnt vmcnt(14)
    s_barrier
    ds_read_b128 v[64:67], v6 offset:28672
    ds_read_b128 v[68:71], v6 offset:30720
    ds_read_b128 v[72:75], v6 offset:32768
    ds_read_b128 v[76:79], v6 offset:34816
    ds_read_b128 v[80:83], v10 offset:45056
    ds_read_b128 v[84:87], v10 offset:47104
    ds_read_b128 v[88:91], v10 offset:49152
    s_add_u32 m0, s25, 0
    s_nop 0
    buffer_load_dwordx4 v2, s[8:11], s32 offen lds
    v_mfma_f32_16x16x32_bf16 v[16:19], v[92:95], v[108:111], v[16:19]
    s_add_u32 m0, s25, 4096
    s_nop 0
    buffer_load_dwordx4 v2, s[8:11], s33 offen lds
    v_mfma_f32_16x16x32_bf16 v[20:23], v[92:95], v[112:115], v[20:23]
    s_add_u32 m0, s25, 8192
    s_nop 0
    buffer_load_dwordx4 v2, s[8:11], s34 offen lds
    v_mfma_f32_16x16x32_bf16 v[24:27], v[92:95], v[116:119], v[24:27]
    s_add_u32 m0, s25, 12288
    s_nop 0
    buffer_load_dwordx4 v2, s[8:11], s35 offen lds
    v_mfma_f32_16x16x32_bf16 v[28:31], v[96:99], v[108:111], v[28:31]
    s_add_u32 m0, s25, 16384
    s_nop 0
    buffer_load_dwordx4 v3, s[12:15], s48 offen lds
    v_mfma_f32_16x16x32_bf16 v[32:35], v[96:99], v[112:115], v[32:35]
    s_add_u32 m0, s25, 20480
    s_nop 0
    buffer_load_dwordx4 v3, s[12:15], s49 offen lds
    v_mfma_f32_16x16x32_bf16 v[36:39], v[96:99], v[116:119], v[36:39]
    s_add_u32 m0, s25, 24576
    s_nop 0
    buffer_load_dwordx4 v3, s[12:15], s50 offen lds
    v_mfma_f32_16x16x32_bf16 v[40:43], v[100:103], v[108:111], v[40:43]
    s_add_u32 s8, s8, 128
    s_addc_u32 s9, s9, 0
    s_add_u32 s12, s12, 128
    s_addc_u32 s13, s13, 0
    v_mfma_f32_16x16x32_bf16 v[44:47], v[100:103], v[112:115], v[44:47]
    v_mfma_f32_16x16x32_bf16 v[48:51], v[100:103], v[116:119], v[48:51]
    v_mfma_f32_16x16x32_bf16 v[52:55], v[104:107], v[108:111], v[52:55]
    v_mfma_f32_16x16x32_bf16 v[56:59], v[104:107], v[112:115], v[56:59]
    v_mfma_f32_16x16x32_bf16 v[60:63], v[104:107], v[116:119], v[60:63]
    ds_read_b128 v[92:95], v7 offset:28672
    ds_read_b128 v[96:99], v7 offset:30720
    ds_read_b128 v[100:103], v7 offset:32768
    ds_read_b128 v[104:107], v7 offset:34816
    ds_read_b128 v[108:111], v11 offset:45056
    ds_read_b128 v[112:115], v11 offset:47104
    ds_read_b128 v[116:119], v11 offset:49152
    s_waitcnt lgkmcnt(7)
    v_mfma_f32_16x16x32_bf16 v[16:19], v[64:67], v[80:83], v[16:19]
    v_mfma_f32_16x16x32_bf16 v[20:23], v[64:67], v[84:87], v[20:23]
    v_mfma_f32_16x16x32_bf16 v[24:27], v[64:67], v[88:91], v[24:27]
    v_mfma_f32_16x16x32_bf16 v[28:31], v[68:71], v[80:83], v[28:31]
    v_mfma_f32_16x16x32_bf16 v[32:35], v[68:71], v[84:87], v[32:35]
    v_mfma_f32_16x16x32_bf16 v[36:39], v[68:71], v[88:91], v[36:39]
    v_mfma_f32_16x16x32_bf16 v[40:43], v[72:75], v[80:83], v[40:43]
    v_mfma_f32_16x16x32_bf16 v[44:47], v[72:75], v[84:87], v[44:47]
    v_mfma_f32_16x16x32_bf16 v[48:51], v[72:75], v[88:91], v[48:51]
    v_mfma_f32_16x16x32_bf16 v[52:55], v[76:79], v[80:83], v[52:55]
    v_mfma_f32_16x16x32_bf16 v[56:59], v[76:79], v[84:87], v[56:59]
    v_mfma_f32_16x16x32_bf16 v[60:63], v[76:79], v[88:91], v[60:63]
    s_waitcnt lgkmcnt(0)
    s_waitcnt vmcnt(14)
    s_barrier
    ds_read_b128 v[64:67], v6 offset:57344
    ds_read_b128 v[68:71], v6 offset:59392
    ds_read_b128 v[72:75], v6 offset:61440
    ds_read_b128 v[76:79], v6 offset:63488
    ds_read_b128 v[80:83], v12 offset:8192
    ds_read_b128 v[84:87], v12 offset:10240
    ds_read_b128 v[88:91], v12 offset:12288
    v_mfma_f32_16x16x32_bf16 v[16:19], v[92:95], v[108:111], v[16:19]
    v_mfma_f32_16x16x32_bf16 v[20:23], v[92:95], v[112:115], v[20:23]
    v_mfma_f32_16x16x32_bf16 v[24:27], v[92:95], v[116:119], v[24:27]
    v_mfma_f32_16x16x32_bf16 v[28:31], v[96:99], v[108:111], v[28:31]
    v_mfma_f32_16x16x32_bf16 v[32:35], v[96:99], v[112:115], v[32:35]
    v_mfma_f32_16x16x32_bf16 v[36:39], v[96:99], v[116:119], v[36:39]
    v_mfma_f32_16x16x32_bf16 v[40:43], v[100:103], v[108:111], v[40:43]
    v_mfma_f32_16x16x32_bf16 v[44:47], v[100:103], v[112:115], v[44:47]
    v_mfma_f32_16x16x32_bf16 v[48:51], v[100:103], v[116:119], v[48:51]
    v_mfma_f32_16x16x32_bf16 v[52:55], v[104:107], v[108:111], v[52:55]
    v_mfma_f32_16x16x32_bf16 v[56:59], v[104:107], v[112:115], v[56:59]
    v_mfma_f32_16x16x32_bf16 v[60:63], v[104:107], v[116:119], v[60:63]
    ds_read_b128 v[92:95], v7 offset:57344
    ds_read_b128 v[96:99], v7 offset:59392
    ds_read_b128 v[100:103], v7 offset:61440
    ds_read_b128 v[104:107], v7 offset:63488
    ds_read_b128 v[108:111], v13 offset:8192
    ds_read_b128 v[112:115], v13 offset:10240
    ds_read_b128 v[116:119], v13 offset:12288
    s_waitcnt lgkmcnt(7)
    v_mfma_f32_16x16x32_bf16 v[16:19], v[64:67], v[80:83], v[16:19]
    v_mfma_f32_16x16x32_bf16 v[20:23], v[64:67], v[84:87], v[20:23]
    v_mfma_f32_16x16x32_bf16 v[24:27], v[64:67], v[88:91], v[24:27]
    v_mfma_f32_16x16x32_bf16 v[28:31], v[68:71], v[80:83], v[28:31]
    v_mfma_f32_16x16x32_bf16 v[32:35], v[68:71], v[84:87], v[32:35]
    v_mfma_f32_16x16x32_bf16 v[36:39], v[68:71], v[88:91], v[36:39]
    v_mfma_f32_16x16x32_bf16 v[40:43], v[72:75], v[80:83], v[40:43]
    v_mfma_f32_16x16x32_bf16 v[44:47], v[72:75], v[84:87], v[44:47]
    v_mfma_f32_16x16x32_bf16 v[48:51], v[72:75], v[88:91], v[48:51]
    v_mfma_f32_16x16x32_bf16 v[52:55], v[76:79], v[80:83], v[52:55]
    v_mfma_f32_16x16x32_bf16 v[56:59], v[76:79], v[84:87], v[56:59]
    v_mfma_f32_16x16x32_bf16 v[60:63], v[76:79], v[88:91], v[60:63]
    s_waitcnt lgkmcnt(0)
    s_waitcnt vmcnt(7)
    s_barrier
    ds_read_b128 v[64:67], v8 offset:20480
    ds_read_b128 v[68:71], v8 offset:22528
    ds_read_b128 v[72:75], v8 offset:24576
    ds_read_b128 v[76:79], v8 offset:26624
    ds_read_b128 v[80:83], v12 offset:36864
    ds_read_b128 v[84:87], v12 offset:38912
    ds_read_b128 v[88:91], v12 offset:40960
    v_mfma_f32_16x16x32_bf16 v[16:19], v[92:95], v[108:111], v[16:19]
    v_mfma_f32_16x16x32_bf16 v[20:23], v[92:95], v[112:115], v[20:23]
    v_mfma_f32_16x16x32_bf16 v[24:27], v[92:95], v[116:119], v[24:27]
    v_mfma_f32_16x16x32_bf16 v[28:31], v[96:99], v[108:111], v[28:31]
    v_mfma_f32_16x16x32_bf16 v[32:35], v[96:99], v[112:115], v[32:35]
    v_mfma_f32_16x16x32_bf16 v[36:39], v[96:99], v[116:119], v[36:39]
    v_mfma_f32_16x16x32_bf16 v[40:43], v[100:103], v[108:111], v[40:43]
    v_mfma_f32_16x16x32_bf16 v[44:47], v[100:103], v[112:115], v[44:47]
    v_mfma_f32_16x16x32_bf16 v[48:51], v[100:103], v[116:119], v[48:51]
    v_mfma_f32_16x16x32_bf16 v[52:55], v[104:107], v[108:111], v[52:55]
    v_mfma_f32_16x16x32_bf16 v[56:59], v[104:107], v[112:115], v[56:59]
    v_mfma_f32_16x16x32_bf16 v[60:63], v[104:107], v[116:119], v[60:63]
    ds_read_b128 v[92:95], v9 offset:20480
    ds_read_b128 v[96:99], v9 offset:22528
    ds_read_b128 v[100:103], v9 offset:24576
    ds_read_b128 v[104:107], v9 offset:26624
    ds_read_b128 v[108:111], v13 offset:36864
    ds_read_b128 v[112:115], v13 offset:38912
    ds_read_b128 v[116:119], v13 offset:40960
    s_waitcnt lgkmcnt(7)
    v_mfma_f32_16x16x32_bf16 v[16:19], v[64:67], v[80:83], v[16:19]
    v_mfma_f32_16x16x32_bf16 v[20:23], v[64:67], v[84:87], v[20:23]
    v_mfma_f32_16x16x32_bf16 v[24:27], v[64:67], v[88:91], v[24:27]
    v_mfma_f32_16x16x32_bf16 v[28:31], v[68:71], v[80:83], v[28:31]
    v_mfma_f32_16x16x32_bf16 v[32:35], v[68:71], v[84:87], v[32:35]
    v_mfma_f32_16x16x32_bf16 v[36:39], v[68:71], v[88:91], v[36:39]
    v_mfma_f32_16x16x32_bf16 v[40:43], v[72:75], v[80:83], v[40:43]
    v_mfma_f32_16x16x32_bf16 v[44:47], v[72:75], v[84:87], v[44:47]
    v_mfma_f32_16x16x32_bf16 v[48:51], v[72:75], v[88:91], v[48:51]
    v_mfma_f32_16x16x32_bf16 v[52:55], v[76:79], v[80:83], v[52:55]
    v_mfma_f32_16x16x32_bf16 v[56:59], v[76:79], v[84:87], v[56:59]
    v_mfma_f32_16x16x32_bf16 v[60:63], v[76:79], v[88:91], v[60:63]
    s_waitcnt lgkmcnt(0)
    s_waitcnt vmcnt(0)
    s_barrier
    ds_read_b128 v[64:67], v6 offset:0
    ds_read_b128 v[68:71], v6 offset:2048
    ds_read_b128 v[72:75], v6 offset:4096
    ds_read_b128 v[76:79], v6 offset:6144
    ds_read_b128 v[80:83], v10 offset:16384
    ds_read_b128 v[84:87], v10 offset:18432
    ds_read_b128 v[88:91], v10 offset:20480
    v_mfma_f32_16x16x32_bf16 v[16:19], v[92:95], v[108:111], v[16:19]
    v_mfma_f32_16x16x32_bf16 v[20:23], v[92:95], v[112:115], v[20:23]
    v_mfma_f32_16x16x32_bf16 v[24:27], v[92:95], v[116:119], v[24:27]
    v_mfma_f32_16x16x32_bf16 v[28:31], v[96:99], v[108:111], v[28:31]
    v_mfma_f32_16x16x32_bf16 v[32:35], v[96:99], v[112:115], v[32:35]
    v_mfma_f32_16x16x32_bf16 v[36:39], v[96:99], v[116:119], v[36:39]
    v_mfma_f32_16x16x32_bf16 v[40:43], v[100:103], v[108:111], v[40:43]
    v_mfma_f32_16x16x32_bf16 v[44:47], v[100:103], v[112:115], v[44:47]
    v_mfma_f32_16x16x32_bf16 v[48:51], v[100:103], v[116:119], v[48:51]
    v_mfma_f32_16x16x32_bf16 v[52:55], v[104:107], v[108:111], v[52:55]
    v_mfma_f32_16x16x32_bf16 v[56:59], v[104:107], v[112:115], v[56:59]
    v_mfma_f32_16x16x32_bf16 v[60:63], v[104:107], v[116:119], v[60:63]
    ds_read_b128 v[92:95], v7 offset:0
    ds_read_b128 v[96:99], v7 offset:2048
    ds_read_b128 v[100:103], v7 offset:4096
    ds_read_b128 v[104:107], v7 offset:6144
    ds_read_b128 v[108:111], v11 offset:16384
    ds_read_b128 v[112:115], v11 offset:18432
    ds_read_b128 v[116:119], v11 offset:20480
    s_waitcnt lgkmcnt(7)
    v_mfma_f32_16x16x32_bf16 v[16:19], v[64:67], v[80:83], v[16:19]
    v_mfma_f32_16x16x32_bf16 v[20:23], v[64:67], v[84:87], v[20:23]
    v_mfma_f32_16x16x32_bf16 v[24:27], v[64:67], v[88:91], v[24:27]
    v_mfma_f32_16x16x32_bf16 v[28:31], v[68:71], v[80:83], v[28:31]
    v_mfma_f32_16x16x32_bf16 v[32:35], v[68:71], v[84:87], v[32:35]
    v_mfma_f32_16x16x32_bf16 v[36:39], v[68:71], v[88:91], v[36:39]
    v_mfma_f32_16x16x32_bf16 v[40:43], v[72:75], v[80:83], v[40:43]
    v_mfma_f32_16x16x32_bf16 v[44:47], v[72:75], v[84:87], v[44:47]
    v_mfma_f32_16x16x32_bf16 v[48:51], v[72:75], v[88:91], v[48:51]
    v_mfma_f32_16x16x32_bf16 v[52:55], v[76:79], v[80:83], v[52:55]
    v_mfma_f32_16x16x32_bf16 v[56:59], v[76:79], v[84:87], v[56:59]
    v_mfma_f32_16x16x32_bf16 v[60:63], v[76:79], v[88:91], v[60:63]
    s_waitcnt lgkmcnt(0)
    v_mfma_f32_16x16x32_bf16 v[16:19], v[92:95], v[108:111], v[16:19]
    v_mfma_f32_16x16x32_bf16 v[20:23], v[92:95], v[112:115], v[20:23]
    v_mfma_f32_16x16x32_bf16 v[24:27], v[92:95], v[116:119], v[24:27]
    v_mfma_f32_16x16x32_bf16 v[28:31], v[96:99], v[108:111], v[28:31]
    v_mfma_f32_16x16x32_bf16 v[32:35], v[96:99], v[112:115], v[32:35]
    v_mfma_f32_16x16x32_bf16 v[36:39], v[96:99], v[116:119], v[36:39]
    v_mfma_f32_16x16x32_bf16 v[40:43], v[100:103], v[108:111], v[40:43]
    v_mfma_f32_16x16x32_bf16 v[44:47], v[100:103], v[112:115], v[44:47]
    v_mfma_f32_16x16x32_bf16 v[48:51], v[100:103], v[116:119], v[48:51]
    v_mfma_f32_16x16x32_bf16 v[52:55], v[104:107], v[108:111], v[52:55]
    v_mfma_f32_16x16x32_bf16 v[56:59], v[104:107], v[112:115], v[56:59]
    v_mfma_f32_16x16x32_bf16 v[60:63], v[104:107], v[116:119], v[60:63]
    s_nop 7
    s_nop 7
    s_mul_i32 s28, s27, 96
    s_lshr_b32 s29, s24, 1
    s_mul_i32 s29, s29, 48
    s_add_u32 s28, s28, s29
    s_mul_i32 s29, s26, 128
    s_and_b32 s30, s24, 1
    s_mul_i32 s30, s30, 64
    s_add_u32 s29, s29, s30
    s_lshl_b32 s29, s29, 1
    v_and_b32 v4, 15, v1
    v_add_u32 v4, s28, v4
    s_mov_b32 s30, 4096
    v_mul_lo_u32 v4, v4, s30
    v_lshrrev_b32 v5, 4, v1
    v_lshlrev_b32 v5, 3, v5
    v_add_u32 v4, v4, v5
    v_add_u32 v4, s29, v4
    s_mov_b32 s31, 0
    v_cvt_pk_bf16_f32 v64, v16, v17
    v_cvt_pk_bf16_f32 v65, v18, v19
    buffer_store_dwordx2 v[64:65], v4, s[16:19], s31 offen
    s_mov_b32 s31, 32
    v_cvt_pk_bf16_f32 v64, v28, v29
    v_cvt_pk_bf16_f32 v65, v30, v31
    buffer_store_dwordx2 v[64:65], v4, s[16:19], s31 offen
    s_mov_b32 s31, 64
    v_cvt_pk_bf16_f32 v64, v40, v41
    v_cvt_pk_bf16_f32 v65, v42, v43
    buffer_store_dwordx2 v[64:65], v4, s[16:19], s31 offen
    s_mov_b32 s31, 96
    v_cvt_pk_bf16_f32 v64, v52, v53
    v_cvt_pk_bf16_f32 v65, v54, v55
    buffer_store_dwordx2 v[64:65], v4, s[16:19], s31 offen
    s_mov_b32 s31, 65536
    v_cvt_pk_bf16_f32 v64, v20, v21
    v_cvt_pk_bf16_f32 v65, v22, v23
    buffer_store_dwordx2 v[64:65], v4, s[16:19], s31 offen
    s_mov_b32 s31, 65568
    v_cvt_pk_bf16_f32 v64, v32, v33
    v_cvt_pk_bf16_f32 v65, v34, v35
    buffer_store_dwordx2 v[64:65], v4, s[16:19], s31 offen
    s_mov_b32 s31, 65600
    v_cvt_pk_bf16_f32 v64, v44, v45
    v_cvt_pk_bf16_f32 v65, v46, v47
    buffer_store_dwordx2 v[64:65], v4, s[16:19], s31 offen
    s_mov_b32 s31, 65632
    v_cvt_pk_bf16_f32 v64, v56, v57
    v_cvt_pk_bf16_f32 v65, v58, v59
    buffer_store_dwordx2 v[64:65], v4, s[16:19], s31 offen
    s_mov_b32 s31, 131072
    v_cvt_pk_bf16_f32 v64, v24, v25
    v_cvt_pk_bf16_f32 v65, v26, v27
    buffer_store_dwordx2 v[64:65], v4, s[16:19], s31 offen
    s_mov_b32 s31, 131104
    v_cvt_pk_bf16_f32 v64, v36, v37
    v_cvt_pk_bf16_f32 v65, v38, v39
    buffer_store_dwordx2 v[64:65], v4, s[16:19], s31 offen
    s_mov_b32 s31, 131136
    v_cvt_pk_bf16_f32 v64, v48, v49
    v_cvt_pk_bf16_f32 v65, v50, v51
    buffer_store_dwordx2 v[64:65], v4, s[16:19], s31 offen
    s_mov_b32 s31, 131168
    v_cvt_pk_bf16_f32 v64, v60, v61
    v_cvt_pk_bf16_f32 v65, v62, v63
    buffer_store_dwordx2 v[64:65], v4, s[16:19], s31 offen
g3_kernel_end:
    s_endpgm
.section .rodata,"a"
.p2align 6
.amdhsa_kernel g3_kernel
  .amdhsa_next_free_vgpr 128
  .amdhsa_next_free_sgpr 102
  .amdhsa_accum_offset 128
  .amdhsa_group_segment_fixed_size 0
  .amdhsa_kernarg_size 96
  .amdhsa_user_sgpr_count 2
  .amdhsa_user_sgpr_kernarg_segment_ptr 1
  .amdhsa_system_sgpr_workgroup_id_x 1
.end_amdhsa_kernel
.text
.globl g4_kernel
.p2align 8
.type g4_kernel,@function
g4_kernel:
    s_cmp_ge_u32 s2, 256
    s_cbranch_scc1 g4_kernel_end
    s_load_dwordx2 s[4:5], s[0:1], 88
    s_load_dwordx2 s[6:7], s[0:1], 40
    s_load_dwordx2 s[64:65], s[0:1], 88
    v_and_b32 v1, 63, v0
    v_lshrrev_b32 v4, 6, v0
    s_nop 0
    v_readfirstlane_b32 s24, v4
    s_lshl_b32 s25, s24, 10
    s_waitcnt lgkmcnt(0)
    s_and_b32 s28, s2, 7
    s_lshr_b32 s29, s2, 3
    s_and_b32 s26, s29, 7
    s_lshr_b32 s29, s29, 3
    s_lshl_b32 s28, s28, 2
    s_add_u32 s28, s28, s29
    s_and_b32 s27, s28, 15
    s_lshr_b32 s30, s28, 4
    s_load_dwordx2 s[6:7], s[0:1], 48
    s_cmp_eq_u32 s30, 0
    s_cbranch_scc1 g4_kernel_re
    s_waitcnt lgkmcnt(0)
    s_add_u32 s4, s4, 0x240000
    s_addc_u32 s5, s5, 0
    s_add_u32 s64, s64, 0x240000
    s_addc_u32 s65, s65, 0
    s_branch g4_kernel_go
g4_kernel_re:
    s_waitcnt lgkmcnt(0)
    s_load_dwordx2 s[6:7], s[0:1], 40
    s_waitcnt lgkmcnt(0)
g4_kernel_go:
    s_add_u32 s8, s4, 0x1200000
    s_addc_u32 s9, s5, 0
    s_mov_b32 s10, 0x240000
    s_mov_b32 s11, 0x00020000
    s_mov_b32 s12, s6
    s_mov_b32 s13, s7
    s_mov_b32 s14, 0x800000
    s_mov_b32 s15, 0x00020000
    s_add_u32 s16, s64, 0x1680000
    s_addc_u32 s17, s65, 0
    s_mov_b32 s18, 0x240000
    s_mov_b32 s19, 0x00020000
    v_lshrrev_b32 v4, 3, v1
    v_and_b32 v5, 7, v1
    v_xor_b32 v5, v5, v4
    v_lshlrev_b32 v5, 4, v5
    s_mov_b32 s28, 4096
    v_mul_lo_u32 v2, v4, s28
    v_add_u32 v2, v2, v5
    s_mov_b32 s28, 4096
    v_mul_lo_u32 v3, v4, s28
    v_add_u32 v3, v3, v5
    s_add_u32 s28, s24, 0
    s_lshl_b32 s29, s28, 3
    s_mul_i32 s30, s26, 72
    s_add_u32 s29, s29, s30
    s_mul_i32 s29, s29, 4096
    s_mov_b32 s32, s29
    s_add_u32 s28, s24, 4
    s_lshl_b32 s29, s28, 3
    s_mul_i32 s30, s26, 72
    s_add_u32 s29, s29, s30
    s_mul_i32 s29, s29, 4096
    s_mov_b32 s33, s29
    s_add_u32 s28, s24, 8
    s_lshl_b32 s29, s28, 3
    s_mul_i32 s30, s26, 72
    s_add_u32 s29, s29, s30
    s_mul_i32 s29, s29, 4096
    s_cmp_lt_u32 s28, 9
    s_cselect_b32 s34, s29, 0x7f000000
    s_add_u32 s28, s24, 0
    s_lshl_b32 s29, s28, 3
    s_mul_i32 s30, s27, 128
    s_add_u32 s29, s29, s30
    s_mul_i32 s29, s29, 4096
    s_mov_b32 s48, s29
    s_add_u32 s28, s24, 4
    s_lshl_b32 s29, s28, 3
    s_mul_i32 s30, s27, 128
    s_add_u32 s29, s29, s30
    s_mul_i32 s29, s29, 4096
    s_mov_b32 s49, s29
    s_add_u32 s28, s24, 8
    s_lshl_b32 s29, s28, 3
    s_mul_i32 s30, s27, 128
    s_add_u32 s29, s29, s30
    s_mul_i32 s29, s29, 4096
    s_mov_b32 s50, s29
    s_add_u32 s28, s24, 12
    s_lshl_b32 s29, s28, 3
    s_mul_i32 s30, s27, 128
    s_add_u32 s29, s29, s30
    s_mul_i32 s29, s29, 4096
    s_mov_b32 s51, s29
    s_and_b32 s28, s24, 0
    s_lshr_b32 s29, s24, 0
    s_mul_i32 s28, s28, 9216
    s_mul_i32 s29, s29, 4096
    v_and_b32 v4, 15, v1
    v_lshlrev_b32 v4, 7, v4
    v_lshrrev_b32 v5, 4, v1
    v_and_b32 v6, 7, v1
    v_xor_b32 v5, v5, v6
    v_lshl_add_u32 v4, v5, 4, v4
    v_add_u32 v6, s28, v4
    v_xor_b32 v7, 64, v6
    v_add_u32 v8, 0x10000, v6
    v_add_u32 v9, 0x10000, v7
    v_add_u32 v10, s29, v4
    v_xor_b32 v11, 64, v10
    v_add_u32 v12, 0x10000, v10
    v_add_u32 v13, 0x10000, v11
    v_mov_b32 v16, 0
    v_mov_b32 v17, 0
    v_mov_b32 v18, 0
    v_mov_b32 v19, 0
    v_mov_b32 v20, 0
    v_mov_b32 v21, 0
    v_mov_b32 v22, 0
    v_mov_b32 v23, 0
    v_mov_b32 v24, 0
    v_mov_b32 v25, 0
    v_mov_b32 v26, 0
    v_mov_b32 v27, 0
    v_mov_b32 v28, 0
    v_mov_b32 v29, 0
    v_mov_b32 v30, 0
    v_mov_b32 v31, 0
    v_mov_b32 v32, 0
    v_mov_b32 v33, 0
    v_mov_b32 v34, 0
    v_mov_b32 v35, 0
    v_mov_b32 v36, 0
    v_mov_b32 v37, 0
    v_mov_b32 v38, 0
    v_mov_b32 v39, 0
    v_mov_b32 v40, 0
    v_mov_b32 v41, 0
    v_mov_b32 v42, 0
    v_mov_b32 v43, 0
    v_mov_b32 v44, 0
    v_mov_b32 v45, 0
    v_mov_b32 v46, 0
    v_mov_b32 v47, 0
    v_mov_b32 v48, 0
    v_mov_b32 v49, 0
    v_mov_b32 v50, 0
    v_mov_b32 v51, 0
    v_mov_b32 v52, 0
    v_mov_b32 v53, 0
    v_mov_b32 v54, 0
    v_mov_b32 v55, 0
    s_add_u32 m0, s25, 0
    s_nop 0
    buffer_load_dwordx4 v2, s[8:11], s32 offen lds
    s_add_u32 m0, s25, 4096
    s_nop 0
    buffer_load_dwordx4 v2, s[8:11], s33 offen lds
    s_add_u32 m0, s25, 8192
    s_nop 0
    buffer_load_dwordx4 v2, s[8:11], s34 offen lds
    s_add_u32 m0, s25, 12288
    s_nop 0
    buffer_load_dwordx4 v3, s[12:15], s48 offen lds
    s_add_u32 m0, s25, 16384
    s_nop 0
    buffer_load_dwordx4 v3, s[12:15], s49 offen lds
    s_add_u32 m0, s25, 20480
    s_nop 0
    buffer_load_dwordx4 v3, s[12:15], s50 offen lds
    s_add_u32 m0, s25, 24576
    s_nop 0
    buffer_load_dwordx4 v3, s[12:15], s51 offen lds
    s_add_u32 s8, s8, 128
    s_addc_u32 s9, s9, 0
    s_add_u32 s12, s12, 128
    s_addc_u32 s13, s13, 0
    s_add_u32 m0, s25, 28672
    s_nop 0
    buffer_load_dwordx4 v2, s[8:11], s32 offen lds
    s_add_u32 m0, s25, 32768
    s_nop 0
    buffer_load_dwordx4 v2, s[8:11], s33 offen lds
    s_add_u32 m0, s25, 36864
    s_nop 0
    buffer_load_dwordx4 v2, s[8:11], s34 offen lds
    s_add_u32 m0, s25, 40960
    s_nop 0
    buffer_load_dwordx4 v3, s[12:15], s48 offen lds
    s_add_u32 m0, s25, 45056
    s_nop 0
    buffer_load_dwordx4 v3, s[12:15], s49 offen lds
    s_add_u32 m0, s25, 49152
    s_nop 0
    buffer_load_dwordx4 v3, s[12:15], s50 offen lds
    s_add_u32 m0, s25, 53248
    s_nop 0
    buffer_load_dwordx4 v3, s[12:15], s51 offen lds
    s_add_u32 s8, s8, 128
    s_addc_u32 s9, s9, 0
    s_add_u32 s12, s12, 128
    s_addc_u32 s13, s13, 0
    s_add_u32 m0, s25, 57344
    s_nop 0
    buffer_load_dwordx4 v2, s[8:11], s32 offen lds
    s_add_u32 m0, s25, 61440
    s_nop 0
    buffer_load_dwordx4 v2, s[8:11], s33 offen lds
    s_add_u32 m0, s25, 65536
    s_nop 0
    buffer_load_dwordx4 v2, s[8:11], s34 offen lds
    s_add_u32 m0, s25, 69632
    s_nop 0
    buffer_load_dwordx4 v3, s[12:15], s48 offen lds
    s_add_u32 m0, s25, 73728
    s_nop 0
    buffer_load_dwordx4 v3, s[12:15], s49 offen lds
    s_add_u32 m0, s25, 77824
    s_nop 0
    buffer_load_dwordx4 v3, s[12:15], s50 offen lds
    s_add_u32 m0, s25, 81920
    s_nop 0
    buffer_load_dwordx4 v3, s[12:15], s51 offen lds
    s_add_u32 s8, s8, 128
    s_addc_u32 s9, s9, 0
    s_add_u32 s12, s12, 128
    s_addc_u32 s13, s13, 0
    s_add_u32 m0, s25, 86016
    s_nop 0
    buffer_load_dwordx4 v2, s[8:11], s32 offen lds
    s_add_u32 m0, s25, 90112
    s_nop 0
    buffer_load_dwordx4 v2, s[8:11], s33 offen lds
    s_add_u32 m0, s25, 94208
    s_nop 0
    buffer_load_dwordx4 v2, s[8:11], s34 offen lds
    s_add_u32 m0, s25, 98304
    s_nop 0
    buffer_load_dwordx4 v3, s[12:15], s48 offen lds
    s_add_u32 m0, s25, 102400
    s_nop 0
    buffer_load_dwordx4 v3, s[12:15], s49 offen lds
    s_add_u32 m0, s25, 106496
    s_nop 0
    buffer_load_dwordx4 v3, s[12:15], s50 offen lds
    s_add_u32 m0, s25, 110592
    s_nop 0
    buffer_load_dwordx4 v3, s[12:15], s51 offen lds
    s_add_u32 s8, s8, 128
    s_addc_u32 s9, s9, 0
    s_add_u32 s12, s12, 128
    s_addc_u32 s13, s13, 0
    s_waitcnt vmcnt(21)
    s_barrier
    ds_read_b128 v[56:59], v6 offset:0
    ds_read_b128 v[60:63], v6 offset:2048
    ds_read_b128 v[64:67], v6 offset:4096
    ds_read_b128 v[68:71], v6 offset:6144
    ds_read_b128 v[72:75], v6 offset:8192
    ds_read_b128 v[76:79], v10 offset:12288
    ds_read_b128 v[80:83], v10 offset:14336
    ds_read_b128 v[84:87], v7 offset:0
    ds_read_b128 v[88:91], v7 offset:2048
    ds_read_b128 v[92:95], v7 offset:4096
    ds_read_b128 v[96:99], v7 offset:6144
    ds_read_b128 v[100:103], v7 offset:8192
    ds_read_b128 v[104:107], v11 offset:12288
    ds_read_b128 v[108:111], v11 offset:14336
    s_waitcnt lgkmcnt(7)
    v_mfma_f32_16x16x32_bf16 v[16:19], v[56:59], v[76:79], v[16:19]
    v_mfma_f32_16x16x32_bf16 v[20:23], v[56:59], v[80:83], v[20:23]
    v_mfma_f32_16x16x32_bf16 v[24:27], v[60:63], v[76:79], v[24:27]
    v_mfma_f32_16x16x32_bf16 v[28:31], v[60:63], v[80:83], v[28:31]
    v_mfma_f32_16x16x32_bf16 v[32:35], v[64:67], v[76:79], v[32:35]
    v_mfma_f32_16x16x32_bf16 v[36:39], v[64:67], v[80:83], v[36:39]
    v_mfma_f32_16x16x32_bf16 v[40:43], v[68:71], v[76:79], v[40:43]
    v_mfma_f32_16x16x32_bf16 v[44:47], v[68:71], v[80:83], v[44:47]
    v_mfma_f32_16x16x32_bf16 v[48:51], v[72:75], v[76:79], v[48:51]
    v_mfma_f32_16x16x32_bf16 v[52:55], v[72:75], v[80:83], v[52:55]
    s_waitcnt lgkmcnt(0)
    s_waitcnt vmcnt(14)
    s_barrier
    ds_read_b128 v[56:59], v6 offset:28672
    ds_read_b128 v[60:63], v6 offset:30720
    ds_read_b128 v[64:67], v6 offset:32768
    ds_read_b128 v[68:71], v6 offset:34816
    ds_read_b128 v[72:75], v6 offset:36864
    ds_read_b128 v[76:79], v10 offset:40960
    ds_read_b128 v[80:83], v10 offset:43008
    s_add_u32 m0, s25, 0
    s_nop 0
    buffer_load_dwordx4 v2, s[8:11], s32 offen lds
    v_mfma_f32_16x16x32_bf16 v[16:19], v[84:87], v[104:107], v[16:19]
    s_add_u32 m0, s25, 4096
    s_nop 0
    buffer_load_dwordx4 v2, s[8:11], s33 offen lds
    v_mfma_f32_16x16x32_bf16 v[20:23], v[84:87], v[108:111], v[20:23]
    s_add_u32 m0, s25, 8192
    s_nop 0
    buffer_load_dwordx4 v2, s[8:11], s34 offen lds
    v_mfma_f32_16x16x32_bf16 v[24:27], v[88:91], v[104:107], v[24:27]
    s_add_u32 m0, s25, 12288
    s_nop 0
    buffer_load_dwordx4 v3, s[12:15], s48 offen lds
    v_mfma_f32_16x16x32_bf16 v[28:31], v[88:91], v[108:111], v[28:31]
    s_add_u32 m0, s25, 16384
    s_nop 0
    buffer_load_dwordx4 v3, s[12:15], s49 offen lds
    v_mfma_f32_16x16x32_bf16 v[32:35], v[92:95], v[104:107], v[32:35]
    s_add_u32 m0, s25, 20480
    s_nop 0
    buffer_load_dwordx4 v3, s[12:15], s50 offen lds
    v_mfma_f32_16x16x32_bf16 v[36:39], v[92:95], v[108:111], v[36:39]
    s_add_u32 m0, s25, 24576
    s_nop 0
    buffer_load_dwordx4 v3, s[12:15], s51 offen lds
    v_mfma_f32_16x16x32_bf16 v[40:43], v[96:99], v[104:107], v[40:43]
    s_add_u32 s8, s8, 128
    s_addc_u32 s9, s9, 0
    s_add_u32 s12, s12, 128
    s_addc_u32 s13, s13, 0
    v_mfma_f32_16x16x32_bf16 v[44:47], v[96:99], v[108:111], v[44:47]
    v_mfma_f32_16x16x32_bf16 v[48:51], v[100:103], v[104:107], v[48:51]
    v_mfma_f32_16x16x32_bf16 v[52:55], v[100:103], v[108:111], v[52:55]
    ds_read_b128 v[84:87], v7 offset:28672
    ds_read_b128 v[88:91], v7 offset:30720
    ds_read_b128 v[92:95], v7 offset:32768
    ds_read_b128 v[96:99], v7 offset:34816
    ds_read_b128 v[100:103], v7 offset:36864
    ds_read_b128 v[104:107], v11 offset:40960
    ds_read_b128 v[108:111], v11 offset:43008
    s_waitcnt lgkmcnt(7)
    v_mfma_f32_16x16x32_bf16 v[16:19], v[56:59], v[76:79], v[16:19]
    v_mfma_f32_16x16x32_bf16 v[20:23], v[56:59], v[80:83], v[20:23]
    v_mfma_f32_16x16x32_bf16 v[24:27], v[60:63], v[76:79], v[24:27]
    v_mfma_f32_16x16x32_bf16 v[28:31], v[60:63], v[80:83], v[28:31]
    v_mfma_f32_16x16x32_bf16 v[32:35], v[64:67], v[76:79], v[32:35]
    v_mfma_f32_16x16x32_bf16 v[36:39], v[64:67], v[80:83], v[36:39]
    v_mfma_f32_16x16x32_bf16 v[40:43], v[68:71], v[76:79], v[40:43]
    v_mfma_f32_16x16x32_bf16 v[44:47], v[68:71], v[80:83], v[44:47]
    v_mfma_f32_16x16x32_bf16 v[48:51], v[72:75], v[76:79], v[48:51]
    v_mfma_f32_16x16x32_bf16 v[52:55], v[72:75], v[80:83], v[52:55]
    s_waitcnt lgkmcnt(0)
    s_waitcnt vmcnt(14)
    s_barrier
    ds_read_b128 v[56:59], v6 offset:57344
    ds_read_b128 v[60:63], v6 offset:59392
    ds_read_b128 v[64:67], v6 offset:61440
    ds_read_b128 v[68:71], v6 offset:63488
    ds_read_b128 v[72:75], v8 offset:0
    ds_read_b128 v[76:79], v12 offset:4096
    ds_read_b128 v[80:83], v12 offset:6144
    s_add_u32 m0, s25, 28672
    s_nop 0
    buffer_load_dwordx4 v2, s[8:11], s32 offen lds
    v_mfma_f32_16x16x32_bf16 v[16:19], v[84:87], v[104:107], v[16:19]
    s_add_u32 m0, s25, 32768
    s_nop 0
    buffer_load_dwordx4 v2, s[8:11], s33 offen lds
    v_mfma_f32_16x16x32_bf16 v[20:23], v[84:87], v[108:111], v[20:23]
    s_add_u32 m0, s25, 36864
    s_nop 0
    buffer_load_dwordx4 v2, s[8:11], s34 offen lds
    v_mfma_f32_16x16x32_bf16 v[24:27], v[88:91], v[104:107], v[24:27]
    s_add_u32 m0, s25, 40960
    s_nop 0
    buffer_load_dwordx4 v3, s[12:15], s48 offen lds
    v_mfma_f32_16x16x32_bf16 v[28:31], v[88:91], v[108:111], v[28:31]
    s_add_u32 m0, s25, 45056
    s_nop 0
    buffer_load_dwordx4 v3, s[12:15], s49 offen lds
    v_mfma_f32_16x16x32_bf16 v[32:35], v[92:95], v[104:107], v[32:35]
    s_add_u32 m0, s25, 49152
    s_nop 0
    buffer_load_dwordx4 v3, s[12:15], s50 offen lds
    v_mfma_f32_16x16x32_bf16 v[36:39], v[92:95], v[108:111], v[36:39]
    s_add_u32 m0, s25, 53248
    s_nop 0
    buffer_load_dwordx4 v3, s[12:15], s51 offen lds
    v_mfma_f32_16x16x32_bf16 v[40:43], v[96:99], v[104:107], v[40:43]
    s_add_u32 s8, s8, 128
    s_addc_u32 s9, s9, 0
    s_add_u32 s12, s12, 128
    s_addc_u32 s13, s13, 0
    v_mfma_f32_16x16x32_bf16 v[44:47], v[96:99], v[108:111], v[44:47]
    v_mfma_f32_16x16x32_bf16 v[48:51], v[100:103], v[104:107], v[48:51]
    v_mfma_f32_16x16x32_bf16 v[52:55], v[100:103], v[108:111], v[52:55]
    ds_read_b128 v[84:87], v7 offset:57344
    ds_read_b128 v[88:91], v7 offset:59392
    ds_read_b128 v[92:95], v7 offset:61440
    ds_read_b128 v[96:99], v7 offset:63488
    ds_read_b128 v[100:103], v9 offset:0
    ds_read_b128 v[104:107], v13 offset:4096
    ds_read_b128 v[108:111], v13 offset:6144
    s_waitcnt lgkmcnt(7)
    v_mfma_f32_16x16x32_bf16 v[16:19], v[56:59], v[76:79], v[16:19]
    v_mfma_f32_16x16x32_bf16 v[20:23], v[56:59], v[80:83], v[20:23]
    v_mfma_f32_16x16x32_bf16 v[24:27], v[60:63], v[76:79], v[24:27]
    v_mfma_f32_16x16x32_bf16 v[28:31], v[60:63], v[80:83], v[28:31]
    v_mfma_f32_16x16x32_bf16 v[32:35], v[64:67], v[76:79], v[32:35]
    v_mfma_f32_16x16x32_bf16 v[36:39], v[64:67], v[80:83], v[36:39]
    v_mfma_f32_16x16x32_bf16 v[40:43], v[68:71], v[76:79], v[40:43]
    v_mfma_f32_16x16x32_bf16 v[44:47], v[68:71], v[80:83], v[44:47]
    v_mfma_f32_16x16x32_bf16 v[48:51], v[72:75], v[76:79], v[48:51]
    v_mfma_f32_16x16x32_bf16 v[52:55], v[72:75], v[80:83], v[52:55]
    s_waitcnt lgkmcnt(0)
    s_waitcnt vmcnt(14)
    s_barrier
    ds_read_b128 v[56:59], v8 offset:20480
    ds_read_b128 v[60:63], v8 offset:22528
    ds_read_b128 v[64:67], v8 offset:24576
    ds_read_b128 v[68:71], v8 offset:26624
    ds_read_b128 v[72:75], v8 offset:28672
    ds_read_b128 v[76:79], v12 offset:32768
    ds_read_b128 v[80:83], v12 offset:34816
    s_add_u32 m0, s25, 57344
    s_nop 0
    buffer_load_dwordx4 v2, s[8:11], s32 offen lds
    v_mfma_f32_16x16x32_bf16 v[16:19], v[84:87], v[104:107], v[16:19]
    s_add_u32 m0, s25, 61440
    s_nop 0
    buffer_load_dwordx4 v2, s[8:11], s33 offen lds
    v_mfma_f32_16x16x32_bf16 v[20:23], v[84:87], v[108:111], v[20:23]
    s_add_u32 m0, s25, 65536
    s_nop 0
    buffer_load_dwordx4 v2, s[8:11], s34 offen lds
    v_mfma_f32_16x16x32_bf16 v[24:27], v[88:91], v[104:107], v[24:27]
    s_add_u32 m0, s25, 69632
    s_nop 0
    buffer_load_dwordx4 v3, s[12:15], s48 offen lds
    v_mfma_f32_16x16x32_bf16 v[28:31], v[88:91], v[108:111], v[28:31]
    s_add_u32 m0, s25, 73728
    s_nop 0
    buffer_load_dwordx4 v3, s[12:15], s49 offen lds
    v_mfma_f32_16x16x32_bf16 v[32:35], v[92:95], v[104:107], v[32:35]
    s_add_u32 m0, s25, 77824
    s_nop 0
    buffer_load_dwordx4 v3, s[12:15], s50 offen lds
    v_mfma_f32_16x16x32_bf16 v[36:39], v[92:95], v[108:111], v[36:39]
    s_add_u32 m0, s25, 81920
    s_nop 0
    buffer_load_dwordx4 v3, s[12:15], s51 offen lds
    v_mfma_f32_16x16x32_bf16 v[40:43], v[96:99], v[104:107], v[40:43]
    s_add_u32 s8, s8, 128
    s_addc_u32 s9, s9, 0
    s_add_u32 s12, s12, 128
    s_addc_u32 s13, s13, 0
    v_mfma_f32_16x16x32_bf16 v[44:47], v[96:99], v[108:111], v[44:47]
    v_mfma_f32_16x16x32_bf16 v[48:51], v[100:103], v[104:107], v[48:51]
    v_mfma_f32_16x16x32_bf16 v[52:55], v[100:103], v[108:111], v[52:55]
    ds_read_b128 v[84:87], v9 offset:20480
    ds_read_b128 v[88:91], v9 offset:22528
    ds_read_b128 v[92:95], v9 offset:24576
    ds_read_b128 v[96:99], v9 offset:26624
    ds_read_b128 v[100:103], v9 offset:28672
    ds_read_b128 v[104:107], v13 offset:32768
    ds_read_b128 v[108:111], v13 offset:34816
    s_waitcnt lgkmcnt(7)
    v_mfma_f32_16x16x32_bf16 v[16:19], v[56:59], v[76:79], v[16:19]
    v_mfma_f32_16x16x32_bf16 v[20:23], v[56:59], v[80:83], v[20:23]
    v_mfma_f32_16x16x32_bf16 v[24:27], v[60:63], v[76:79], v[24:27]
    v_mfma_f32_16x16x32_bf16 v[28:31], v[60:63], v[80:83], v[28:31]
    v_mfma_f32_16x16x32_bf16 v[32:35], v[64:67], v[76:79], v[32:35]
    v_mfma_f32_16x16x32_bf16 v[36:39], v[64:67], v[80:83], v[36:39]
    v_mfma_f32_16x16x32_bf16 v[40:43], v[68:71], v[76:79], v[40:43]
    v_mfma_f32_16x16x32_bf16 v[44:47], v[68:71], v[80:83], v[44:47]
    v_mfma_f32_16x16x32_bf16 v[48:51], v[72:75], v[76:79], v[48:51]
    v_mfma_f32_16x16x32_bf16 v[52:55], v[72:75], v[80:83], v[52:55]
    s_waitcnt lgkmcnt(0)
    s_waitcnt vmcnt(14)
    s_barrier
    ds_read_b128 v[56:59], v6 offset:0
    ds_read_b128 v[60:63], v6 offset:2048
    ds_read_b128 v[64:67], v6 offset:4096
    ds_read_b128 v[68:71], v6 offset:6144
    ds_read_b128 v[72:75], v6 offset:8192
    ds_read_b128 v[76:79], v10 offset:12288
    ds_read_b128 v[80:83], v10 offset:14336
    s_add_u32 m0, s25, 86016
    s_nop 0
    buffer_load_dwordx4 v2, s[8:11], s32 offen lds
    v_mfma_f32_16x16x32_bf16 v[16:19], v[84:87], v[104:107], v[16:19]
    s_add_u32 m0, s25, 90112
    s_nop 0
    buffer_load_dwordx4 v2, s[8:11], s33 offen lds
    v_mfma_f32_16x16x32_bf16 v[20:23], v[84:87], v[108:111], v[20:23]
    s_add_u32 m0, s25, 94208
    s_nop 0
    buffer_load_dwordx4 v2, s[8:11], s34 offen lds
    v_mfma_f32_16x16x32_bf16 v[24:27], v[88:91], v[104:107], v[24:27]
    s_add_u32 m0, s25, 98304
    s_nop 0
    buffer_load_dwordx4 v3, s[12:15], s48 offen lds
    v_mfma_f32_16x16x32_bf16 v[28:31], v[88:91], v[108:111], v[28:31]
    s_add_u32 m0, s25, 102400
    s_nop 0
    buffer_load_dwordx4 v3, s[12:15], s49 offen lds
    v_mfma_f32_16x16x32_bf16 v[32:35], v[92:95], v[104:107], v[32:35]
    s_add_u32 m0, s25, 106496
    s_nop 0
    buffer_load_dwordx4 v3, s[12:15], s50 offen lds
    v_mfma_f32_16x16x32_bf16 v[36:39], v[92:95], v[108:111], v[36:39]
    s_add_u32 m0, s25, 110592
    s_nop 0
    buffer_load_dwordx4 v3, s[12:15], s51 offen lds
    v_mfma_f32_16x16x32_bf16 v[40:43], v[96:99], v[104:107], v[40:43]
    s_add_u32 s8, s8, 128
    s_addc_u32 s9, s9, 0
    s_add_u32 s12, s12, 128
    s_addc_u32 s13, s13, 0
    v_mfma_f32_16x16x32_bf16 v[44:47], v[96:99], v[108:111], v[44:47]
    v_mfma_f32_16x16x32_bf16 v[48:51], v[100:103], v[104:107], v[48:51]
    v_mfma_f32_16x16x32_bf16 v[52:55], v[100:103], v[108:111], v[52:55]
    ds_read_b128 v[84:87], v7 offset:0
    ds_read_b128 v[88:91], v7 offset:2048
    ds_read_b128 v[92:95], v7 offset:4096
    ds_read_b128 v[96:99], v7 offset:6144
    ds_read_b128 v[100:103], v7 offset:8192
    ds_read_b128 v[104:107], v11 offset:12288
    ds_read_b128 v[108:111], v11 offset:14336
    s_waitcnt lgkmcnt(7)
    v_mfma_f32_16x16x32_bf16 v[16:19], v[56:59], v[76:79], v[16:19]
    v_mfma_f32_16x16x32_bf16 v[20:23], v[56:59], v[80:83], v[20:23]
    v_mfma_f32_16x16x32_bf16 v[24:27], v[60:63], v[76:79], v[24:27]
    v_mfma_f32_16x16x32_bf16 v[28:31], v[60:63], v[80:83], v[28:31]
    v_mfma_f32_16x16x32_bf16 v[32:35], v[64:67], v[76:79], v[32:35]
    v_mfma_f32_16x16x32_bf16 v[36:39], v[64:67], v[80:83], v[36:39]
    v_mfma_f32_16x16x32_bf16 v[40:43], v[68:71], v[76:79], v[40:43]
    v_mfma_f32_16x16x32_bf16 v[44:47], v[68:71], v[80:83], v[44:47]
    v_mfma_f32_16x16x32_bf16 v[48:51], v[72:75], v[76:79], v[48:51]
    v_mfma_f32_16x16x32_bf16 v[52:55], v[72:75], v[80:83], v[52:55]
    s_waitcnt lgkmcnt(0)
    s_waitcnt vmcnt(14)
    s_barrier
    ds_read_b128 v[56:59], v6 offset:28672
    ds_read_b128 v[60:63], v6 offset:30720
    ds_read_b128 v[64:67], v6 offset:32768
    ds_read_b128 v[68:71], v6 offset:34816
    ds_read_b128 v[72:75], v6 offset:36864
    ds_read_b128 v[76:79], v10 offset:40960
    ds_read_b128 v[80:83], v10 offset:43008
    s_add_u32 m0, s25, 0
    s_nop 0
    buffer_load_dwordx4 v2, s[8:11], s32 offen lds
    v_mfma_f32_16x16x32_bf16 v[16:19], v[84:87], v[104:107], v[16:19]
    s_add_u32 m0, s25, 4096
    s_nop 0
    buffer_load_dwordx4 v2, s[8:11], s33 offen lds
    v_mfma_f32_16x16x32_bf16 v[20:23], v[84:87], v[108:111], v[20:23]
    s_add_u32 m0, s25, 8192
    s_nop 0
    buffer_load_dwordx4 v2, s[8:11], s34 offen lds
    v_mfma_f32_16x16x32_bf16 v[24:27], v[88:91], v[104:107], v[24:27]
    s_add_u32 m0, s25, 12288
    s_nop 0
    buffer_load_dwordx4 v3, s[12:15], s48 offen lds
    v_mfma_f32_16x16x32_bf16 v[28:31], v[88:91], v[108:111], v[28:31]
    s_add_u32 m0, s25, 16384
    s_nop 0
    buffer_load_dwordx4 v3, s[12:15], s49 offen lds
    v_mfma_f32_16x16x32_bf16 v[32:35], v[92:95], v[104:107], v[32:35]
    s_add_u32 m0, s25, 20480
    s_nop 0
    buffer_load_dwordx4 v3, s[12:15], s50 offen lds
    v_mfma_f32_16x16x32_bf16 v[36:39], v[92:95], v[108:111], v[36:39]
    s_add_u32 m0, s25, 24576
    s_nop 0
    buffer_load_dwordx4 v3, s[12:15], s51 offen lds
    v_mfma_f32_16x16x32_bf16 v[40:43], v[96:99], v[104:107], v[40:43]
    s_add_u32 s8, s8, 128
    s_addc_u32 s9, s9, 0
    s_add_u32 s12, s12, 128
    s_addc_u32 s13, s13, 0
    v_mfma_f32_16x16x32_bf16 v[44:47], v[96:99], v[108:111], v[44:47]
    v_mfma_f32_16x16x32_bf16 v[48:51], v[100:103], v[104:107], v[48:51]
    v_mfma_f32_16x16x32_bf16 v[52:55], v[100:103], v[108:111], v[52:55]
    ds_read_b128 v[84:87], v7 offset:28672
    ds_read_b128 v[88:91], v7 offset:30720
    ds_read_b128 v[92:95], v7 offset:32768
    ds_read_b128 v[96:99], v7 offset:34816
    ds_read_b128 v[100:103], v7 offset:36864
    ds_read_b128 v[104:107], v11 offset:40960
    ds_read_b128 v[108:111], v11 offset:43008
    s_waitcnt lgkmcnt(7)
    v_mfma_f32_16x16x32_bf16 v[16:19], v[56:59], v[76:79], v[16:19]
    v_mfma_f32_16x16x32_bf16 v[20:23], v[56:59], v[80:83], v[20:23]
    v_mfma_f32_16x16x32_bf16 v[24:27], v[60:63], v[76:79], v[24:27]
    v_mfma_f32_16x16x32_bf16 v[28:31], v[60:63], v[80:83], v[28:31]
    v_mfma_f32_16x16x32_bf16 v[32:35], v[64:67], v[76:79], v[32:35]
    v_mfma_f32_16x16x32_bf16 v[36:39], v[64:67], v[80:83], v[36:39]
    v_mfma_f32_16x16x32_bf16 v[40:43], v[68:71], v[76:79], v[40:43]
    v_mfma_f32_16x16x32_bf16 v[44:47], v[68:71], v[80:83], v[44:47]
    v_mfma_f32_16x16x32_bf16 v[48:51], v[72:75], v[76:79], v[48:51]
    v_mfma_f32_16x16x32_bf16 v[52:55], v[72:75], v[80:83], v[52:55]
    s_waitcnt lgkmcnt(0)
    s_waitcnt vmcnt(14)
    s_barrier
    ds_read_b128 v[56:59], v6 offset:57344
    ds_read_b128 v[60:63], v6 offset:59392
    ds_read_b128 v[64:67], v6 offset:61440
    ds_read_b128 v[68:71], v6 offset:63488
    ds_read_b128 v[72:75], v8 offset:0
    ds_read_b128 v[76:79], v12 offset:4096
    ds_read_b128 v[80:83], v12 offset:6144
    s_add_u32 m0, s25, 28672
    s_nop 0
    buffer_load_dwordx4 v2, s[8:11], s32 offen lds
    v_mfma_f32_16x16x32_bf16 v[16:19], v[84:87], v[104:107], v[16:19]
    s_add_u32 m0, s25, 32768
    s_nop 0
    buffer_load_dwordx4 v2, s[8:11], s33 offen lds
    v_mfma_f32_16x16x32_bf16 v[20:23], v[84:87], v[108:111], v[20:23]
    s_add_u32 m0, s25, 36864
    s_nop 0
    buffer_load_dwordx4 v2, s[8:11], s34 offen lds
    v_mfma_f32_16x16x32_bf16 v[24:27], v[88:91], v[104:107], v[24:27]
    s_add_u32 m0, s25, 40960
    s_nop 0
    buffer_load_dwordx4 v3, s[12:15], s48 offen lds
    v_mfma_f32_16x16x32_bf16 v[28:31], v[88:91], v[108:111], v[28:31]
    s_add_u32 m0, s25, 45056
    s_nop 0
    buffer_load_dwordx4 v3, s[12:15], s49 offen lds
    v_mfma_f32_16x16x32_bf16 v[32:35], v[92:95], v[104:107], v[32:35]
    s_add_u32 m0, s25, 49152
    s_nop 0
    buffer_load_dwordx4 v3, s[12:15], s50 offen lds
    v_mfma_f32_16x16x32_bf16 v[36:39], v[92:95], v[108:111], v[36:39]
    s_add_u32 m0, s25, 53248
    s_nop 0
    buffer_load_dwordx4 v3, s[12:15], s51 offen lds
    v_mfma_f32_16x16x32_bf16 v[40:43], v[96:99], v[104:107], v[40:43]
    s_add_u32 s8, s8, 128
    s_addc_u32 s9, s9, 0
    s_add_u32 s12, s12, 128
    s_addc_u32 s13, s13, 0
    v_mfma_f32_16x16x32_bf16 v[44:47], v[96:99], v[108:111], v[44:47]
    v_mfma_f32_16x16x32_bf16 v[48:51], v[100:103], v[104:107], v[48:51]
    v_mfma_f32_16x16x32_bf16 v[52:55], v[100:103], v[108:111], v[52:55]
    ds_read_b128 v[84:87], v7 offset:57344
    ds_read_b128 v[88:91], v7 offset:59392
    ds_read_b128 v[92:95], v7 offset:61440
    ds_read_b128 v[96:99], v7 offset:63488
    ds_read_b128 v[100:103], v9 offset:0
    ds_read_b128 v[104:107], v13 offset:4096
    ds_read_b128 v[108:111], v13 offset:6144
    s_waitcnt lgkmcnt(7)
    v_mfma_f32_16x16x32_bf16 v[16:19], v[56:59], v[76:79], v[16:19]
    v_mfma_f32_16x16x32_bf16 v[20:23], v[56:59], v[80:83], v[20:23]
    v_mfma_f32_16x16x32_bf16 v[24:27], v[60:63], v[76:79], v[24:27]
    v_mfma_f32_16x16x32_bf16 v[28:31], v[60:63], v[80:83], v[28:31]
    v_mfma_f32_16x16x32_bf16 v[32:35], v[64:67], v[76:79], v[32:35]
    v_mfma_f32_16x16x32_bf16 v[36:39], v[64:67], v[80:83], v[36:39]
    v_mfma_f32_16x16x32_bf16 v[40:43], v[68:71], v[76:79], v[40:43]
    v_mfma_f32_16x16x32_bf16 v[44:47], v[68:71], v[80:83], v[44:47]
    v_mfma_f32_16x16x32_bf16 v[48:51], v[72:75], v[76:79], v[48:51]
    v_mfma_f32_16x16x32_bf16 v[52:55], v[72:75], v[80:83], v[52:55]
    s_waitcnt lgkmcnt(0)
    s_waitcnt vmcnt(14)
    s_barrier
    ds_read_b128 v[56:59], v8 offset:20480
    ds_read_b128 v[60:63], v8 offset:22528
    ds_read_b128 v[64:67], v8 offset:24576
    ds_read_b128 v[68:71], v8 offset:26624
    ds_read_b128 v[72:75], v8 offset:28672
    ds_read_b128 v[76:79], v12 offset:32768
    ds_read_b128 v[80:83], v12 offset:34816
    s_add_u32 m0, s25, 57344
    s_nop 0
    buffer_load_dwordx4 v2, s[8:11], s32 offen lds
    v_mfma_f32_16x16x32_bf16 v[16:19], v[84:87], v[104:107], v[16:19]
    s_add_u32 m0, s25, 61440
    s_nop 0
    buffer_load_dwordx4 v2, s[8:11], s33 offen lds
    v_mfma_f32_16x16x32_bf16 v[20:23], v[84:87], v[108:111], v[20:23]
    s_add_u32 m0, s25, 65536
    s_nop 0
    buffer_load_dwordx4 v2, s[8:11], s34 offen lds
    v_mfma_f32_16x16x32_bf16 v[24:27], v[88:91], v[104:107], v[24:27]
    s_add_u32 m0, s25, 69632
    s_nop 0
    buffer_load_dwordx4 v3, s[12:15], s48 offen lds
    v_mfma_f32_16x16x32_bf16 v[28:31], v[88:91], v[108:111], v[28:31]
    s_add_u32 m0, s25, 73728
    s_nop 0
    buffer_load_dwordx4 v3, s[12:15], s49 offen lds
    v_mfma_f32_16x16x32_bf16 v[32:35], v[92:95], v[104:107], v[32:35]
    s_add_u32 m0, s25, 77824
    s_nop 0
    buffer_load_dwordx4 v3, s[12:15], s50 offen lds
    v_mfma_f32_16x16x32_bf16 v[36:39], v[92:95], v[108:111], v[36:39]
    s_add_u32 m0, s25, 81920
    s_nop 0
    buffer_load_dwordx4 v3, s[12:15], s51 offen lds
    v_mfma_f32_16x16x32_bf16 v[40:43], v[96:99], v[104:107], v[40:43]
    s_add_u32 s8, s8, 128
    s_addc_u32 s9, s9, 0
    s_add_u32 s12, s12, 128
    s_addc_u32 s13, s13, 0
    v_mfma_f32_16x16x32_bf16 v[44:47], v[96:99], v[108:111], v[44:47]
    v_mfma_f32_16x16x32_bf16 v[48:51], v[100:103], v[104:107], v[48:51]
    v_mfma_f32_16x16x32_bf16 v[52:55], v[100:103], v[108:111], v[52:55]
    ds_read_b128 v[84:87], v9 offset:20480
    ds_read_b128 v[88:91], v9 offset:22528
    ds_read_b128 v[92:95], v9 offset:24576
    ds_read_b128 v[96:99], v9 offset:26624
    ds_read_b128 v[100:103], v9 offset:28672
    ds_read_b128 v[104:107], v13 offset:32768
    ds_read_b128 v[108:111], v13 offset:34816
    s_waitcnt lgkmcnt(7)
    v_mfma_f32_16x16x32_bf16 v[16:19], v[56:59], v[76:79], v[16:19]
    v_mfma_f32_16x16x32_bf16 v[20:23], v[56:59], v[80:83], v[20:23]
    v_mfma_f32_16x16x32_bf16 v[24:27], v[60:63], v[76:79], v[24:27]
    v_mfma_f32_16x16x32_bf16 v[28:31], v[60:63], v[80:83], v[28:31]
    v_mfma_f32_16x16x32_bf16 v[32:35], v[64:67], v[76:79], v[32:35]
    v_mfma_f32_16x16x32_bf16 v[36:39], v[64:67], v[80:83], v[36:39]
    v_mfma_f32_16x16x32_bf16 v[40:43], v[68:71], v[76:79], v[40:43]
    v_mfma_f32_16x16x32_bf16 v[44:47], v[68:71], v[80:83], v[44:47]
    v_mfma_f32_16x16x32_bf16 v[48:51], v[72:75], v[76:79], v[48:51]
    v_mfma_f32_16x16x32_bf16 v[52:55], v[72:75], v[80:83], v[52:55]
    s_waitcnt lgkmcnt(0)
    s_waitcnt vmcnt(14)
    s_barrier
    ds_read_b128 v[56:59], v6 offset:0
    ds_read_b128 v[60:63], v6 offset:2048
    ds_read_b128 v[64:67], v6 offset:4096
    ds_read_b128 v[68:71], v6 offset:6144
    ds_read_b128 v[72:75], v6 offset:8192
    ds_read_b128 v[76:79], v10 offset:12288
    ds_read_b128 v[80:83], v10 offset:14336
    s_add_u32 m0, s25, 86016
    s_nop 0
    buffer_load_dwordx4 v2, s[8:11], s32 offen lds
    v_mfma_f32_16x16x32_bf16 v[16:19], v[84:87], v[104:107], v[16:19]
    s_add_u32 m0, s25, 90112
    s_nop 0
    buffer_load_dwordx4 v2, s[8:11], s33 offen lds
    v_mfma_f32_16x16x32_bf16 v[20:23], v[84:87], v[108:111], v[20:23]
    s_add_u32 m0, s25, 94208
    s_nop 0
    buffer_load_dwordx4 v2, s[8:11], s34 offen lds
    v_mfma_f32_16x16x32_bf16 v[24:27], v[88:91], v[104:107], v[24:27]
    s_add_u32 m0, s25, 98304
    s_nop 0
    buffer_load_dwordx4 v3, s[12:15], s48 offen lds
    v_mfma_f32_16x16x32_bf16 v[28:31], v[88:91], v[108:111], v[28:31]
    s_add_u32 m0, s25, 102400
    s_nop 0
    buffer_load_dwordx4 v3, s[12:15], s49 offen lds
    v_mfma_f32_16x16x32_bf16 v[32:35], v[92:95], v[104:107], v[32:35]
    s_add_u32 m0, s25, 106496
    s_nop 0
    buffer_load_dwordx4 v3, s[12:15], s50 offen lds
    v_mfma_f32_16x16x32_bf16 v[36:39], v[92:95], v[108:111], v[36:39]
    s_add_u32 m0, s25, 110592
    s_nop 0
    buffer_load_dwordx4 v3, s[12:15], s51 offen lds
    v_mfma_f32_16x16x32_bf16 v[40:43], v[96:99], v[104:107], v[40:43]
    s_add_u32 s8, s8, 128
    s_addc_u32 s9, s9, 0
    s_add_u32 s12, s12, 128
    s_addc_u32 s13, s13, 0
    v_mfma_f32_16x16x32_bf16 v[44:47], v[96:99], v[108:111], v[44:47]
    v_mfma_f32_16x16x32_bf16 v[48:51], v[100:103], v[104:107], v[48:51]
    v_mfma_f32_16x16x32_bf16 v[52:55], v[100:103], v[108:111], v[52:55]
    ds_read_b128 v[84:87], v7 offset:0
    ds_read_b128 v[88:91], v7 offset:2048
    ds_read_b128 v[92:95], v7 offset:4096
    ds_read_b128 v[96:99], v7 offset:6144
    ds_read_b128 v[100:103], v7 offset:8192
    ds_read_b128 v[104:107], v11 offset:12288
    ds_read_b128 v[108:111], v11 offset:14336
    s_waitcnt lgkmcnt(7)
    v_mfma_f32_16x16x32_bf16 v[16:19], v[56:59], v[76:79], v[16:19]
    v_mfma_f32_16x16x32_bf16 v[20:23], v[56:59], v[80:83], v[20:23]
    v_mfma_f32_16x16x32_bf16 v[24:27], v[60:63], v[76:79], v[24:27]
    v_mfma_f32_16x16x32_bf16 v[28:31], v[60:63], v[80:83], v[28:31]
    v_mfma_f32_16x16x32_bf16 v[32:35], v[64:67], v[76:79], v[32:35]
    v_mfma_f32_16x16x32_bf16 v[36:39], v[64:67], v[80:83], v[36:39]
    v_mfma_f32_16x16x32_bf16 v[40:43], v[68:71], v[76:79], v[40:43]
    v_mfma_f32_16x16x32_bf16 v[44:47], v[68:71], v[80:83], v[44:47]
    v_mfma_f32_16x16x32_bf16 v[48:51], v[72:75], v[76:79], v[48:51]
    v_mfma_f32_16x16x32_bf16 v[52:55], v[72:75], v[80:83], v[52:55]
    s_waitcnt lgkmcnt(0)
    s_waitcnt vmcnt(14)
    s_barrier
    ds_read_b128 v[56:59], v6 offset:28672
    ds_read_b128 v[60:63], v6 offset:30720
    ds_read_b128 v[64:67], v6 offset:32768
    ds_read_b128 v[68:71], v6 offset:34816
    ds_read_b128 v[72:75], v6 offset:36864
    ds_read_b128 v[76:79], v10 offset:40960
    ds_read_b128 v[80:83], v10 offset:43008
    s_add_u32 m0, s25, 0
    s_nop 0
    buffer_load_dwordx4 v2, s[8:11], s32 offen lds
    v_mfma_f32_16x16x32_bf16 v[16:19], v[84:87], v[104:107], v[16:19]
    s_add_u32 m0, s25, 4096
    s_nop 0
    buffer_load_dwordx4 v2, s[8:11], s33 offen lds
    v_mfma_f32_16x16x32_bf16 v[20:23], v[84:87], v[108:111], v[20:23]
    s_add_u32 m0, s25, 8192
    s_nop 0
    buffer_load_dwordx4 v2, s[8:11], s34 offen lds
    v_mfma_f32_16x16x32_bf16 v[24:27], v[88:91], v[104:107], v[24:27]
    s_add_u32 m0, s25, 12288
    s_nop 0
    buffer_load_dwordx4 v3, s[12:15], s48 offen lds
    v_mfma_f32_16x16x32_bf16 v[28:31], v[88:91], v[108:111], v[28:31]
    s_add_u32 m0, s25, 16384
    s_nop 0
    buffer_load_dwordx4 v3, s[12:15], s49 offen lds
    v_mfma_f32_16x16x32_bf16 v[32:35], v[92:95], v[104:107], v[32:35]
    s_add_u32 m0, s25, 20480
    s_nop 0
    buffer_load_dwordx4 v3, s[12:15], s50 offen lds
    v_mfma_f32_16x16x32_bf16 v[36:39], v[92:95], v[108:111], v[36:39]
    s_add_u32 m0, s25, 24576
    s_nop 0
    buffer_load_dwordx4 v3, s[12:15], s51 offen lds
    v_mfma_f32_16x16x32_bf16 v[40:43], v[96:99], v[104:107], v[40:43]
    s_add_u32 s8, s8, 128
    s_addc_u32 s9, s9, 0
    s_add_u32 s12, s12, 128
    s_addc_u32 s13, s13, 0
    v_mfma_f32_16x16x32_bf16 v[44:47], v[96:99], v[108:111], v[44:47]
    v_mfma_f32_16x16x32_bf16 v[48:51], v[100:103], v[104:107], v[48:51]
    v_mfma_f32_16x16x32_bf16 v[52:55], v[100:103], v[108:111], v[52:55]
    ds_read_b128 v[84:87], v7 offset:28672
    ds_read_b128 v[88:91], v7 offset:30720
    ds_read_b128 v[92:95], v7 offset:32768
    ds_read_b128 v[96:99], v7 offset:34816
    ds_read_b128 v[100:103], v7 offset:36864
    ds_read_b128 v[104:107], v11 offset:40960
    ds_read_b128 v[108:111], v11 offset:43008
    s_waitcnt lgkmcnt(7)
    v_mfma_f32_16x16x32_bf16 v[16:19], v[56:59], v[76:79], v[16:19]
    v_mfma_f32_16x16x32_bf16 v[20:23], v[56:59], v[80:83], v[20:23]
    v_mfma_f32_16x16x32_bf16 v[24:27], v[60:63], v[76:79], v[24:27]
    v_mfma_f32_16x16x32_bf16 v[28:31], v[60:63], v[80:83], v[28:31]
    v_mfma_f32_16x16x32_bf16 v[32:35], v[64:67], v[76:79], v[32:35]
    v_mfma_f32_16x16x32_bf16 v[36:39], v[64:67], v[80:83], v[36:39]
    v_mfma_f32_16x16x32_bf16 v[40:43], v[68:71], v[76:79], v[40:43]
    v_mfma_f32_16x16x32_bf16 v[44:47], v[68:71], v[80:83], v[44:47]
    v_mfma_f32_16x16x32_bf16 v[48:51], v[72:75], v[76:79], v[48:51]
    v_mfma_f32_16x16x32_bf16 v[52:55], v[72:75], v[80:83], v[52:55]
    s_waitcnt lgkmcnt(0)
    s_waitcnt vmcnt(14)
    s_barrier
    ds_read_b128 v[56:59], v6 offset:57344
    ds_read_b128 v[60:63], v6 offset:59392
    ds_read_b128 v[64:67], v6 offset:61440
    ds_read_b128 v[68:71], v6 offset:63488
    ds_read_b128 v[72:75], v8 offset:0
    ds_read_b128 v[76:79], v12 offset:4096
    ds_read_b128 v[80:83], v12 offset:6144
    s_add_u32 m0, s25, 28672
    s_nop 0
    buffer_load_dwordx4 v2, s[8:11], s32 offen lds
    v_mfma_f32_16x16x32_bf16 v[16:19], v[84:87], v[104:107], v[16:19]
    s_add_u32 m0, s25, 32768
    s_nop 0
    buffer_load_dwordx4 v2, s[8:11], s33 offen lds
    v_mfma_f32_16x16x32_bf16 v[20:23], v[84:87], v[108:111], v[20:23]
    s_add_u32 m0, s25, 36864
    s_nop 0
    buffer_load_dwordx4 v2, s[8:11], s34 offen lds
    v_mfma_f32_16x16x32_bf16 v[24:27], v[88:91], v[104:107], v[24:27]
    s_add_u32 m0, s25, 40960
    s_nop 0
    buffer_load_dwordx4 v3, s[12:15], s48 offen lds
    v_mfma_f32_16x16x32_bf16 v[28:31], v[88:91], v[108:111], v[28:31]
    s_add_u32 m0, s25, 45056
    s_nop 0
    buffer_load_dwordx4 v3, s[12:15], s49 offen lds
    v_mfma_f32_16x16x32_bf16 v[32:35], v[92:95], v[104:107], v[32:35]
    s_add_u32 m0, s25, 49152
    s_nop 0
    buffer_load_dwordx4 v3, s[12:15], s50 offen lds
    v_mfma_f32_16x16x32_bf16 v[36:39], v[92:95], v[108:111], v[36:39]
    s_add_u32 m0, s25, 53248
    s_nop 0
    buffer_load_dwordx4 v3, s[12:15], s51 offen lds
    v_mfma_f32_16x16x32_bf16 v[40:43], v[96:99], v[104:107], v[40:43]
    s_add_u32 s8, s8, 128
    s_addc_u32 s9, s9, 0
    s_add_u32 s12, s12, 128
    s_addc_u32 s13, s13, 0
    v_mfma_f32_16x16x32_bf16 v[44:47], v[96:99], v[108:111], v[44:47]
    v_mfma_f32_16x16x32_bf16 v[48:51], v[100:103], v[104:107], v[48:51]
    v_mfma_f32_16x16x32_bf16 v[52:55], v[100:103], v[108:111], v[52:55]
    ds_read_b128 v[84:87], v7 offset:57344
    ds_read_b128 v[88:91], v7 offset:59392
    ds_read_b128 v[92:95], v7 offset:61440
    ds_read_b128 v[96:99], v7 offset:63488
    ds_read_b128 v[100:103], v9 offset:0
    ds_read_b128 v[104:107], v13 offset:4096
    ds_read_b128 v[108:111], v13 offset:6144
    s_waitcnt lgkmcnt(7)
    v_mfma_f32_16x16x32_bf16 v[16:19], v[56:59], v[76:79], v[16:19]
    v_mfma_f32_16x16x32_bf16 v[20:23], v[56:59], v[80:83], v[20:23]
    v_mfma_f32_16x16x32_bf16 v[24:27], v[60:63], v[76:79], v[24:27]
    v_mfma_f32_16x16x32_bf16 v[28:31], v[60:63], v[80:83], v[28:31]
    v_mfma_f32_16x16x32_bf16 v[32:35], v[64:67], v[76:79], v[32:35]
    v_mfma_f32_16x16x32_bf16 v[36:39], v[64:67], v[80:83], v[36:39]
    v_mfma_f32_16x16x32_bf16 v[40:43], v[68:71], v[76:79], v[40:43]
    v_mfma_f32_16x16x32_bf16 v[44:47], v[68:71], v[80:83], v[44:47]
    v_mfma_f32_16x16x32_bf16 v[48:51], v[72:75], v[76:79], v[48:51]
    v_mfma_f32_16x16x32_bf16 v[52:55], v[72:75], v[80:83], v[52:55]
    s_waitcnt lgkmcnt(0)
    s_waitcnt vmcnt(14)
    s_barrier
    ds_read_b128 v[56:59], v8 offset:20480
    ds_read_b128 v[60:63], v8 offset:22528
    ds_read_b128 v[64:67], v8 offset:24576
    ds_read_b128 v[68:71], v8 offset:26624
    ds_read_b128 v[72:75], v8 offset:28672
    ds_read_b128 v[76:79], v12 offset:32768
    ds_read_b128 v[80:83], v12 offset:34816
    s_add_u32 m0, s25, 57344
    s_nop 0
    buffer_load_dwordx4 v2, s[8:11], s32 offen lds
    v_mfma_f32_16x16x32_bf16 v[16:19], v[84:87], v[104:107], v[16:19]
    s_add_u32 m0, s25, 61440
    s_nop 0
    buffer_load_dwordx4 v2, s[8:11], s33 offen lds
    v_mfma_f32_16x16x32_bf16 v[20:23], v[84:87], v[108:111], v[20:23]
    s_add_u32 m0, s25, 65536
    s_nop 0
    buffer_load_dwordx4 v2, s[8:11], s34 offen lds
    v_mfma_f32_16x16x32_bf16 v[24:27], v[88:91], v[104:107], v[24:27]
    s_add_u32 m0, s25, 69632
    s_nop 0
    buffer_load_dwordx4 v3, s[12:15], s48 offen lds
    v_mfma_f32_16x16x32_bf16 v[28:31], v[88:91], v[108:111], v[28:31]
    s_add_u32 m0, s25, 73728
    s_nop 0
    buffer_load_dwordx4 v3, s[12:15], s49 offen lds
    v_mfma_f32_16x16x32_bf16 v[32:35], v[92:95], v[104:107], v[32:35]
    s_add_u32 m0, s25, 77824
    s_nop 0
    buffer_load_dwordx4 v3, s[12:15], s50 offen lds
    v_mfma_f32_16x16x32_bf16 v[36:39], v[92:95], v[108:111], v[36:39]
    s_add_u32 m0, s25, 81920
    s_nop 0
    buffer_load_dwordx4 v3, s[12:15], s51 offen lds
    v_mfma_f32_16x16x32_bf16 v[40:43], v[96:99], v[104:107], v[40:43]
    s_add_u32 s8, s8, 128
    s_addc_u32 s9, s9, 0
    s_add_u32 s12, s12, 128
    s_addc_u32 s13, s13, 0
    v_mfma_f32_16x16x32_bf16 v[44:47], v[96:99], v[108:111], v[44:47]
    v_mfma_f32_16x16x32_bf16 v[48:51], v[100:103], v[104:107], v[48:51]
    v_mfma_f32_16x16x32_bf16 v[52:55], v[100:103], v[108:111], v[52:55]
    ds_read_b128 v[84:87], v9 offset:20480
    ds_read_b128 v[88:91], v9 offset:22528
    ds_read_b128 v[92:95], v9 offset:24576
    ds_read_b128 v[96:99], v9 offset:26624
    ds_read_b128 v[100:103], v9 offset:28672
    ds_read_b128 v[104:107], v13 offset:32768
    ds_read_b128 v[108:111], v13 offset:34816
    s_waitcnt lgkmcnt(7)
    v_mfma_f32_16x16x32_bf16 v[16:19], v[56:59], v[76:79], v[16:19]
    v_mfma_f32_16x16x32_bf16 v[20:23], v[56:59], v[80:83], v[20:23]
    v_mfma_f32_16x16x32_bf16 v[24:27], v[60:63], v[76:79], v[24:27]
    v_mfma_f32_16x16x32_bf16 v[28:31], v[60:63], v[80:83], v[28:31]
    v_mfma_f32_16x16x32_bf16 v[32:35], v[64:67], v[76:79], v[32:35]
    v_mfma_f32_16x16x32_bf16 v[36:39], v[64:67], v[80:83], v[36:39]
    v_mfma_f32_16x16x32_bf16 v[40:43], v[68:71], v[76:79], v[40:43]
    v_mfma_f32_16x16x32_bf16 v[44:47], v[68:71], v[80:83], v[44:47]
    v_mfma_f32_16x16x32_bf16 v[48:51], v[72:75], v[76:79], v[48:51]
    v_mfma_f32_16x16x32_bf16 v[52:55], v[72:75], v[80:83], v[52:55]
    s_waitcnt lgkmcnt(0)
    s_waitcnt vmcnt(14)
    s_barrier
    ds_read_b128 v[56:59], v6 offset:0
    ds_read_b128 v[60:63], v6 offset:2048
    ds_read_b128 v[64:67], v6 offset:4096
    ds_read_b128 v[68:71], v6 offset:6144
    ds_read_b128 v[72:75], v6 offset:8192
    ds_read_b128 v[76:79], v10 offset:12288
    ds_read_b128 v[80:83], v10 offset:14336
    s_add_u32 m0, s25, 86016
    s_nop 0
    buffer_load_dwordx4 v2, s[8:11], s32 offen lds
    v_mfma_f32_16x16x32_bf16 v[16:19], v[84:87], v[104:107], v[16:19]
    s_add_u32 m0, s25, 90112
    s_nop 0
    buffer_load_dwordx4 v2, s[8:11], s33 offen lds
    v_mfma_f32_16x16x32_bf16 v[20:23], v[84:87], v[108:111], v[20:23]
    s_add_u32 m0, s25, 94208
    s_nop 0
    buffer_load_dwordx4 v2, s[8:11], s34 offen lds
    v_mfma_f32_16x16x32_bf16 v[24:27], v[88:91], v[104:107], v[24:27]
    s_add_u32 m0, s25, 98304
    s_nop 0
    buffer_load_dwordx4 v3, s[12:15], s48 offen lds
    v_mfma_f32_16x16x32_bf16 v[28:31], v[88:91], v[108:111], v[28:31]
    s_add_u32 m0, s25, 102400
    s_nop 0
    buffer_load_dwordx4 v3, s[12:15], s49 offen lds
    v_mfma_f32_16x16x32_bf16 v[32:35], v[92:95], v[104:107], v[32:35]
    s_add_u32 m0, s25, 106496
    s_nop 0
    buffer_load_dwordx4 v3, s[12:15], s50 offen lds
    v_mfma_f32_16x16x32_bf16 v[36:39], v[92:95], v[108:111], v[36:39]
    s_add_u32 m0, s25, 110592
    s_nop 0
    buffer_load_dwordx4 v3, s[12:15], s51 offen lds
    v_mfma_f32_16x16x32_bf16 v[40:43], v[96:99], v[104:107], v[40:43]
    s_add_u32 s8, s8, 128
    s_addc_u32 s9, s9, 0
    s_add_u32 s12, s12, 128
    s_addc_u32 s13, s13, 0
    v_mfma_f32_16x16x32_bf16 v[44:47], v[96:99], v[108:111], v[44:47]
    v_mfma_f32_16x16x32_bf16 v[48:51], v[100:103], v[104:107], v[48:51]
    v_mfma_f32_16x16x32_bf16 v[52:55], v[100:103], v[108:111], v[52:55]
    ds_read_b128 v[84:87], v7 offset:0
    ds_read_b128 v[88:91], v7 offset:2048
    ds_read_b128 v[92:95], v7 offset:4096
    ds_read_b128 v[96:99], v7 offset:6144
    ds_read_b128 v[100:103], v7 offset:8192
    ds_read_b128 v[104:107], v11 offset:12288
    ds_read_b128 v[108:111], v11 offset:14336
    s_waitcnt lgkmcnt(7)
    v_mfma_f32_16x16x32_bf16 v[16:19], v[56:59], v[76:79], v[16:19]
    v_mfma_f32_16x16x32_bf16 v[20:23], v[56:59], v[80:83], v[20:23]
    v_mfma_f32_16x16x32_bf16 v[24:27], v[60:63], v[76:79], v[24:27]
    v_mfma_f32_16x16x32_bf16 v[28:31], v[60:63], v[80:83], v[28:31]
    v_mfma_f32_16x16x32_bf16 v[32:35], v[64:67], v[76:79], v[32:35]
    v_mfma_f32_16x16x32_bf16 v[36:39], v[64:67], v[80:83], v[36:39]
    v_mfma_f32_16x16x32_bf16 v[40:43], v[68:71], v[76:79], v[40:43]
    v_mfma_f32_16x16x32_bf16 v[44:47], v[68:71], v[80:83], v[44:47]
    v_mfma_f32_16x16x32_bf16 v[48:51], v[72:75], v[76:79], v[48:51]
    v_mfma_f32_16x16x32_bf16 v[52:55], v[72:75], v[80:83], v[52:55]
    s_waitcnt lgkmcnt(0)
    s_waitcnt vmcnt(14)
    s_barrier
    ds_read_b128 v[56:59], v6 offset:28672
    ds_read_b128 v[60:63], v6 offset:30720
    ds_read_b128 v[64:67], v6 offset:32768
    ds_read_b128 v[68:71], v6 offset:34816
    ds_read_b128 v[72:75], v6 offset:36864
    ds_read_b128 v[76:79], v10 offset:40960
    ds_read_b128 v[80:83], v10 offset:43008
    s_add_u32 m0, s25, 0
    s_nop 0
    buffer_load_dwordx4 v2, s[8:11], s32 offen lds
    v_mfma_f32_16x16x32_bf16 v[16:19], v[84:87], v[104:107], v[16:19]
    s_add_u32 m0, s25, 4096
    s_nop 0
    buffer_load_dwordx4 v2, s[8:11], s33 offen lds
    v_mfma_f32_16x16x32_bf16 v[20:23], v[84:87], v[108:111], v[20:23]
    s_add_u32 m0, s25, 8192
    s_nop 0
    buffer_load_dwordx4 v2, s[8:11], s34 offen lds
    v_mfma_f32_16x16x32_bf16 v[24:27], v[88:91], v[104:107], v[24:27]
    s_add_u32 m0, s25, 12288
    s_nop 0
    buffer_load_dwordx4 v3, s[12:15], s48 offen lds
    v_mfma_f32_16x16x32_bf16 v[28:31], v[88:91], v[108:111], v[28:31]
    s_add_u32 m0, s25, 16384
    s_nop 0
    buffer_load_dwordx4 v3, s[12:15], s49 offen lds
    v_mfma_f32_16x16x32_bf16 v[32:35], v[92:95], v[104:107], v[32:35]
    s_add_u32 m0, s25, 20480
    s_nop 0
    buffer_load_dwordx4 v3, s[12:15], s50 offen lds
    v_mfma_f32_16x16x32_bf16 v[36:39], v[92:95], v[108:111], v[36:39]
    s_add_u32 m0, s25, 24576
    s_nop 0
    buffer_load_dwordx4 v3, s[12:15], s51 offen lds
    v_mfma_f32_16x16x32_bf16 v[40:43], v[96:99], v[104:107], v[40:43]
    s_add_u32 s8, s8, 128
    s_addc_u32 s9, s9, 0
    s_add_u32 s12, s12, 128
    s_addc_u32 s13, s13, 0
    v_mfma_f32_16x16x32_bf16 v[44:47], v[96:99], v[108:111], v[44:47]
    v_mfma_f32_16x16x32_bf16 v[48:51], v[100:103], v[104:107], v[48:51]
    v_mfma_f32_16x16x32_bf16 v[52:55], v[100:103], v[108:111], v[52:55]
    ds_read_b128 v[84:87], v7 offset:28672
    ds_read_b128 v[88:91], v7 offset:30720
    ds_read_b128 v[92:95], v7 offset:32768
    ds_read_b128 v[96:99], v7 offset:34816
    ds_read_b128 v[100:103], v7 offset:36864
    ds_read_b128 v[104:107], v11 offset:40960
    ds_read_b128 v[108:111], v11 offset:43008
    s_waitcnt lgkmcnt(7)
    v_mfma_f32_16x16x32_bf16 v[16:19], v[56:59], v[76:79], v[16:19]
    v_mfma_f32_16x16x32_bf16 v[20:23], v[56:59], v[80:83], v[20:23]
    v_mfma_f32_16x16x32_bf16 v[24:27], v[60:63], v[76:79], v[24:27]
    v_mfma_f32_16x16x32_bf16 v[28:31], v[60:63], v[80:83], v[28:31]
    v_mfma_f32_16x16x32_bf16 v[32:35], v[64:67], v[76:79], v[32:35]
    v_mfma_f32_16x16x32_bf16 v[36:39], v[64:67], v[80:83], v[36:39]
    v_mfma_f32_16x16x32_bf16 v[40:43], v[68:71], v[76:79], v[40:43]
    v_mfma_f32_16x16x32_bf16 v[44:47], v[68:71], v[80:83], v[44:47]
    v_mfma_f32_16x16x32_bf16 v[48:51], v[72:75], v[76:79], v[48:51]
    v_mfma_f32_16x16x32_bf16 v[52:55], v[72:75], v[80:83], v[52:55]
    s_waitcnt lgkmcnt(0)
    s_waitcnt vmcnt(14)
    s_barrier
    ds_read_b128 v[56:59], v6 offset:57344
    ds_read_b128 v[60:63], v6 offset:59392
    ds_read_b128 v[64:67], v6 offset:61440
    ds_read_b128 v[68:71], v6 offset:63488
    ds_read_b128 v[72:75], v8 offset:0
    ds_read_b128 v[76:79], v12 offset:4096
    ds_read_b128 v[80:83], v12 offset:6144
    s_add_u32 m0, s25, 28672
    s_nop 0
    buffer_load_dwordx4 v2, s[8:11], s32 offen lds
    v_mfma_f32_16x16x32_bf16 v[16:19], v[84:87], v[104:107], v[16:19]
    s_add_u32 m0, s25, 32768
    s_nop 0
    buffer_load_dwordx4 v2, s[8:11], s33 offen lds
    v_mfma_f32_16x16x32_bf16 v[20:23], v[84:87], v[108:111], v[20:23]
    s_add_u32 m0, s25, 36864
    s_nop 0
    buffer_load_dwordx4 v2, s[8:11], s34 offen lds
    v_mfma_f32_16x16x32_bf16 v[24:27], v[88:91], v[104:107], v[24:27]
    s_add_u32 m0, s25, 40960
    s_nop 0
    buffer_load_dwordx4 v3, s[12:15], s48 offen lds
    v_mfma_f32_16x16x32_bf16 v[28:31], v[88:91], v[108:111], v[28:31]
    s_add_u32 m0, s25, 45056
    s_nop 0
    buffer_load_dwordx4 v3, s[12:15], s49 offen lds
    v_mfma_f32_16x16x32_bf16 v[32:35], v[92:95], v[104:107], v[32:35]
    s_add_u32 m0, s25, 49152
    s_nop 0
    buffer_load_dwordx4 v3, s[12:15], s50 offen lds
    v_mfma_f32_16x16x32_bf16 v[36:39], v[92:95], v[108:111], v[36:39]
    s_add_u32 m0, s25, 53248
    s_nop 0
    buffer_load_dwordx4 v3, s[12:15], s51 offen lds
    v_mfma_f32_16x16x32_bf16 v[40:43], v[96:99], v[104:107], v[40:43]
    s_add_u32 s8, s8, 128
    s_addc_u32 s9, s9, 0
    s_add_u32 s12, s12, 128
    s_addc_u32 s13, s13, 0
    v_mfma_f32_16x16x32_bf16 v[44:47], v[96:99], v[108:111], v[44:47]
    v_mfma_f32_16x16x32_bf16 v[48:51], v[100:103], v[104:107], v[48:51]
    v_mfma_f32_16x16x32_bf16 v[52:55], v[100:103], v[108:111], v[52:55]
    ds_read_b128 v[84:87], v7 offset:57344
    ds_read_b128 v[88:91], v7 offset:59392
    ds_read_b128 v[92:95], v7 offset:61440
    ds_read_b128 v[96:99], v7 offset:63488
    ds_read_b128 v[100:103], v9 offset:0
    ds_read_b128 v[104:107], v13 offset:4096
    ds_read_b128 v[108:111], v13 offset:6144
    s_waitcnt lgkmcnt(7)
    v_mfma_f32_16x16x32_bf16 v[16:19], v[56:59], v[76:79], v[16:19]
    v_mfma_f32_16x16x32_bf16 v[20:23], v[56:59], v[80:83], v[20:23]
    v_mfma_f32_16x16x32_bf16 v[24:27], v[60:63], v[76:79], v[24:27]
    v_mfma_f32_16x16x32_bf16 v[28:31], v[60:63], v[80:83], v[28:31]
    v_mfma_f32_16x16x32_bf16 v[32:35], v[64:67], v[76:79], v[32:35]
    v_mfma_f32_16x16x32_bf16 v[36:39], v[64:67], v[80:83], v[36:39]
    v_mfma_f32_16x16x32_bf16 v[40:43], v[68:71], v[76:79], v[40:43]
    v_mfma_f32_16x16x32_bf16 v[44:47], v[68:71], v[80:83], v[44:47]
    v_mfma_f32_16x16x32_bf16 v[48:51], v[72:75], v[76:79], v[48:51]
    v_mfma_f32_16x16x32_bf16 v[52:55], v[72:75], v[80:83], v[52:55]
    s_waitcnt lgkmcnt(0)
    s_waitcnt vmcnt(14)
    s_barrier
    ds_read_b128 v[56:59], v8 offset:20480
    ds_read_b128 v[60:63], v8 offset:22528
    ds_read_b128 v[64:67], v8 offset:24576
    ds_read_b128 v[68:71], v8 offset:26624
    ds_read_b128 v[72:75], v8 offset:28672
    ds_read_b128 v[76:79], v12 offset:32768
    ds_read_b128 v[80:83], v12 offset:34816
    s_add_u32 m0, s25, 57344
    s_nop 0
    buffer_load_dwordx4 v2, s[8:11], s32 offen lds
    v_mfma_f32_16x16x32_bf16 v[16:19], v[84:87], v[104:107], v[16:19]
    s_add_u32 m0, s25, 61440
    s_nop 0
    buffer_load_dwordx4 v2, s[8:11], s33 offen lds
    v_mfma_f32_16x16x32_bf16 v[20:23], v[84:87], v[108:111], v[20:23]
    s_add_u32 m0, s25, 65536
    s_nop 0
    buffer_load_dwordx4 v2, s[8:11], s34 offen lds
    v_mfma_f32_16x16x32_bf16 v[24:27], v[88:91], v[104:107], v[24:27]
    s_add_u32 m0, s25, 69632
    s_nop 0
    buffer_load_dwordx4 v3, s[12:15], s48 offen lds
    v_mfma_f32_16x16x32_bf16 v[28:31], v[88:91], v[108:111], v[28:31]
    s_add_u32 m0, s25, 73728
    s_nop 0
    buffer_load_dwordx4 v3, s[12:15], s49 offen lds
    v_mfma_f32_16x16x32_bf16 v[32:35], v[92:95], v[104:107], v[32:35]
    s_add_u32 m0, s25, 77824
    s_nop 0
    buffer_load_dwordx4 v3, s[12:15], s50 offen lds
    v_mfma_f32_16x16x32_bf16 v[36:39], v[92:95], v[108:111], v[36:39]
    s_add_u32 m0, s25, 81920
    s_nop 0
    buffer_load_dwordx4 v3, s[12:15], s51 offen lds
    v_mfma_f32_16x16x32_bf16 v[40:43], v[96:99], v[104:107], v[40:43]
    s_add_u32 s8, s8, 128
    s_addc_u32 s9, s9, 0
    s_add_u32 s12, s12, 128
    s_addc_u32 s13, s13, 0
    v_mfma_f32_16x16x32_bf16 v[44:47], v[96:99], v[108:111], v[44:47]
    v_mfma_f32_16x16x32_bf16 v[48:51], v[100:103], v[104:107], v[48:51]
    v_mfma_f32_16x16x32_bf16 v[52:55], v[100:103], v[108:111], v[52:55]
    ds_read_b128 v[84:87], v9 offset:20480
    ds_read_b128 v[88:91], v9 offset:22528
    ds_read_b128 v[92:95], v9 offset:24576
    ds_read_b128 v[96:99], v9 offset:26624
    ds_read_b128 v[100:103], v9 offset:28672
    ds_read_b128 v[104:107], v13 offset:32768
    ds_read_b128 v[108:111], v13 offset:34816
    s_waitcnt lgkmcnt(7)
    v_mfma_f32_16x16x32_bf16 v[16:19], v[56:59], v[76:79], v[16:19]
    v_mfma_f32_16x16x32_bf16 v[20:23], v[56:59], v[80:83], v[20:23]
    v_mfma_f32_16x16x32_bf16 v[24:27], v[60:63], v[76:79], v[24:27]
    v_mfma_f32_16x16x32_bf16 v[28:31], v[60:63], v[80:83], v[28:31]
    v_mfma_f32_16x16x32_bf16 v[32:35], v[64:67], v[76:79], v[32:35]
    v_mfma_f32_16x16x32_bf16 v[36:39], v[64:67], v[80:83], v[36:39]
    v_mfma_f32_16x16x32_bf16 v[40:43], v[68:71], v[76:79], v[40:43]
    v_mfma_f32_16x16x32_bf16 v[44:47], v[68:71], v[80:83], v[44:47]
    v_mfma_f32_16x16x32_bf16 v[48:51], v[72:75], v[76:79], v[48:51]
    v_mfma_f32_16x16x32_bf16 v[52:55], v[72:75], v[80:83], v[52:55]
    s_waitcnt lgkmcnt(0)
    s_waitcnt vmcnt(14)
    s_barrier
    ds_read_b128 v[56:59], v6 offset:0
    ds_read_b128 v[60:63], v6 offset:2048
    ds_read_b128 v[64:67], v6 offset:4096
    ds_read_b128 v[68:71], v6 offset:6144
    ds_read_b128 v[72:75], v6 offset:8192
    ds_read_b128 v[76:79], v10 offset:12288
    ds_read_b128 v[80:83], v10 offset:14336
    s_add_u32 m0, s25, 86016
    s_nop 0
    buffer_load_dwordx4 v2, s[8:11], s32 offen lds
    v_mfma_f32_16x16x32_bf16 v[16:19], v[84:87], v[104:107], v[16:19]
    s_add_u32 m0, s25, 90112
    s_nop 0
    buffer_load_dwordx4 v2, s[8:11], s33 offen lds
    v_mfma_f32_16x16x32_bf16 v[20:23], v[84:87], v[108:111], v[20:23]
    s_add_u32 m0, s25, 94208
    s_nop 0
    buffer_load_dwordx4 v2, s[8:11], s34 offen lds
    v_mfma_f32_16x16x32_bf16 v[24:27], v[88:91], v[104:107], v[24:27]
    s_add_u32 m0, s25, 98304
    s_nop 0
    buffer_load_dwordx4 v3, s[12:15], s48 offen lds
    v_mfma_f32_16x16x32_bf16 v[28:31], v[88:91], v[108:111], v[28:31]
    s_add_u32 m0, s25, 102400
    s_nop 0
    buffer_load_dwordx4 v3, s[12:15], s49 offen lds
    v_mfma_f32_16x16x32_bf16 v[32:35], v[92:95], v[104:107], v[32:35]
    s_add_u32 m0, s25, 106496
    s_nop 0
    buffer_load_dwordx4 v3, s[12:15], s50 offen lds
    v_mfma_f32_16x16x32_bf16 v[36:39], v[92:95], v[108:111], v[36:39]
    s_add_u32 m0, s25, 110592
    s_nop 0
    buffer_load_dwordx4 v3, s[12:15], s51 offen lds
    v_mfma_f32_16x16x32_bf16 v[40:43], v[96:99], v[104:107], v[40:43]
    s_add_u32 s8, s8, 128
    s_addc_u32 s9, s9, 0
    s_add_u32 s12, s12, 128
    s_addc_u32 s13, s13, 0
    v_mfma_f32_16x16x32_bf16 v[44:47], v[96:99], v[108:111], v[44:47]
    v_mfma_f32_16x16x32_bf16 v[48:51], v[100:103], v[104:107], v[48:51]
    v_mfma_f32_16x16x32_bf16 v[52:55], v[100:103], v[108:111], v[52:55]
    ds_read_b128 v[84:87], v7 offset:0
    ds_read_b128 v[88:91], v7 offset:2048
    ds_read_b128 v[92:95], v7 offset:4096
    ds_read_b128 v[96:99], v7 offset:6144
    ds_read_b128 v[100:103], v7 offset:8192
    ds_read_b128 v[104:107], v11 offset:12288
    ds_read_b128 v[108:111], v11 offset:14336
    s_waitcnt lgkmcnt(7)
    v_mfma_f32_16x16x32_bf16 v[16:19], v[56:59], v[76:79], v[16:19]
    v_mfma_f32_16x16x32_bf16 v[20:23], v[56:59], v[80:83], v[20:23]
    v_mfma_f32_16x16x32_bf16 v[24:27], v[60:63], v[76:79], v[24:27]
    v_mfma_f32_16x16x32_bf16 v[28:31], v[60:63], v[80:83], v[28:31]
    v_mfma_f32_16x16x32_bf16 v[32:35], v[64:67], v[76:79], v[32:35]
    v_mfma_f32_16x16x32_bf16 v[36:39], v[64:67], v[80:83], v[36:39]
    v_mfma_f32_16x16x32_bf16 v[40:43], v[68:71], v[76:79], v[40:43]
    v_mfma_f32_16x16x32_bf16 v[44:47], v[68:71], v[80:83], v[44:47]
    v_mfma_f32_16x16x32_bf16 v[48:51], v[72:75], v[76:79], v[48:51]
    v_mfma_f32_16x16x32_bf16 v[52:55], v[72:75], v[80:83], v[52:55]
    s_waitcnt lgkmcnt(0)
    s_waitcnt vmcnt(14)
    s_barrier
    ds_read_b128 v[56:59], v6 offset:28672
    ds_read_b128 v[60:63], v6 offset:30720
    ds_read_b128 v[64:67], v6 offset:32768
    ds_read_b128 v[68:71], v6 offset:34816
    ds_read_b128 v[72:75], v6 offset:36864
    ds_read_b128 v[76:79], v10 offset:40960
    ds_read_b128 v[80:83], v10 offset:43008
    s_add_u32 m0, s25, 0
    s_nop 0
    buffer_load_dwordx4 v2, s[8:11], s32 offen lds
    v_mfma_f32_16x16x32_bf16 v[16:19], v[84:87], v[104:107], v[16:19]
    s_add_u32 m0, s25, 4096
    s_nop 0
    buffer_load_dwordx4 v2, s[8:11], s33 offen lds
    v_mfma_f32_16x16x32_bf16 v[20:23], v[84:87], v[108:111], v[20:23]
    s_add_u32 m0, s25, 8192
    s_nop 0
    buffer_load_dwordx4 v2, s[8:11], s34 offen lds
    v_mfma_f32_16x16x32_bf16 v[24:27], v[88:91], v[104:107], v[24:27]
    s_add_u32 m0, s25, 12288
    s_nop 0
    buffer_load_dwordx4 v3, s[12:15], s48 offen lds
    v_mfma_f32_16x16x32_bf16 v[28:31], v[88:91], v[108:111], v[28:31]
    s_add_u32 m0, s25, 16384
    s_nop 0
    buffer_load_dwordx4 v3, s[12:15], s49 offen lds
    v_mfma_f32_16x16x32_bf16 v[32:35], v[92:95], v[104:107], v[32:35]
    s_add_u32 m0, s25, 20480
    s_nop 0
    buffer_load_dwordx4 v3, s[12:15], s50 offen lds
    v_mfma_f32_16x16x32_bf16 v[36:39], v[92:95], v[108:111], v[36:39]
    s_add_u32 m0, s25, 24576
    s_nop 0
    buffer_load_dwordx4 v3, s[12:15], s51 offen lds
    v_mfma_f32_16x16x32_bf16 v[40:43], v[96:99], v[104:107], v[40:43]
    s_add_u32 s8, s8, 128
    s_addc_u32 s9, s9, 0
    s_add_u32 s12, s12, 128
    s_addc_u32 s13, s13, 0
    v_mfma_f32_16x16x32_bf16 v[44:47], v[96:99], v[108:111], v[44:47]
    v_mfma_f32_16x16x32_bf16 v[48:51], v[100:103], v[104:107], v[48:51]
    v_mfma_f32_16x16x32_bf16 v[52:55], v[100:103], v[108:111], v[52:55]
    ds_read_b128 v[84:87], v7 offset:28672
    ds_read_b128 v[88:91], v7 offset:30720
    ds_read_b128 v[92:95], v7 offset:32768
    ds_read_b128 v[96:99], v7 offset:34816
    ds_read_b128 v[100:103], v7 offset:36864
    ds_read_b128 v[104:107], v11 offset:40960
    ds_read_b128 v[108:111], v11 offset:43008
    s_waitcnt lgkmcnt(7)
    v_mfma_f32_16x16x32_bf16 v[16:19], v[56:59], v[76:79], v[16:19]
    v_mfma_f32_16x16x32_bf16 v[20:23], v[56:59], v[80:83], v[20:23]
    v_mfma_f32_16x16x32_bf16 v[24:27], v[60:63], v[76:79], v[24:27]
    v_mfma_f32_16x16x32_bf16 v[28:31], v[60:63], v[80:83], v[28:31]
    v_mfma_f32_16x16x32_bf16 v[32:35], v[64:67], v[76:79], v[32:35]
    v_mfma_f32_16x16x32_bf16 v[36:39], v[64:67], v[80:83], v[36:39]
    v_mfma_f32_16x16x32_bf16 v[40:43], v[68:71], v[76:79], v[40:43]
    v_mfma_f32_16x16x32_bf16 v[44:47], v[68:71], v[80:83], v[44:47]
    v_mfma_f32_16x16x32_bf16 v[48:51], v[72:75], v[76:79], v[48:51]
    v_mfma_f32_16x16x32_bf16 v[52:55], v[72:75], v[80:83], v[52:55]
    s_waitcnt lgkmcnt(0)
    s_waitcnt vmcnt(14)
    s_barrier
    ds_read_b128 v[56:59], v6 offset:57344
    ds_read_b128 v[60:63], v6 offset:59392
    ds_read_b128 v[64:67], v6 offset:61440
    ds_read_b128 v[68:71], v6 offset:63488
    ds_read_b128 v[72:75], v8 offset:0
    ds_read_b128 v[76:79], v12 offset:4096
    ds_read_b128 v[80:83], v12 offset:6144
    s_add_u32 m0, s25, 28672
    s_nop 0
    buffer_load_dwordx4 v2, s[8:11], s32 offen lds
    v_mfma_f32_16x16x32_bf16 v[16:19], v[84:87], v[104:107], v[16:19]
    s_add_u32 m0, s25, 32768
    s_nop 0
    buffer_load_dwordx4 v2, s[8:11], s33 offen lds
    v_mfma_f32_16x16x32_bf16 v[20:23], v[84:87], v[108:111], v[20:23]
    s_add_u32 m0, s25, 36864
    s_nop 0
    buffer_load_dwordx4 v2, s[8:11], s34 offen lds
    v_mfma_f32_16x16x32_bf16 v[24:27], v[88:91], v[104:107], v[24:27]
    s_add_u32 m0, s25, 40960
    s_nop 0
    buffer_load_dwordx4 v3, s[12:15], s48 offen lds
    v_mfma_f32_16x16x32_bf16 v[28:31], v[88:91], v[108:111], v[28:31]
    s_add_u32 m0, s25, 45056
    s_nop 0
    buffer_load_dwordx4 v3, s[12:15], s49 offen lds
    v_mfma_f32_16x16x32_bf16 v[32:35], v[92:95], v[104:107], v[32:35]
    s_add_u32 m0, s25, 49152
    s_nop 0
    buffer_load_dwordx4 v3, s[12:15], s50 offen lds
    v_mfma_f32_16x16x32_bf16 v[36:39], v[92:95], v[108:111], v[36:39]
    s_add_u32 m0, s25, 53248
    s_nop 0
    buffer_load_dwordx4 v3, s[12:15], s51 offen lds
    v_mfma_f32_16x16x32_bf16 v[40:43], v[96:99], v[104:107], v[40:43]
    s_add_u32 s8, s8, 128
    s_addc_u32 s9, s9, 0
    s_add_u32 s12, s12, 128
    s_addc_u32 s13, s13, 0
    v_mfma_f32_16x16x32_bf16 v[44:47], v[96:99], v[108:111], v[44:47]
    v_mfma_f32_16x16x32_bf16 v[48:51], v[100:103], v[104:107], v[48:51]
    v_mfma_f32_16x16x32_bf16 v[52:55], v[100:103], v[108:111], v[52:55]
    ds_read_b128 v[84:87], v7 offset:57344
    ds_read_b128 v[88:91], v7 offset:59392
    ds_read_b128 v[92:95], v7 offset:61440
    ds_read_b128 v[96:99], v7 offset:63488
    ds_read_b128 v[100:103], v9 offset:0
    ds_read_b128 v[104:107], v13 offset:4096
    ds_read_b128 v[108:111], v13 offset:6144
    s_waitcnt lgkmcnt(7)
    v_mfma_f32_16x16x32_bf16 v[16:19], v[56:59], v[76:79], v[16:19]
    v_mfma_f32_16x16x32_bf16 v[20:23], v[56:59], v[80:83], v[20:23]
    v_mfma_f32_16x16x32_bf16 v[24:27], v[60:63], v[76:79], v[24:27]
    v_mfma_f32_16x16x32_bf16 v[28:31], v[60:63], v[80:83], v[28:31]
    v_mfma_f32_16x16x32_bf16 v[32:35], v[64:67], v[76:79], v[32:35]
    v_mfma_f32_16x16x32_bf16 v[36:39], v[64:67], v[80:83], v[36:39]
    v_mfma_f32_16x16x32_bf16 v[40:43], v[68:71], v[76:79], v[40:43]
    v_mfma_f32_16x16x32_bf16 v[44:47], v[68:71], v[80:83], v[44:47]
    v_mfma_f32_16x16x32_bf16 v[48:51], v[72:75], v[76:79], v[48:51]
    v_mfma_f32_16x16x32_bf16 v[52:55], v[72:75], v[80:83], v[52:55]
    s_waitcnt lgkmcnt(0)
    s_waitcnt vmcnt(14)
    s_barrier
    ds_read_b128 v[56:59], v8 offset:20480
    ds_read_b128 v[60:63], v8 offset:22528
    ds_read_b128 v[64:67], v8 offset:24576
    ds_read_b128 v[68:71], v8 offset:26624
    ds_read_b128 v[72:75], v8 offset:28672
    ds_read_b128 v[76:79], v12 offset:32768
    ds_read_b128 v[80:83], v12 offset:34816
    s_add_u32 m0, s25, 57344
    s_nop 0
    buffer_load_dwordx4 v2, s[8:11], s32 offen lds
    v_mfma_f32_16x16x32_bf16 v[16:19], v[84:87], v[104:107], v[16:19]
    s_add_u32 m0, s25, 61440
    s_nop 0
    buffer_load_dwordx4 v2, s[8:11], s33 offen lds
    v_mfma_f32_16x16x32_bf16 v[20:23], v[84:87], v[108:111], v[20:23]
    s_add_u32 m0, s25, 65536
    s_nop 0
    buffer_load_dwordx4 v2, s[8:11], s34 offen lds
    v_mfma_f32_16x16x32_bf16 v[24:27], v[88:91], v[104:107], v[24:27]
    s_add_u32 m0, s25, 69632
    s_nop 0
    buffer_load_dwordx4 v3, s[12:15], s48 offen lds
    v_mfma_f32_16x16x32_bf16 v[28:31], v[88:91], v[108:111], v[28:31]
    s_add_u32 m0, s25, 73728
    s_nop 0
    buffer_load_dwordx4 v3, s[12:15], s49 offen lds
    v_mfma_f32_16x16x32_bf16 v[32:35], v[92:95], v[104:107], v[32:35]
    s_add_u32 m0, s25, 77824
    s_nop 0
    buffer_load_dwordx4 v3, s[12:15], s50 offen lds
    v_mfma_f32_16x16x32_bf16 v[36:39], v[92:95], v[108:111], v[36:39]
    s_add_u32 m0, s25, 81920
    s_nop 0
    buffer_load_dwordx4 v3, s[12:15], s51 offen lds
    v_mfma_f32_16x16x32_bf16 v[40:43], v[96:99], v[104:107], v[40:43]
    s_add_u32 s8, s8, 128
    s_addc_u32 s9, s9, 0
    s_add_u32 s12, s12, 128
    s_addc_u32 s13, s13, 0
    v_mfma_f32_16x16x32_bf16 v[44:47], v[96:99], v[108:111], v[44:47]
    v_mfma_f32_16x16x32_bf16 v[48:51], v[100:103], v[104:107], v[48:51]
    v_mfma_f32_16x16x32_bf16 v[52:55], v[100:103], v[108:111], v[52:55]
    ds_read_b128 v[84:87], v9 offset:20480
    ds_read_b128 v[88:91], v9 offset:22528
    ds_read_b128 v[92:95], v9 offset:24576
    ds_read_b128 v[96:99], v9 offset:26624
    ds_read_b128 v[100:103], v9 offset:28672
    ds_read_b128 v[104:107], v13 offset:32768
    ds_read_b128 v[108:111], v13 offset:34816
    s_waitcnt lgkmcnt(7)
    v_mfma_f32_16x16x32_bf16 v[16:19], v[56:59], v[76:79], v[16:19]
    v_mfma_f32_16x16x32_bf16 v[20:23], v[56:59], v[80:83], v[20:23]
    v_mfma_f32_16x16x32_bf16 v[24:27], v[60:63], v[76:79], v[24:27]
    v_mfma_f32_16x16x32_bf16 v[28:31], v[60:63], v[80:83], v[28:31]
    v_mfma_f32_16x16x32_bf16 v[32:35], v[64:67], v[76:79], v[32:35]
    v_mfma_f32_16x16x32_bf16 v[36:39], v[64:67], v[80:83], v[36:39]
    v_mfma_f32_16x16x32_bf16 v[40:43], v[68:71], v[76:79], v[40:43]
    v_mfma_f32_16x16x32_bf16 v[44:47], v[68:71], v[80:83], v[44:47]
    v_mfma_f32_16x16x32_bf16 v[48:51], v[72:75], v[76:79], v[48:51]
    v_mfma_f32_16x16x32_bf16 v[52:55], v[72:75], v[80:83], v[52:55]
    s_waitcnt lgkmcnt(0)
    s_waitcnt vmcnt(14)
    s_barrier
    ds_read_b128 v[56:59], v6 offset:0
    ds_read_b128 v[60:63], v6 offset:2048
    ds_read_b128 v[64:67], v6 offset:4096
    ds_read_b128 v[68:71], v6 offset:6144
    ds_read_b128 v[72:75], v6 offset:8192
    ds_read_b128 v[76:79], v10 offset:12288
    ds_read_b128 v[80:83], v10 offset:14336
    s_add_u32 m0, s25, 86016
    s_nop 0
    buffer_load_dwordx4 v2, s[8:11], s32 offen lds
    v_mfma_f32_16x16x32_bf16 v[16:19], v[84:87], v[104:107], v[16:19]
    s_add_u32 m0, s25, 90112
    s_nop 0
    buffer_load_dwordx4 v2, s[8:11], s33 offen lds
    v_mfma_f32_16x16x32_bf16 v[20:23], v[84:87], v[108:111], v[20:23]
    s_add_u32 m0, s25, 94208
    s_nop 0
    buffer_load_dwordx4 v2, s[8:11], s34 offen lds
    v_mfma_f32_16x16x32_bf16 v[24:27], v[88:91], v[104:107], v[24:27]
    s_add_u32 m0, s25, 98304
    s_nop 0
    buffer_load_dwordx4 v3, s[12:15], s48 offen lds
    v_mfma_f32_16x16x32_bf16 v[28:31], v[88:91], v[108:111], v[28:31]
    s_add_u32 m0, s25, 102400
    s_nop 0
    buffer_load_dwordx4 v3, s[12:15], s49 offen lds
    v_mfma_f32_16x16x32_bf16 v[32:35], v[92:95], v[104:107], v[32:35]
    s_add_u32 m0, s25, 106496
    s_nop 0
    buffer_load_dwordx4 v3, s[12:15], s50 offen lds
    v_mfma_f32_16x16x32_bf16 v[36:39], v[92:95], v[108:111], v[36:39]
    s_add_u32 m0, s25, 110592
    s_nop 0
    buffer_load_dwordx4 v3, s[12:15], s51 offen lds
    v_mfma_f32_16x16x32_bf16 v[40:43], v[96:99], v[104:107], v[40:43]
    s_add_u32 s8, s8, 128
    s_addc_u32 s9, s9, 0
    s_add_u32 s12, s12, 128
    s_addc_u32 s13, s13, 0
    v_mfma_f32_16x16x32_bf16 v[44:47], v[96:99], v[108:111], v[44:47]
    v_mfma_f32_16x16x32_bf16 v[48:51], v[100:103], v[104:107], v[48:51]
    v_mfma_f32_16x16x32_bf16 v[52:55], v[100:103], v[108:111], v[52:55]
    ds_read_b128 v[84:87], v7 offset:0
    ds_read_b128 v[88:91], v7 offset:2048
    ds_read_b128 v[92:95], v7 offset:4096
    ds_read_b128 v[96:99], v7 offset:6144
    ds_read_b128 v[100:103], v7 offset:8192
    ds_read_b128 v[104:107], v11 offset:12288
    ds_read_b128 v[108:111], v11 offset:14336
    s_waitcnt lgkmcnt(7)
    v_mfma_f32_16x16x32_bf16 v[16:19], v[56:59], v[76:79], v[16:19]
    v_mfma_f32_16x16x32_bf16 v[20:23], v[56:59], v[80:83], v[20:23]
    v_mfma_f32_16x16x32_bf16 v[24:27], v[60:63], v[76:79], v[24:27]
    v_mfma_f32_16x16x32_bf16 v[28:31], v[60:63], v[80:83], v[28:31]
    v_mfma_f32_16x16x32_bf16 v[32:35], v[64:67], v[76:79], v[32:35]
    v_mfma_f32_16x16x32_bf16 v[36:39], v[64:67], v[80:83], v[36:39]
    v_mfma_f32_16x16x32_bf16 v[40:43], v[68:71], v[76:79], v[40:43]
    v_mfma_f32_16x16x32_bf16 v[44:47], v[68:71], v[80:83], v[44:47]
    v_mfma_f32_16x16x32_bf16 v[48:51], v[72:75], v[76:79], v[48:51]
    v_mfma_f32_16x16x32_bf16 v[52:55], v[72:75], v[80:83], v[52:55]
    s_waitcnt lgkmcnt(0)
    s_waitcnt vmcnt(14)
    s_barrier
    ds_read_b128 v[56:59], v6 offset:28672
    ds_read_b128 v[60:63], v6 offset:30720
    ds_read_b128 v[64:67], v6 offset:32768
    ds_read_b128 v[68:71], v6 offset:34816
    ds_read_b128 v[72:75], v6 offset:36864
    ds_read_b128 v[76:79], v10 offset:40960
    ds_read_b128 v[80:83], v10 offset:43008
    s_add_u32 m0, s25, 0
    s_nop 0
    buffer_load_dwordx4 v2, s[8:11], s32 offen lds
    v_mfma_f32_16x16x32_bf16 v[16:19], v[84:87], v[104:107], v[16:19]
    s_add_u32 m0, s25, 4096
    s_nop 0
    buffer_load_dwordx4 v2, s[8:11], s33 offen lds
    v_mfma_f32_16x16x32_bf16 v[20:23], v[84:87], v[108:111], v[20:23]
    s_add_u32 m0, s25, 8192
    s_nop 0
    buffer_load_dwordx4 v2, s[8:11], s34 offen lds
    v_mfma_f32_16x16x32_bf16 v[24:27], v[88:91], v[104:107], v[24:27]
    s_add_u32 m0, s25, 12288
    s_nop 0
    buffer_load_dwordx4 v3, s[12:15], s48 offen lds
    v_mfma_f32_16x16x32_bf16 v[28:31], v[88:91], v[108:111], v[28:31]
    s_add_u32 m0, s25, 16384
    s_nop 0
    buffer_load_dwordx4 v3, s[12:15], s49 offen lds
    v_mfma_f32_16x16x32_bf16 v[32:35], v[92:95], v[104:107], v[32:35]
    s_add_u32 m0, s25, 20480
    s_nop 0
    buffer_load_dwordx4 v3, s[12:15], s50 offen lds
    v_mfma_f32_16x16x32_bf16 v[36:39], v[92:95], v[108:111], v[36:39]
    s_add_u32 m0, s25, 24576
    s_nop 0
    buffer_load_dwordx4 v3, s[12:15], s51 offen lds
    v_mfma_f32_16x16x32_bf16 v[40:43], v[96:99], v[104:107], v[40:43]
    s_add_u32 s8, s8, 128
    s_addc_u32 s9, s9, 0
    s_add_u32 s12, s12, 128
    s_addc_u32 s13, s13, 0
    v_mfma_f32_16x16x32_bf16 v[44:47], v[96:99], v[108:111], v[44:47]
    v_mfma_f32_16x16x32_bf16 v[48:51], v[100:103], v[104:107], v[48:51]
    v_mfma_f32_16x16x32_bf16 v[52:55], v[100:103], v[108:111], v[52:55]
    ds_read_b128 v[84:87], v7 offset:28672
    ds_read_b128 v[88:91], v7 offset:30720
    ds_read_b128 v[92:95], v7 offset:32768
    ds_read_b128 v[96:99], v7 offset:34816
    ds_read_b128 v[100:103], v7 offset:36864
    ds_read_b128 v[104:107], v11 offset:40960
    ds_read_b128 v[108:111], v11 offset:43008
    s_waitcnt lgkmcnt(7)
    v_mfma_f32_16x16x32_bf16 v[16:19], v[56:59], v[76:79], v[16:19]
    v_mfma_f32_16x16x32_bf16 v[20:23], v[56:59], v[80:83], v[20:23]
    v_mfma_f32_16x16x32_bf16 v[24:27], v[60:63], v[76:79], v[24:27]
    v_mfma_f32_16x16x32_bf16 v[28:31], v[60:63], v[80:83], v[28:31]
    v_mfma_f32_16x16x32_bf16 v[32:35], v[64:67], v[76:79], v[32:35]
    v_mfma_f32_16x16x32_bf16 v[36:39], v[64:67], v[80:83], v[36:39]
    v_mfma_f32_16x16x32_bf16 v[40:43], v[68:71], v[76:79], v[40:43]
    v_mfma_f32_16x16x32_bf16 v[44:47], v[68:71], v[80:83], v[44:47]
    v_mfma_f32_16x16x32_bf16 v[48:51], v[72:75], v[76:79], v[48:51]
    v_mfma_f32_16x16x32_bf16 v[52:55], v[72:75], v[80:83], v[52:55]
    s_waitcnt lgkmcnt(0)
    s_waitcnt vmcnt(14)
    s_barrier
    ds_read_b128 v[56:59], v6 offset:57344
    ds_read_b128 v[60:63], v6 offset:59392
    ds_read_b128 v[64:67], v6 offset:61440
    ds_read_b128 v[68:71], v6 offset:63488
    ds_read_b128 v[72:75], v8 offset:0
    ds_read_b128 v[76:79], v12 offset:4096
    ds_read_b128 v[80:83], v12 offset:6144
    s_add_u32 m0, s25, 28672
    s_nop 0
    buffer_load_dwordx4 v2, s[8:11], s32 offen lds
    v_mfma_f32_16x16x32_bf16 v[16:19], v[84:87], v[104:107], v[16:19]
    s_add_u32 m0, s25, 32768
    s_nop 0
    buffer_load_dwordx4 v2, s[8:11], s33 offen lds
    v_mfma_f32_16x16x32_bf16 v[20:23], v[84:87], v[108:111], v[20:23]
    s_add_u32 m0, s25, 36864
    s_nop 0
    buffer_load_dwordx4 v2, s[8:11], s34 offen lds
    v_mfma_f32_16x16x32_bf16 v[24:27], v[88:91], v[104:107], v[24:27]
    s_add_u32 m0, s25, 40960
    s_nop 0
    buffer_load_dwordx4 v3, s[12:15], s48 offen lds
    v_mfma_f32_16x16x32_bf16 v[28:31], v[88:91], v[108:111], v[28:31]
    s_add_u32 m0, s25, 45056
    s_nop 0
    buffer_load_dwordx4 v3, s[12:15], s49 offen lds
    v_mfma_f32_16x16x32_bf16 v[32:35], v[92:95], v[104:107], v[32:35]
    s_add_u32 m0, s25, 49152
    s_nop 0
    buffer_load_dwordx4 v3, s[12:15], s50 offen lds
    v_mfma_f32_16x16x32_bf16 v[36:39], v[92:95], v[108:111], v[36:39]
    s_add_u32 m0, s25, 53248
    s_nop 0
    buffer_load_dwordx4 v3, s[12:15], s51 offen lds
    v_mfma_f32_16x16x32_bf16 v[40:43], v[96:99], v[104:107], v[40:43]
    s_add_u32 s8, s8, 128
    s_addc_u32 s9, s9, 0
    s_add_u32 s12, s12, 128
    s_addc_u32 s13, s13, 0
    v_mfma_f32_16x16x32_bf16 v[44:47], v[96:99], v[108:111], v[44:47]
    v_mfma_f32_16x16x32_bf16 v[48:51], v[100:103], v[104:107], v[48:51]
    v_mfma_f32_16x16x32_bf16 v[52:55], v[100:103], v[108:111], v[52:55]
    ds_read_b128 v[84:87], v7 offset:57344
    ds_read_b128 v[88:91], v7 offset:59392
    ds_read_b128 v[92:95], v7 offset:61440
    ds_read_b128 v[96:99], v7 offset:63488
    ds_read_b128 v[100:103], v9 offset:0
    ds_read_b128 v[104:107], v13 offset:4096
    ds_read_b128 v[108:111], v13 offset:6144
    s_waitcnt lgkmcnt(7)
    v_mfma_f32_16x16x32_bf16 v[16:19], v[56:59], v[76:79], v[16:19]
    v_mfma_f32_16x16x32_bf16 v[20:23], v[56:59], v[80:83], v[20:23]
    v_mfma_f32_16x16x32_bf16 v[24:27], v[60:63], v[76:79], v[24:27]
    v_mfma_f32_16x16x32_bf16 v[28:31], v[60:63], v[80:83], v[28:31]
    v_mfma_f32_16x16x32_bf16 v[32:35], v[64:67], v[76:79], v[32:35]
    v_mfma_f32_16x16x32_bf16 v[36:39], v[64:67], v[80:83], v[36:39]
    v_mfma_f32_16x16x32_bf16 v[40:43], v[68:71], v[76:79], v[40:43]
    v_mfma_f32_16x16x32_bf16 v[44:47], v[68:71], v[80:83], v[44:47]
    v_mfma_f32_16x16x32_bf16 v[48:51], v[72:75], v[76:79], v[48:51]
    v_mfma_f32_16x16x32_bf16 v[52:55], v[72:75], v[80:83], v[52:55]
    s_waitcnt lgkmcnt(0)
    s_waitcnt vmcnt(14)
    s_barrier
    ds_read_b128 v[56:59], v8 offset:20480
    ds_read_b128 v[60:63], v8 offset:22528
    ds_read_b128 v[64:67], v8 offset:24576
    ds_read_b128 v[68:71], v8 offset:26624
    ds_read_b128 v[72:75], v8 offset:28672
    ds_read_b128 v[76:79], v12 offset:32768
    ds_read_b128 v[80:83], v12 offset:34816
    s_add_u32 m0, s25, 57344
    s_nop 0
    buffer_load_dwordx4 v2, s[8:11], s32 offen lds
    v_mfma_f32_16x16x32_bf16 v[16:19], v[84:87], v[104:107], v[16:19]
    s_add_u32 m0, s25, 61440
    s_nop 0
    buffer_load_dwordx4 v2, s[8:11], s33 offen lds
    v_mfma_f32_16x16x32_bf16 v[20:23], v[84:87], v[108:111], v[20:23]
    s_add_u32 m0, s25, 65536
    s_nop 0
    buffer_load_dwordx4 v2, s[8:11], s34 offen lds
    v_mfma_f32_16x16x32_bf16 v[24:27], v[88:91], v[104:107], v[24:27]
    s_add_u32 m0, s25, 69632
    s_nop 0
    buffer_load_dwordx4 v3, s[12:15], s48 offen lds
    v_mfma_f32_16x16x32_bf16 v[28:31], v[88:91], v[108:111], v[28:31]
    s_add_u32 m0, s25, 73728
    s_nop 0
    buffer_load_dwordx4 v3, s[12:15], s49 offen lds
    v_mfma_f32_16x16x32_bf16 v[32:35], v[92:95], v[104:107], v[32:35]
    s_add_u32 m0, s25, 77824
    s_nop 0
    buffer_load_dwordx4 v3, s[12:15], s50 offen lds
    v_mfma_f32_16x16x32_bf16 v[36:39], v[92:95], v[108:111], v[36:39]
    s_add_u32 m0, s25, 81920
    s_nop 0
    buffer_load_dwordx4 v3, s[12:15], s51 offen lds
    v_mfma_f32_16x16x32_bf16 v[40:43], v[96:99], v[104:107], v[40:43]
    s_add_u32 s8, s8, 128
    s_addc_u32 s9, s9, 0
    s_add_u32 s12, s12, 128
    s_addc_u32 s13, s13, 0
    v_mfma_f32_16x16x32_bf16 v[44:47], v[96:99], v[108:111], v[44:47]
    v_mfma_f32_16x16x32_bf16 v[48:51], v[100:103], v[104:107], v[48:51]
    v_mfma_f32_16x16x32_bf16 v[52:55], v[100:103], v[108:111], v[52:55]
    ds_read_b128 v[84:87], v9 offset:20480
    ds_read_b128 v[88:91], v9 offset:22528
    ds_read_b128 v[92:95], v9 offset:24576
    ds_read_b128 v[96:99], v9 offset:26624
    ds_read_b128 v[100:103], v9 offset:28672
    ds_read_b128 v[104:107], v13 offset:32768
    ds_read_b128 v[108:111], v13 offset:34816
    s_waitcnt lgkmcnt(7)
    v_mfma_f32_16x16x32_bf16 v[16:19], v[56:59], v[76:79], v[16:19]
    v_mfma_f32_16x16x32_bf16 v[20:23], v[56:59], v[80:83], v[20:23]
    v_mfma_f32_16x16x32_bf16 v[24:27], v[60:63], v[76:79], v[24:27]
    v_mfma_f32_16x16x32_bf16 v[28:31], v[60:63], v[80:83], v[28:31]
    v_mfma_f32_16x16x32_bf16 v[32:35], v[64:67], v[76:79], v[32:35]
    v_mfma_f32_16x16x32_bf16 v[36:39], v[64:67], v[80:83], v[36:39]
    v_mfma_f32_16x16x32_bf16 v[40:43], v[68:71], v[76:79], v[40:43]
    v_mfma_f32_16x16x32_bf16 v[44:47], v[68:71], v[80:83], v[44:47]
    v_mfma_f32_16x16x32_bf16 v[48:51], v[72:75], v[76:79], v[48:51]
    v_mfma_f32_16x16x32_bf16 v[52:55], v[72:75], v[80:83], v[52:55]
    s_waitcnt lgkmcnt(0)
    s_waitcnt vmcnt(14)
    s_barrier
    ds_read_b128 v[56:59], v6 offset:0
    ds_read_b128 v[60:63], v6 offset:2048
    ds_read_b128 v[64:67], v6 offset:4096
    ds_read_b128 v[68:71], v6 offset:6144
    ds_read_b128 v[72:75], v6 offset:8192
    ds_read_b128 v[76:79], v10 offset:12288
    ds_read_b128 v[80:83], v10 offset:14336
    s_add_u32 m0, s25, 86016
    s_nop 0
    buffer_load_dwordx4 v2, s[8:11], s32 offen lds
    v_mfma_f32_16x16x32_bf16 v[16:19], v[84:87], v[104:107], v[16:19]
    s_add_u32 m0, s25, 90112
    s_nop 0
    buffer_load_dwordx4 v2, s[8:11], s33 offen lds
    v_mfma_f32_16x16x32_bf16 v[20:23], v[84:87], v[108:111], v[20:23]
    s_add_u32 m0, s25, 94208
    s_nop 0
    buffer_load_dwordx4 v2, s[8:11], s34 offen lds
    v_mfma_f32_16x16x32_bf16 v[24:27], v[88:91], v[104:107], v[24:27]
    s_add_u32 m0, s25, 98304
    s_nop 0
    buffer_load_dwordx4 v3, s[12:15], s48 offen lds
    v_mfma_f32_16x16x32_bf16 v[28:31], v[88:91], v[108:111], v[28:31]
    s_add_u32 m0, s25, 102400
    s_nop 0
    buffer_load_dwordx4 v3, s[12:15], s49 offen lds
    v_mfma_f32_16x16x32_bf16 v[32:35], v[92:95], v[104:107], v[32:35]
    s_add_u32 m0, s25, 106496
    s_nop 0
    buffer_load_dwordx4 v3, s[12:15], s50 offen lds
    v_mfma_f32_16x16x32_bf16 v[36:39], v[92:95], v[108:111], v[36:39]
    s_add_u32 m0, s25, 110592
    s_nop 0
    buffer_load_dwordx4 v3, s[12:15], s51 offen lds
    v_mfma_f32_16x16x32_bf16 v[40:43], v[96:99], v[104:107], v[40:43]
    s_add_u32 s8, s8, 128
    s_addc_u32 s9, s9, 0
    s_add_u32 s12, s12, 128
    s_addc_u32 s13, s13, 0
    v_mfma_f32_16x16x32_bf16 v[44:47], v[96:99], v[108:111], v[44:47]
    v_mfma_f32_16x16x32_bf16 v[48:51], v[100:103], v[104:107], v[48:51]
    v_mfma_f32_16x16x32_bf16 v[52:55], v[100:103], v[108:111], v[52:55]
    ds_read_b128 v[84:87], v7 offset:0
    ds_read_b128 v[88:91], v7 offset:2048
    ds_read_b128 v[92:95], v7 offset:4096
    ds_read_b128 v[96:99], v7 offset:6144
    ds_read_b128 v[100:103], v7 offset:8192
    ds_read_b128 v[104:107], v11 offset:12288
    ds_read_b128 v[108:111], v11 offset:14336
    s_waitcnt lgkmcnt(7)
    v_mfma_f32_16x16x32_bf16 v[16:19], v[56:59], v[76:79], v[16:19]
    v_mfma_f32_16x16x32_bf16 v[20:23], v[56:59], v[80:83], v[20:23]
    v_mfma_f32_16x16x32_bf16 v[24:27], v[60:63], v[76:79], v[24:27]
    v_mfma_f32_16x16x32_bf16 v[28:31], v[60:63], v[80:83], v[28:31]
    v_mfma_f32_16x16x32_bf16 v[32:35], v[64:67], v[76:79], v[32:35]
    v_mfma_f32_16x16x32_bf16 v[36:39], v[64:67], v[80:83], v[36:39]
    v_mfma_f32_16x16x32_bf16 v[40:43], v[68:71], v[76:79], v[40:43]
    v_mfma_f32_16x16x32_bf16 v[44:47], v[68:71], v[80:83], v[44:47]
    v_mfma_f32_16x16x32_bf16 v[48:51], v[72:75], v[76:79], v[48:51]
    v_mfma_f32_16x16x32_bf16 v[52:55], v[72:75], v[80:83], v[52:55]
    s_waitcnt lgkmcnt(0)
    s_waitcnt vmcnt(14)
    s_barrier
    ds_read_b128 v[56:59], v6 offset:28672
    ds_read_b128 v[60:63], v6 offset:30720
    ds_read_b128 v[64:67], v6 offset:32768
    ds_read_b128 v[68:71], v6 offset:34816
    ds_read_b128 v[72:75], v6 offset:36864
    ds_read_b128 v[76:79], v10 offset:40960
    ds_read_b128 v[80:83], v10 offset:43008
    s_add_u32 m0, s25, 0
    s_nop 0
    buffer_load_dwordx4 v2, s[8:11], s32 offen lds
    v_mfma_f32_16x16x32_bf16 v[16:19], v[84:87], v[104:107], v[16:19]
    s_add_u32 m0, s25, 4096
    s_nop 0
    buffer_load_dwordx4 v2, s[8:11], s33 offen lds
    v_mfma_f32_16x16x32_bf16 v[20:23], v[84:87], v[108:111], v[20:23]
    s_add_u32 m0, s25, 8192
    s_nop 0
    buffer_load_dwordx4 v2, s[8:11], s34 offen lds
    v_mfma_f32_16x16x32_bf16 v[24:27], v[88:91], v[104:107], v[24:27]
    s_add_u32 m0, s25, 12288
    s_nop 0
    buffer_load_dwordx4 v3, s[12:15], s48 offen lds
    v_mfma_f32_16x16x32_bf16 v[28:31], v[88:91], v[108:111], v[28:31]
    s_add_u32 m0, s25, 16384
    s_nop 0
    buffer_load_dwordx4 v3, s[12:15], s49 offen lds
    v_mfma_f32_16x16x32_bf16 v[32:35], v[92:95], v[104:107], v[32:35]
    s_add_u32 m0, s25, 20480
    s_nop 0
    buffer_load_dwordx4 v3, s[12:15], s50 offen lds
    v_mfma_f32_16x16x32_bf16 v[36:39], v[92:95], v[108:111], v[36:39]
    s_add_u32 m0, s25, 24576
    s_nop 0
    buffer_load_dwordx4 v3, s[12:15], s51 offen lds
    v_mfma_f32_16x16x32_bf16 v[40:43], v[96:99], v[104:107], v[40:43]
    s_add_u32 s8, s8, 128
    s_addc_u32 s9, s9, 0
    s_add_u32 s12, s12, 128
    s_addc_u32 s13, s13, 0
    v_mfma_f32_16x16x32_bf16 v[44:47], v[96:99], v[108:111], v[44:47]
    v_mfma_f32_16x16x32_bf16 v[48:51], v[100:103], v[104:107], v[48:51]
    v_mfma_f32_16x16x32_bf16 v[52:55], v[100:103], v[108:111], v[52:55]
    ds_read_b128 v[84:87], v7 offset:28672
    ds_read_b128 v[88:91], v7 offset:30720
    ds_read_b128 v[92:95], v7 offset:32768
    ds_read_b128 v[96:99], v7 offset:34816
    ds_read_b128 v[100:103], v7 offset:36864
    ds_read_b128 v[104:107], v11 offset:40960
    ds_read_b128 v[108:111], v11 offset:43008
    s_waitcnt lgkmcnt(7)
    v_mfma_f32_16x16x32_bf16 v[16:19], v[56:59], v[76:79], v[16:19]
    v_mfma_f32_16x16x32_bf16 v[20:23], v[56:59], v[80:83], v[20:23]
    v_mfma_f32_16x16x32_bf16 v[24:27], v[60:63], v[76:79], v[24:27]
    v_mfma_f32_16x16x32_bf16 v[28:31], v[60:63], v[80:83], v[28:31]
    v_mfma_f32_16x16x32_bf16 v[32:35], v[64:67], v[76:79], v[32:35]
    v_mfma_f32_16x16x32_bf16 v[36:39], v[64:67], v[80:83], v[36:39]
    v_mfma_f32_16x16x32_bf16 v[40:43], v[68:71], v[76:79], v[40:43]
    v_mfma_f32_16x16x32_bf16 v[44:47], v[68:71], v[80:83], v[44:47]
    v_mfma_f32_16x16x32_bf16 v[48:51], v[72:75], v[76:79], v[48:51]
    v_mfma_f32_16x16x32_bf16 v[52:55], v[72:75], v[80:83], v[52:55]
    s_waitcnt lgkmcnt(0)
    s_waitcnt vmcnt(14)
    s_barrier
    ds_read_b128 v[56:59], v6 offset:57344
    ds_read_b128 v[60:63], v6 offset:59392
    ds_read_b128 v[64:67], v6 offset:61440
    ds_read_b128 v[68:71], v6 offset:63488
    ds_read_b128 v[72:75], v8 offset:0
    ds_read_b128 v[76:79], v12 offset:4096
    ds_read_b128 v[80:83], v12 offset:6144
    s_add_u32 m0, s25, 28672
    s_nop 0
    buffer_load_dwordx4 v2, s[8:11], s32 offen lds
    v_mfma_f32_16x16x32_bf16 v[16:19], v[84:87], v[104:107], v[16:19]
    s_add_u32 m0, s25, 32768
    s_nop 0
    buffer_load_dwordx4 v2, s[8:11], s33 offen lds
    v_mfma_f32_16x16x32_bf16 v[20:23], v[84:87], v[108:111], v[20:23]
    s_add_u32 m0, s25, 36864
    s_nop 0
    buffer_load_dwordx4 v2, s[8:11], s34 offen lds
    v_mfma_f32_16x16x32_bf16 v[24:27], v[88:91], v[104:107], v[24:27]
    s_add_u32 m0, s25, 40960
    s_nop 0
    buffer_load_dwordx4 v3, s[12:15], s48 offen lds
    v_mfma_f32_16x16x32_bf16 v[28:31], v[88:91], v[108:111], v[28:31]
    s_add_u32 m0, s25, 45056
    s_nop 0
    buffer_load_dwordx4 v3, s[12:15], s49 offen lds
    v_mfma_f32_16x16x32_bf16 v[32:35], v[92:95], v[104:107], v[32:35]
    s_add_u32 m0, s25, 49152
    s_nop 0
    buffer_load_dwordx4 v3, s[12:15], s50 offen lds
    v_mfma_f32_16x16x32_bf16 v[36:39], v[92:95], v[108:111], v[36:39]
    s_add_u32 m0, s25, 53248
    s_nop 0
    buffer_load_dwordx4 v3, s[12:15], s51 offen lds
    v_mfma_f32_16x16x32_bf16 v[40:43], v[96:99], v[104:107], v[40:43]
    s_add_u32 s8, s8, 128
    s_addc_u32 s9, s9, 0
    s_add_u32 s12, s12, 128
    s_addc_u32 s13, s13, 0
    v_mfma_f32_16x16x32_bf16 v[44:47], v[96:99], v[108:111], v[44:47]
    v_mfma_f32_16x16x32_bf16 v[48:51], v[100:103], v[104:107], v[48:51]
    v_mfma_f32_16x16x32_bf16 v[52:55], v[100:103], v[108:111], v[52:55]
    ds_read_b128 v[84:87], v7 offset:57344
    ds_read_b128 v[88:91], v7 offset:59392
    ds_read_b128 v[92:95], v7 offset:61440
    ds_read_b128 v[96:99], v7 offset:63488
    ds_read_b128 v[100:103], v9 offset:0
    ds_read_b128 v[104:107], v13 offset:4096
    ds_read_b128 v[108:111], v13 offset:6144
    s_waitcnt lgkmcnt(7)
    v_mfma_f32_16x16x32_bf16 v[16:19], v[56:59], v[76:79], v[16:19]
    v_mfma_f32_16x16x32_bf16 v[20:23], v[56:59], v[80:83], v[20:23]
    v_mfma_f32_16x16x32_bf16 v[24:27], v[60:63], v[76:79], v[24:27]
    v_mfma_f32_16x16x32_bf16 v[28:31], v[60:63], v[80:83], v[28:31]
    v_mfma_f32_16x16x32_bf16 v[32:35], v[64:67], v[76:79], v[32:35]
    v_mfma_f32_16x16x32_bf16 v[36:39], v[64:67], v[80:83], v[36:39]
    v_mfma_f32_16x16x32_bf16 v[40:43], v[68:71], v[76:79], v[40:43]
    v_mfma_f32_16x16x32_bf16 v[44:47], v[68:71], v[80:83], v[44:47]
    v_mfma_f32_16x16x32_bf16 v[48:51], v[72:75], v[76:79], v[48:51]
    v_mfma_f32_16x16x32_bf16 v[52:55], v[72:75], v[80:83], v[52:55]
    s_waitcnt lgkmcnt(0)
    s_waitcnt vmcnt(14)
    s_barrier
    ds_read_b128 v[56:59], v8 offset:20480
    ds_read_b128 v[60:63], v8 offset:22528
    ds_read_b128 v[64:67], v8 offset:24576
    ds_read_b128 v[68:71], v8 offset:26624
    ds_read_b128 v[72:75], v8 offset:28672
    ds_read_b128 v[76:79], v12 offset:32768
    ds_read_b128 v[80:83], v12 offset:34816
    s_add_u32 m0, s25, 57344
    s_nop 0
    buffer_load_dwordx4 v2, s[8:11], s32 offen lds
    v_mfma_f32_16x16x32_bf16 v[16:19], v[84:87], v[104:107], v[16:19]
    s_add_u32 m0, s25, 61440
    s_nop 0
    buffer_load_dwordx4 v2, s[8:11], s33 offen lds
    v_mfma_f32_16x16x32_bf16 v[20:23], v[84:87], v[108:111], v[20:23]
    s_add_u32 m0, s25, 65536
    s_nop 0
    buffer_load_dwordx4 v2, s[8:11], s34 offen lds
    v_mfma_f32_16x16x32_bf16 v[24:27], v[88:91], v[104:107], v[24:27]
    s_add_u32 m0, s25, 69632
    s_nop 0
    buffer_load_dwordx4 v3, s[12:15], s48 offen lds
    v_mfma_f32_16x16x32_bf16 v[28:31], v[88:91], v[108:111], v[28:31]
    s_add_u32 m0, s25, 73728
    s_nop 0
    buffer_load_dwordx4 v3, s[12:15], s49 offen lds
    v_mfma_f32_16x16x32_bf16 v[32:35], v[92:95], v[104:107], v[32:35]
    s_add_u32 m0, s25, 77824
    s_nop 0
    buffer_load_dwordx4 v3, s[12:15], s50 offen lds
    v_mfma_f32_16x16x32_bf16 v[36:39], v[92:95], v[108:111], v[36:39]
    s_add_u32 m0, s25, 81920
    s_nop 0
    buffer_load_dwordx4 v3, s[12:15], s51 offen lds
    v_mfma_f32_16x16x32_bf16 v[40:43], v[96:99], v[104:107], v[40:43]
    s_add_u32 s8, s8, 128
    s_addc_u32 s9, s9, 0
    s_add_u32 s12, s12, 128
    s_addc_u32 s13, s13, 0
    v_mfma_f32_16x16x32_bf16 v[44:47], v[96:99], v[108:111], v[44:47]
    v_mfma_f32_16x16x32_bf16 v[48:51], v[100:103], v[104:107], v[48:51]
    v_mfma_f32_16x16x32_bf16 v[52:55], v[100:103], v[108:111], v[52:55]
    ds_read_b128 v[84:87], v9 offset:20480
    ds_read_b128 v[88:91], v9 offset:22528
    ds_read_b128 v[92:95], v9 offset:24576
    ds_read_b128 v[96:99], v9 offset:26624
    ds_read_b128 v[100:103], v9 offset:28672
    ds_read_b128 v[104:107], v13 offset:32768
    ds_read_b128 v[108:111], v13 offset:34816
    s_waitcnt lgkmcnt(7)
    v_mfma_f32_16x16x32_bf16 v[16:19], v[56:59], v[76:79], v[16:19]
    v_mfma_f32_16x16x32_bf16 v[20:23], v[56:59], v[80:83], v[20:23]
    v_mfma_f32_16x16x32_bf16 v[24:27], v[60:63], v[76:79], v[24:27]
    v_mfma_f32_16x16x32_bf16 v[28:31], v[60:63], v[80:83], v[28:31]
    v_mfma_f32_16x16x32_bf16 v[32:35], v[64:67], v[76:79], v[32:35]
    v_mfma_f32_16x16x32_bf16 v[36:39], v[64:67], v[80:83], v[36:39]
    v_mfma_f32_16x16x32_bf16 v[40:43], v[68:71], v[76:79], v[40:43]
    v_mfma_f32_16x16x32_bf16 v[44:47], v[68:71], v[80:83], v[44:47]
    v_mfma_f32_16x16x32_bf16 v[48:51], v[72:75], v[76:79], v[48:51]
    v_mfma_f32_16x16x32_bf16 v[52:55], v[72:75], v[80:83], v[52:55]
    s_waitcnt lgkmcnt(0)
    s_waitcnt vmcnt(14)
    s_barrier
    ds_read_b128 v[56:59], v6 offset:0
    ds_read_b128 v[60:63], v6 offset:2048
    ds_read_b128 v[64:67], v6 offset:4096
    ds_read_b128 v[68:71], v6 offset:6144
    ds_read_b128 v[72:75], v6 offset:8192
    ds_read_b128 v[76:79], v10 offset:12288
    ds_read_b128 v[80:83], v10 offset:14336
    s_add_u32 m0, s25, 86016
    s_nop 0
    buffer_load_dwordx4 v2, s[8:11], s32 offen lds
    v_mfma_f32_16x16x32_bf16 v[16:19], v[84:87], v[104:107], v[16:19]
    s_add_u32 m0, s25, 90112
    s_nop 0
    buffer_load_dwordx4 v2, s[8:11], s33 offen lds
    v_mfma_f32_16x16x32_bf16 v[20:23], v[84:87], v[108:111], v[20:23]
    s_add_u32 m0, s25, 94208
    s_nop 0
    buffer_load_dwordx4 v2, s[8:11], s34 offen lds
    v_mfma_f32_16x16x32_bf16 v[24:27], v[88:91], v[104:107], v[24:27]
    s_add_u32 m0, s25, 98304
    s_nop 0
    buffer_load_dwordx4 v3, s[12:15], s48 offen lds
    v_mfma_f32_16x16x32_bf16 v[28:31], v[88:91], v[108:111], v[28:31]
    s_add_u32 m0, s25, 102400
    s_nop 0
    buffer_load_dwordx4 v3, s[12:15], s49 offen lds
    v_mfma_f32_16x16x32_bf16 v[32:35], v[92:95], v[104:107], v[32:35]
    s_add_u32 m0, s25, 106496
    s_nop 0
    buffer_load_dwordx4 v3, s[12:15], s50 offen lds
    v_mfma_f32_16x16x32_bf16 v[36:39], v[92:95], v[108:111], v[36:39]
    s_add_u32 m0, s25, 110592
    s_nop 0
    buffer_load_dwordx4 v3, s[12:15], s51 offen lds
    v_mfma_f32_16x16x32_bf16 v[40:43], v[96:99], v[104:107], v[40:43]
    s_add_u32 s8, s8, 128
    s_addc_u32 s9, s9, 0
    s_add_u32 s12, s12, 128
    s_addc_u32 s13, s13, 0
    v_mfma_f32_16x16x32_bf16 v[44:47], v[96:99], v[108:111], v[44:47]
    v_mfma_f32_16x16x32_bf16 v[48:51], v[100:103], v[104:107], v[48:51]
    v_mfma_f32_16x16x32_bf16 v[52:55], v[100:103], v[108:111], v[52:55]
    ds_read_b128 v[84:87], v7 offset:0
    ds_read_b128 v[88:91], v7 offset:2048
    ds_read_b128 v[92:95], v7 offset:4096
    ds_read_b128 v[96:99], v7 offset:6144
    ds_read_b128 v[100:103], v7 offset:8192
    ds_read_b128 v[104:107], v11 offset:12288
    ds_read_b128 v[108:111], v11 offset:14336
    s_waitcnt lgkmcnt(7)
    v_mfma_f32_16x16x32_bf16 v[16:19], v[56:59], v[76:79], v[16:19]
    v_mfma_f32_16x16x32_bf16 v[20:23], v[56:59], v[80:83], v[20:23]
    v_mfma_f32_16x16x32_bf16 v[24:27], v[60:63], v[76:79], v[24:27]
    v_mfma_f32_16x16x32_bf16 v[28:31], v[60:63], v[80:83], v[28:31]
    v_mfma_f32_16x16x32_bf16 v[32:35], v[64:67], v[76:79], v[32:35]
    v_mfma_f32_16x16x32_bf16 v[36:39], v[64:67], v[80:83], v[36:39]
    v_mfma_f32_16x16x32_bf16 v[40:43], v[68:71], v[76:79], v[40:43]
    v_mfma_f32_16x16x32_bf16 v[44:47], v[68:71], v[80:83], v[44:47]
    v_mfma_f32_16x16x32_bf16 v[48:51], v[72:75], v[76:79], v[48:51]
    v_mfma_f32_16x16x32_bf16 v[52:55], v[72:75], v[80:83], v[52:55]
    s_waitcnt lgkmcnt(0)
    s_waitcnt vmcnt(14)
    s_barrier
    ds_read_b128 v[56:59], v6 offset:28672
    ds_read_b128 v[60:63], v6 offset:30720
    ds_read_b128 v[64:67], v6 offset:32768
    ds_read_b128 v[68:71], v6 offset:34816
    ds_read_b128 v[72:75], v6 offset:36864
    ds_read_b128 v[76:79], v10 offset:40960
    ds_read_b128 v[80:83], v10 offset:43008
    v_mfma_f32_16x16x32_bf16 v[16:19], v[84:87], v[104:107], v[16:19]
    v_mfma_f32_16x16x32_bf16 v[20:23], v[84:87], v[108:111], v[20:23]
    v_mfma_f32_16x16x32_bf16 v[24:27], v[88:91], v[104:107], v[24:27]
    v_mfma_f32_16x16x32_bf16 v[28:31], v[88:91], v[108:111], v[28:31]
    v_mfma_f32_16x16x32_bf16 v[32:35], v[92:95], v[104:107], v[32:35]
    v_mfma_f32_16x16x32_bf16 v[36:39], v[92:95], v[108:111], v[36:39]
    v_mfma_f32_16x16x32_bf16 v[40:43], v[96:99], v[104:107], v[40:43]
    v_mfma_f32_16x16x32_bf16 v[44:47], v[96:99], v[108:111], v[44:47]
    v_mfma_f32_16x16x32_bf16 v[48:51], v[100:103], v[104:107], v[48:51]
    v_mfma_f32_16x16x32_bf16 v[52:55], v[100:103], v[108:111], v[52:55]
    ds_read_b128 v[84:87], v7 offset:28672
    ds_read_b128 v[88:91], v7 offset:30720
    ds_read_b128 v[92:95], v7 offset:32768
    ds_read_b128 v[96:99], v7 offset:34816
    ds_read_b128 v[100:103], v7 offset:36864
    ds_read_b128 v[104:107], v11 offset:40960
    ds_read_b128 v[108:111], v11 offset:43008
    s_waitcnt lgkmcnt(7)
    v_mfma_f32_16x16x32_bf16 v[16:19], v[56:59], v[76:79], v[16:19]
    v_mfma_f32_16x16x32_bf16 v[20:23], v[56:59], v[80:83], v[20:23]
    v_mfma_f32_16x16x32_bf16 v[24:27], v[60:63], v[76:79], v[24:27]
    v_mfma_f32_16x16x32_bf16 v[28:31], v[60:63], v[80:83], v[28:31]
    v_mfma_f32_16x16x32_bf16 v[32:35], v[64:67], v[76:79], v[32:35]
    v_mfma_f32_16x16x32_bf16 v[36:39], v[64:67], v[80:83], v[36:39]
    v_mfma_f32_16x16x32_bf16 v[40:43], v[68:71], v[76:79], v[40:43]
    v_mfma_f32_16x16x32_bf16 v[44:47], v[68:71], v[80:83], v[44:47]
    v_mfma_f32_16x16x32_bf16 v[48:51], v[72:75], v[76:79], v[48:51]
    v_mfma_f32_16x16x32_bf16 v[52:55], v[72:75], v[80:83], v[52:55]
    s_waitcnt lgkmcnt(0)
    s_waitcnt vmcnt(7)
    s_barrier
    ds_read_b128 v[56:59], v6 offset:57344
    ds_read_b128 v[60:63], v6 offset:59392
    ds_read_b128 v[64:67], v6 offset:61440
    ds_read_b128 v[68:71], v6 offset:63488
    ds_read_b128 v[72:75], v8 offset:0
    ds_read_b128 v[76:79], v12 offset:4096
    ds_read_b128 v[80:83], v12 offset:6144
    v_mfma_f32_16x16x32_bf16 v[16:19], v[84:87], v[104:107], v[16:19]
    v_mfma_f32_16x16x32_bf16 v[20:23], v[84:87], v[108:111], v[20:23]
    v_mfma_f32_16x16x32_bf16 v[24:27], v[88:91], v[104:107], v[24:27]
    v_mfma_f32_16x16x32_bf16 v[28:31], v[88:91], v[108:111], v[28:31]
    v_mfma_f32_16x16x32_bf16 v[32:35], v[92:95], v[104:107], v[32:35]
    v_mfma_f32_16x16x32_bf16 v[36:39], v[92:95], v[108:111], v[36:39]
    v_mfma_f32_16x16x32_bf16 v[40:43], v[96:99], v[104:107], v[40:43]
    v_mfma_f32_16x16x32_bf16 v[44:47], v[96:99], v[108:111], v[44:47]
    v_mfma_f32_16x16x32_bf16 v[48:51], v[100:103], v[104:107], v[48:51]
    v_mfma_f32_16x16x32_bf16 v[52:55], v[100:103], v[108:111], v[52:55]
    ds_read_b128 v[84:87], v7 offset:57344
    ds_read_b128 v[88:91], v7 offset:59392
    ds_read_b128 v[92:95], v7 offset:61440
    ds_read_b128 v[96:99], v7 offset:63488
    ds_read_b128 v[100:103], v9 offset:0
    ds_read_b128 v[104:107], v13 offset:4096
    ds_read_b128 v[108:111], v13 offset:6144
    s_waitcnt lgkmcnt(7)
    v_mfma_f32_16x16x32_bf16 v[16:19], v[56:59], v[76:79], v[16:19]
    v_mfma_f32_16x16x32_bf16 v[20:23], v[56:59], v[80:83], v[20:23]
    v_mfma_f32_16x16x32_bf16 v[24:27], v[60:63], v[76:79], v[24:27]
    v_mfma_f32_16x16x32_bf16 v[28:31], v[60:63], v[80:83], v[28:31]
    v_mfma_f32_16x16x32_bf16 v[32:35], v[64:67], v[76:79], v[32:35]
    v_mfma_f32_16x16x32_bf16 v[36:39], v[64:67], v[80:83], v[36:39]
    v_mfma_f32_16x16x32_bf16 v[40:43], v[68:71], v[76:79], v[40:43]
    v_mfma_f32_16x16x32_bf16 v[44:47], v[68:71], v[80:83], v[44:47]
    v_mfma_f32_16x16x32_bf16 v[48:51], v[72:75], v[76:79], v[48:51]
    v_mfma_f32_16x16x32_bf16 v[52:55], v[72:75], v[80:83], v[52:55]
    s_waitcnt lgkmcnt(0)
    s_waitcnt vmcnt(0)
    s_barrier
    ds_read_b128 v[56:59], v8 offset:20480
    ds_read_b128 v[60:63], v8 offset:22528
    ds_read_b128 v[64:67], v8 offset:24576
    ds_read_b128 v[68:71], v8 offset:26624
    ds_read_b128 v[72:75], v8 offset:28672
    ds_read_b128 v[76:79], v12 offset:32768
    ds_read_b128 v[80:83], v12 offset:34816
    v_mfma_f32_16x16x32_bf16 v[16:19], v[84:87], v[104:107], v[16:19]
    v_mfma_f32_16x16x32_bf16 v[20:23], v[84:87], v[108:111], v[20:23]
    v_mfma_f32_16x16x32_bf16 v[24:27], v[88:91], v[104:107], v[24:27]
    v_mfma_f32_16x16x32_bf16 v[28:31], v[88:91], v[108:111], v[28:31]
    v_mfma_f32_16x16x32_bf16 v[32:35], v[92:95], v[104:107], v[32:35]
    v_mfma_f32_16x16x32_bf16 v[36:39], v[92:95], v[108:111], v[36:39]
    v_mfma_f32_16x16x32_bf16 v[40:43], v[96:99], v[104:107], v[40:43]
    v_mfma_f32_16x16x32_bf16 v[44:47], v[96:99], v[108:111], v[44:47]
    v_mfma_f32_16x16x32_bf16 v[48:51], v[100:103], v[104:107], v[48:51]
    v_mfma_f32_16x16x32_bf16 v[52:55], v[100:103], v[108:111], v[52:55]
    ds_read_b128 v[84:87], v9 offset:20480
    ds_read_b128 v[88:91], v9 offset:22528
    ds_read_b128 v[92:95], v9 offset:24576
    ds_read_b128 v[96:99], v9 offset:26624
    ds_read_b128 v[100:103], v9 offset:28672
    ds_read_b128 v[104:107], v13 offset:32768
    ds_read_b128 v[108:111], v13 offset:34816
    s_waitcnt lgkmcnt(7)
    v_mfma_f32_16x16x32_bf16 v[16:19], v[56:59], v[76:79], v[16:19]
    v_mfma_f32_16x16x32_bf16 v[20:23], v[56:59], v[80:83], v[20:23]
    v_mfma_f32_16x16x32_bf16 v[24:27], v[60:63], v[76:79], v[24:27]
    v_mfma_f32_16x16x32_bf16 v[28:31], v[60:63], v[80:83], v[28:31]
    v_mfma_f32_16x16x32_bf16 v[32:35], v[64:67], v[76:79], v[32:35]
    v_mfma_f32_16x16x32_bf16 v[36:39], v[64:67], v[80:83], v[36:39]
    v_mfma_f32_16x16x32_bf16 v[40:43], v[68:71], v[76:79], v[40:43]
    v_mfma_f32_16x16x32_bf16 v[44:47], v[68:71], v[80:83], v[44:47]
    v_mfma_f32_16x16x32_bf16 v[48:51], v[72:75], v[76:79], v[48:51]
    v_mfma_f32_16x16x32_bf16 v[52:55], v[72:75], v[80:83], v[52:55]
    s_waitcnt lgkmcnt(0)
    v_mfma_f32_16x16x32_bf16 v[16:19], v[84:87], v[104:107], v[16:19]
    v_mfma_f32_16x16x32_bf16 v[20:23], v[84:87], v[108:111], v[20:23]
    v_mfma_f32_16x16x32_bf16 v[24:27], v[88:91], v[104:107], v[24:27]
    v_mfma_f32_16x16x32_bf16 v[28:31], v[88:91], v[108:111], v[28:31]
    v_mfma_f32_16x16x32_bf16 v[32:35], v[92:95], v[104:107], v[32:35]
    v_mfma_f32_16x16x32_bf16 v[36:39], v[92:95], v[108:111], v[36:39]
    v_mfma_f32_16x16x32_bf16 v[40:43], v[96:99], v[104:107], v[40:43]
    v_mfma_f32_16x16x32_bf16 v[44:47], v[96:99], v[108:111], v[44:47]
    v_mfma_f32_16x16x32_bf16 v[48:51], v[100:103], v[104:107], v[48:51]
    v_mfma_f32_16x16x32_bf16 v[52:55], v[100:103], v[108:111], v[52:55]
    s_nop 7
    s_nop 7
    s_mul_i32 s28, s27, 128
    s_lshr_b32 s29, s24, 0
    s_mul_i32 s29, s29, 32
    s_add_u32 s28, s28, s29
    s_mul_i32 s29, s26, 72
    s_and_b32 s30, s24, 0
    s_mul_i32 s30, s30, 72
    s_add_u32 s29, s29, s30
    s_lshl_b32 s29, s29, 1
    v_and_b32 v4, 15, v1
    v_add_u32 v4, s28, v4
    s_mov_b32 s30, 1152
    v_mul_lo_u32 v4, v4, s30
    v_lshrrev_b32 v5, 4, v1
    v_lshlrev_b32 v5, 3, v5
    v_add_u32 v4, v4, v5
    v_add_u32 v4, s29, v4
    s_mov_b32 s31, 0
    v_cvt_pk_bf16_f32 v56, v16, v17
    v_cvt_pk_bf16_f32 v57, v18, v19
    buffer_store_dwordx2 v[56:57], v4, s[16:19], s31 offen
    s_mov_b32 s31, 32
    v_cvt_pk_bf16_f32 v56, v24, v25
    v_cvt_pk_bf16_f32 v57, v26, v27
    buffer_store_dwordx2 v[56:57], v4, s[16:19], s31 offen
    s_mov_b32 s31, 64
    v_cvt_pk_bf16_f32 v56, v32, v33
    v_cvt_pk_bf16_f32 v57, v34, v35
    buffer_store_dwordx2 v[56:57], v4, s[16:19], s31 offen
    s_mov_b32 s31, 96
    v_cvt_pk_bf16_f32 v56, v40, v41
    v_cvt_pk_bf16_f32 v57, v42, v43
    buffer_store_dwordx2 v[56:57], v4, s[16:19], s31 offen
    s_mov_b64 exec, 0xffffffff
    s_mov_b32 s31, 128
    v_cvt_pk_bf16_f32 v56, v48, v49
    v_cvt_pk_bf16_f32 v57, v50, v51
    buffer_store_dwordx2 v[56:57], v4, s[16:19], s31 offen
    s_mov_b64 exec, -1
    s_mov_b32 s31, 18432
    v_cvt_pk_bf16_f32 v56, v20, v21
    v_cvt_pk_bf16_f32 v57, v22, v23
    buffer_store_dwordx2 v[56:57], v4, s[16:19], s31 offen
    s_mov_b32 s31, 18464
    v_cvt_pk_bf16_f32 v56, v28, v29
    v_cvt_pk_bf16_f32 v57, v30, v31
    buffer_store_dwordx2 v[56:57], v4, s[16:19], s31 offen
    s_mov_b32 s31, 18496
    v_cvt_pk_bf16_f32 v56, v36, v37
    v_cvt_pk_bf16_f32 v57, v38, v39
    buffer_store_dwordx2 v[56:57], v4, s[16:19], s31 offen
    s_mov_b32 s31, 18528
    v_cvt_pk_bf16_f32 v56, v44, v45
    v_cvt_pk_bf16_f32 v57, v46, v47
    buffer_store_dwordx2 v[56:57], v4, s[16:19], s31 offen
    s_mov_b64 exec, 0xffffffff
    s_mov_b32 s31, 18560
    v_cvt_pk_bf16_f32 v56, v52, v53
    v_cvt_pk_bf16_f32 v57, v54, v55
    buffer_store_dwordx2 v[56:57], v4, s[16:19], s31 offen
    s_mov_b64 exec, -1
g4_kernel_end:
    s_endpgm
.section .rodata,"a"
.p2align 6
.amdhsa_kernel g4_kernel
  .amdhsa_next_free_vgpr 120
  .amdhsa_next_free_sgpr 102
  .amdhsa_accum_offset 120
  .amdhsa_group_segment_fixed_size 0
  .amdhsa_kernarg_size 96
  .amdhsa_user_sgpr_count 2
  .amdhsa_user_sgpr_kernarg_segment_ptr 1
  .amdhsa_system_sgpr_workgroup_id_x 1
.end_amdhsa_kernel
.text
.globl ln3_kernel
.p2align 8
.type ln3_kernel,@function
ln3_kernel:
    s_load_dwordx2 s[4:5], s[0:1], 0
    s_load_dwordx2 s[6:7], s[0:1], 88
    s_load_dwordx2 s[8:9], s[0:1], 72
    v_lshrrev_b32 v1, 6, v0
    v_and_b32 v2, 63, v0
    s_nop 0
    v_readfirstlane_b32 s3, v1
    s_lshl_b32 s10, s2, 2
    s_add_u32 s10, s10, s3
    s_cmp_ge_u32 s10, 2048
    s_cbranch_scc1 ln3_kernel_end
    s_waitcnt lgkmcnt(0)
    s_add_u32 s12, s6, 0xb40000
    s_addc_u32 s13, s7, 0
    s_mov_b32 s14, 0x240000
    s_mov_b32 s15, 0x00020000
    s_mov_b32 s16, s6
    s_mov_b32 s17, s7
    s_mov_b32 s18, 0x240000
    s_mov_b32 s19, 0x00020000
    s_add_u32 s20, s6, 0x1680000
    s_addc_u32 s21, s7, 0
    s_mov_b32 s22, 0x240000
    s_mov_b32 s23, 0x00020000
    s_add_u32 s24, s6, 0x18c0000
    s_addc_u32 s25, s7, 0
    s_mov_b32 s26, 0x240000
    s_mov_b32 s27, 0x00020000
    s_add_u32 s28, s6, 0xd80000
    s_addc_u32 s29, s7, 0
    s_mov_b32 s30, 0x240000
    s_mov_b32 s31, 0x00020000
    s_mul_i32 s11, s10, 1152
    v_lshlrev_b32 v3, 4, v2
    v_cmp_gt_u32 s[32:33], 8, v2
    v_mov_b32 v12, 0
    v_mov_b32 v13, 0
    v_mov_b32 v14, 0
    v_mov_b32 v15, 0
    v_mov_b32 v16, 0
    v_mov_b32 v17, 0
    v_mov_b32 v18, 0
    v_mov_b32 v19, 0
    buffer_load_dwordx4 v[4:7], v3, s[12:15], s11 offen
    s_mov_b64 exec, s[32:33]
    buffer_load_dwordx4 v[12:15], v3, s[12:15], s11 offen offset:1024
    s_mov_b64 exec, -1
    v_mov_b32 v36, 0
    v_mov_b32 v37, 0
    v_mov_b32 v38, 0
    v_mov_b32 v39, 0
    v_mov_b32 v40, 0
    v_mov_b32 v41, 0
    v_mov_b32 v42, 0
    v_mov_b32 v43, 0
    buffer_load_dwordx4 v[8:11], v3, s[20:23], s11 offen
    s_mov_b64 exec, s[32:33]
    buffer_load_dwordx4 v[16:19], v3, s[20:23], s11 offen offset:1024
    s_mov_b64 exec, -1
    buffer_load_dwordx4 v[36:39], v3, s[24:27], s11 offen
    s_mov_b64 exec, s[32:33]
    buffer_load_dwordx4 v[40:43], v3, s[24:27], s11 offen offset:1024
    s_mov_b64 exec, -1
    s_waitcnt vmcnt(0)
    v_lshlrev_b32 v44, 16, v8
    v_and_b32 v45, 0xffff0000, v8
    v_lshlrev_b32 v46, 16, v36
    v_and_b32 v47, 0xffff0000, v36
    v_sub_f32 v44, v44, v46
    v_sub_f32 v45, v45, v47
    v_cvt_pk_bf16_f32 v44, v44, v45
    v_lshlrev_b32 v45, 16, v44
    v_and_b32 v46, 0xffff0000, v44
    v_lshlrev_b32 v47, 16, v4
    v_and_b32 v48, 0xffff0000, v4
    v_add_f32 v45, v45, v47
    v_add_f32 v46, v46, v48
    v_cvt_pk_bf16_f32 v4, v45, v46
    v_lshlrev_b32 v44, 16, v9
    v_and_b32 v45, 0xffff0000, v9
    v_lshlrev_b32 v46, 16, v37
    v_and_b32 v47, 0xffff0000, v37
    v_sub_f32 v44, v44, v46
    v_sub_f32 v45, v45, v47
    v_cvt_pk_bf16_f32 v44, v44, v45
    v_lshlrev_b32 v45, 16, v44
    v_and_b32 v46, 0xffff0000, v44
    v_lshlrev_b32 v47, 16, v5
    v_and_b32 v48, 0xffff0000, v5
    v_add_f32 v45, v45, v47
    v_add_f32 v46, v46, v48
    v_cvt_pk_bf16_f32 v5, v45, v46
    v_lshlrev_b32 v44, 16, v10
    v_and_b32 v45, 0xffff0000, v10
    v_lshlrev_b32 v46, 16, v38
    v_and_b32 v47, 0xffff0000, v38
    v_sub_f32 v44, v44, v46
    v_sub_f32 v45, v45, v47
    v_cvt_pk_bf16_f32 v44, v44, v45
    v_lshlrev_b32 v45, 16, v44
    v_and_b32 v46, 0xffff0000, v44
    v_lshlrev_b32 v47, 16, v6
    v_and_b32 v48, 0xffff0000, v6
    v_add_f32 v45, v45, v47
    v_add_f32 v46, v46, v48
    v_cvt_pk_bf16_f32 v6, v45, v46
    v_lshlrev_b32 v44, 16, v11
    v_and_b32 v45, 0xffff0000, v11
    v_lshlrev_b32 v46, 16, v39
    v_and_b32 v47, 0xffff0000, v39
    v_sub_f32 v44, v44, v46
    v_sub_f32 v45, v45, v47
    v_cvt_pk_bf16_f32 v44, v44, v45
    v_lshlrev_b32 v45, 16, v44
    v_and_b32 v46, 0xffff0000, v44
    v_lshlrev_b32 v47, 16, v7
    v_and_b32 v48, 0xffff0000, v7
    v_add_f32 v45, v45, v47
    v_add_f32 v46, v46, v48
    v_cvt_pk_bf16_f32 v7, v45, v46
    v_lshlrev_b32 v44, 16, v16
    v_and_b32 v45, 0xffff0000, v16
    v_lshlrev_b32 v46, 16, v40
    v_and_b32 v47, 0xffff0000, v40
    v_sub_f32 v44, v44, v46
    v_sub_f32 v45, v45, v47
    v_cvt_pk_bf16_f32 v44, v44, v45
    v_lshlrev_b32 v45, 16, v44
    v_and_b32 v46, 0xffff0000, v44
    v_lshlrev_b32 v47, 16, v12
    v_and_b32 v48, 0xffff0000, v12
    v_add_f32 v45, v45, v47
    v_add_f32 v46, v46, v48
    v_cvt_pk_bf16_f32 v12, v45, v46
    v_lshlrev_b32 v44, 16, v17
    v_and_b32 v45, 0xffff0000, v17
    v_lshlrev_b32 v46, 16, v41
    v_and_b32 v47, 0xffff0000, v41
    v_sub_f32 v44, v44, v46
    v_sub_f32 v45, v45, v47
    v_cvt_pk_bf16_f32 v44, v44, v45
    v_lshlrev_b32 v45, 16, v44
    v_and_b32 v46, 0xffff0000, v44
    v_lshlrev_b32 v47, 16, v13
    v_and_b32 v48, 0xffff0000, v13
    v_add_f32 v45, v45, v47
    v_add_f32 v46, v46, v48
    v_cvt_pk_bf16_f32 v13, v45, v46
    v_lshlrev_b32 v44, 16, v18
    v_and_b32 v45, 0xffff0000, v18
    v_lshlrev_b32 v46, 16, v42
    v_and_b32 v47, 0xffff0000, v42
    v_sub_f32 v44, v44, v46
    v_sub_f32 v45, v45, v47
    v_cvt_pk_bf16_f32 v44, v44, v45
    v_lshlrev_b32 v45, 16, v44
    v_and_b32 v46, 0xffff0000, v44
    v_lshlrev_b32 v47, 16, v14
    v_and_b32 v48, 0xffff0000, v14
    v_add_f32 v45, v45, v47
    v_add_f32 v46, v46, v48
    v_cvt_pk_bf16_f32 v14, v45, v46
    v_lshlrev_b32 v44, 16, v19
    v_and_b32 v45, 0xffff0000, v19
    v_lshlrev_b32 v46, 16, v43
    v_and_b32 v47, 0xffff0000, v43
    v_sub_f32 v44, v44, v46
    v_sub_f32 v45, v45, v47
    v_cvt_pk_bf16_f32 v44, v44, v45
    v_lshlrev_b32 v45, 16, v44
    v_and_b32 v46, 0xffff0000, v44
    v_lshlrev_b32 v47, 16, v15
    v_and_b32 v48, 0xffff0000, v15
    v_add_f32 v45, v45, v47
    v_add_f32 v46, v46, v48
    v_cvt_pk_bf16_f32 v15, v45, v46
    buffer_store_dwordx4 v[4:7], v3, s[28:31], s11 offen
    s_mov_b64 exec, s[32:33]
    buffer_store_dwordx4 v[12:15], v3, s[28:31], s11 offen offset:1024
    s_mov_b64 exec, -1
    v_lshlrev_b32 v20, 16, v4
    v_and_b32 v21, 0xffff0000, v4
    v_lshlrev_b32 v22, 16, v5
    v_and_b32 v23, 0xffff0000, v5
    v_lshlrev_b32 v24, 16, v6
    v_and_b32 v25, 0xffff0000, v6
    v_lshlrev_b32 v26, 16, v7
    v_and_b32 v27, 0xffff0000, v7
    v_lshlrev_b32 v28, 16, v12
    v_and_b32 v29, 0xffff0000, v12
    v_lshlrev_b32 v30, 16, v13
    v_and_b32 v31, 0xffff0000, v13
    v_lshlrev_b32 v32, 16, v14
    v_and_b32 v33, 0xffff0000, v14
    v_lshlrev_b32 v34, 16, v15
    v_and_b32 v35, 0xffff0000, v15
    v_add_f32 v36, v20, v21
    v_add_f32 v36, v36, v22
    v_add_f32 v36, v36, v23
    v_add_f32 v36, v36, v24
    v_add_f32 v36, v36, v25
    v_add_f32 v36, v36, v26
    v_add_f32 v36, v36, v27
    v_add_f32 v36, v36, v28
    v_add_f32 v36, v36, v29
    v_add_f32 v36, v36, v30
    v_add_f32 v36, v36, v31
    v_add_f32 v36, v36, v32
    v_add_f32 v36, v36, v33
    v_add_f32 v36, v36, v34
    v_add_f32 v36, v36, v35
    s_nop 1
    v_add_f32_dpp v36, v36, v36 row_shr:1 row_mask:0xf bank_mask:0xf
    s_nop 1
    v_add_f32_dpp v36, v36, v36 row_shr:2 row_mask:0xf bank_mask:0xf
    s_nop 1
    v_add_f32_dpp v36, v36, v36 row_shr:4 row_mask:0xf bank_mask:0xf
    s_nop 1
    v_add_f32_dpp v36, v36, v36 row_shr:8 row_mask:0xf bank_mask:0xf
    s_nop 1
    v_add_f32_dpp v36, v36, v36 row_bcast:15 row_mask:0xa bank_mask:0xf
    s_nop 1
    v_add_f32_dpp v36, v36, v36 row_bcast:31 row_mask:0xc bank_mask:0xf
    s_nop 0
    v_readlane_b32 s34, v36, 63
    s_nop 1
    v_mov_b32 v37, s34
    v_mul_f32 v37, 0x3ae38e39, v37
    v_sub_f32 v38, v20, v37
    v_mul_f32 v36, v38, v38
    v_sub_f32 v38, v21, v37
    v_fmac_f32 v36, v38, v38
    v_sub_f32 v38, v22, v37
    v_fmac_f32 v36, v38, v38
    v_sub_f32 v38, v23, v37
    v_fmac_f32 v36, v38, v38
    v_sub_f32 v38, v24, v37
    v_fmac_f32 v36, v38, v38
    v_sub_f32 v38, v25, v37
    v_fmac_f32 v36, v38, v38
    v_sub_f32 v38, v26, v37
    v_fmac_f32 v36, v38, v38
    v_sub_f32 v38, v27, v37
    v_fmac_f32 v36, v38, v38
    s_mov_b64 exec, s[32:33]
    v_sub_f32 v38, v28, v37
    v_fmac_f32 v36, v38, v38
    v_sub_f32 v38, v29, v37
    v_fmac_f32 v36, v38, v38
    v_sub_f32 v38, v30, v37
    v_fmac_f32 v36, v38, v38
    v_sub_f32 v38, v31, v37
    v_fmac_f32 v36, v38, v38
    v_sub_f32 v38, v32, v37
    v_fmac_f32 v36, v38, v38
    v_sub_f32 v38, v33, v37
    v_fmac_f32 v36, v38, v38
    v_sub_f32 v38, v34, v37
    v_fmac_f32 v36, v38, v38
    v_sub_f32 v38, v35, v37
    v_fmac_f32 v36, v38, v38
    s_mov_b64 exec, -1
    s_nop 1
    v_add_f32_dpp v36, v36, v36 row_shr:1 row_mask:0xf bank_mask:0xf
    s_nop 1
    v_add_f32_dpp v36, v36, v36 row_shr:2 row_mask:0xf bank_mask:0xf
    s_nop 1
    v_add_f32_dpp v36, v36, v36 row_shr:4 row_mask:0xf bank_mask:0xf
    s_nop 1
    v_add_f32_dpp v36, v36, v36 row_shr:8 row_mask:0xf bank_mask:0xf
    s_nop 1
    v_add_f32_dpp v36, v36, v36 row_bcast:15 row_mask:0xa bank_mask:0xf
    s_nop 1
    v_add_f32_dpp v36, v36, v36 row_bcast:31 row_mask:0xc bank_mask:0xf
    s_nop 0
    v_readlane_b32 s34, v36, 63
    s_nop 1
    v_mov_b32 v38, s34
    v_mul_f32 v38, 0x3ae38e39, v38
    v_cvt_pk_bf16_f32 v39, v37, v38
    v_lshlrev_b32 v37, 16, v39
    v_and_b32 v38, 0xffff0000, v39
    v_add_f32 v38, 0x3727c5ac, v38
    v_cvt_pk_bf16_f32 v39, v38, v38
    v_lshlrev_b32 v38, 16, v39
    v_sqrt_f32 v38, v38
    s_nop 0
    v_cvt_pk_bf16_f32 v39, v38, v38
    v_lshlrev_b32 v38, 16, v39
    v_rcp_f32 v39, v38
    s_nop 0
    v_sub_f32 v40, v20, v37
    v_sub_f32 v41, v21, v37
    v_cvt_pk_bf16_f32 v42, v40, v41
    v_lshlrev_b32 v40, 16, v42
    v_and_b32 v41, 0xffff0000, v42
    v_mul_f32 v42, v40, v39
    v_mul_f32 v43, v41, v39
    v_fma_f32 v44, -v42, v38, v40
    v_fma_f32 v45, -v43, v38, v41
    v_fma_f32 v42, v44, v39, v42
    v_fma_f32 v43, v45, v39, v43
    v_cvt_pk_bf16_f32 v4, v42, v43
    v_sub_f32 v40, v22, v37
    v_sub_f32 v41, v23, v37
    v_cvt_pk_bf16_f32 v42, v40, v41
    v_lshlrev_b32 v40, 16, v42
    v_and_b32 v41, 0xffff0000, v42
    v_mul_f32 v42, v40, v39
    v_mul_f32 v43, v41, v39
    v_fma_f32 v44, -v42, v38, v40
    v_fma_f32 v45, -v43, v38, v41
    v_fma_f32 v42, v44, v39, v42
    v_fma_f32 v43, v45, v39, v43
    v_cvt_pk_bf16_f32 v5, v42, v43
    v_sub_f32 v40, v24, v37
    v_sub_f32 v41, v25, v37
    v_cvt_pk_bf16_f32 v42, v40, v41
    v_lshlrev_b32 v40, 16, v42
    v_and_b32 v41, 0xffff0000, v42
    v_mul_f32 v42, v40, v39
    v_mul_f32 v43, v41, v39
    v_fma_f32 v44, -v42, v38, v40
    v_fma_f32 v45, -v43, v38, v41
    v_fma_f32 v42, v44, v39, v42
    v_fma_f32 v43, v45, v39, v43
    v_cvt_pk_bf16_f32 v6, v42, v43
    v_sub_f32 v40, v26, v37
    v_sub_f32 v41, v27, v37
    v_cvt_pk_bf16_f32 v42, v40, v41
    v_lshlrev_b32 v40, 16, v42
    v_and_b32 v41, 0xffff0000, v42
    v_mul_f32 v42, v40, v39
    v_mul_f32 v43, v41, v39
    v_fma_f32 v44, -v42, v38, v40
    v_fma_f32 v45, -v43, v38, v41
    v_fma_f32 v42, v44, v39, v42
    v_fma_f32 v43, v45, v39, v43
    v_cvt_pk_bf16_f32 v7, v42, v43
    v_sub_f32 v40, v28, v37
    v_sub_f32 v41, v29, v37
    v_cvt_pk_bf16_f32 v42, v40, v41
    v_lshlrev_b32 v40, 16, v42
    v_and_b32 v41, 0xffff0000, v42
    v_mul_f32 v42, v40, v39
    v_mul_f32 v43, v41, v39
    v_fma_f32 v44, -v42, v38, v40
    v_fma_f32 v45, -v43, v38, v41
    v_fma_f32 v42, v44, v39, v42
    v_fma_f32 v43, v45, v39, v43
    v_cvt_pk_bf16_f32 v12, v42, v43
    v_sub_f32 v40, v30, v37
    v_sub_f32 v41, v31, v37
    v_cvt_pk_bf16_f32 v42, v40, v41
    v_lshlrev_b32 v40, 16, v42
    v_and_b32 v41, 0xffff0000, v42
    v_mul_f32 v42, v40, v39
    v_mul_f32 v43, v41, v39
    v_fma_f32 v44, -v42, v38, v40
    v_fma_f32 v45, -v43, v38, v41
    v_fma_f32 v42, v44, v39, v42
    v_fma_f32 v43, v45, v39, v43
    v_cvt_pk_bf16_f32 v13, v42, v43
    v_sub_f32 v40, v32, v37
    v_sub_f32 v41, v33, v37
    v_cvt_pk_bf16_f32 v42, v40, v41
    v_lshlrev_b32 v40, 16, v42
    v_and_b32 v41, 0xffff0000, v42
    v_mul_f32 v42, v40, v39
    v_mul_f32 v43, v41, v39
    v_fma_f32 v44, -v42, v38, v40
    v_fma_f32 v45, -v43, v38, v41
    v_fma_f32 v42, v44, v39, v42
    v_fma_f32 v43, v45, v39, v43
    v_cvt_pk_bf16_f32 v14, v42, v43
    v_sub_f32 v40, v34, v37
    v_sub_f32 v41, v35, v37
    v_cvt_pk_bf16_f32 v42, v40, v41
    v_lshlrev_b32 v40, 16, v42
    v_and_b32 v41, 0xffff0000, v42
    v_mul_f32 v42, v40, v39
    v_mul_f32 v43, v41, v39
    v_fma_f32 v44, -v42, v38, v40
    v_fma_f32 v45, -v43, v38, v41
    v_fma_f32 v42, v44, v39, v42
    v_fma_f32 v43, v45, v39, v43
    v_cvt_pk_bf16_f32 v15, v42, v43
    buffer_store_dwordx4 v[4:7], v3, s[16:19], s11 offen
    s_mov_b64 exec, s[32:33]
    buffer_store_dwordx4 v[12:15], v3, s[16:19], s11 offen offset:1024
    s_mov_b64 exec, -1
ln3_kernel_end:
    s_endpgm
.section .rodata,"a"
.p2align 6
.amdhsa_kernel ln3_kernel
  .amdhsa_next_free_vgpr 64
  .amdhsa_next_free_sgpr 102
  .amdhsa_accum_offset 64
  .amdhsa_group_segment_fixed_size 0
  .amdhsa_kernarg_size 96
  .amdhsa_user_sgpr_count 2
  .amdhsa_user_sgpr_kernarg_segment_ptr 1
  .amdhsa_system_sgpr_workgroup_id_x 1
.end_amdhsa_kernel
.text
.globl g2b_kernel
.p2align 8
.type g2b_kernel,@function
g2b_kernel:
    s_cmp_ge_u32 s2, 192
    s_cbranch_scc1 g2b_kernel_end
    s_load_dwordx2 s[4:5], s[0:1], 88
    s_load_dwordx2 s[6:7], s[0:1], 88
    s_load_dwordx2 s[64:65], s[0:1], 88
    s_load_dwordx2 s[66:67], s[0:1], 88
    v_and_b32 v1, 63, v0
    v_lshrrev_b32 v4, 6, v0
    s_nop 0
    v_readfirstlane_b32 s24, v4
    s_lshl_b32 s25, s24, 10
    s_waitcnt lgkmcnt(0)
    s_and_b32 s28, s2, 7
    s_lshr_b32 s29, s2, 3
    s_mul_hi_u32 s30, s29, 0x2aaaaaab
    s_mul_i32 s26, s30, 6
    s_sub_u32 s26, s29, s26
    s_lshl_b32 s27, s28, 2
    s_add_u32 s27, s27, s30
    s_add_u32 s8, s4, 0x1cf0000
    s_addc_u32 s9, s5, 0
    s_mov_b32 s10, 0xa2000
    s_mov_b32 s11, 0x00020000
    s_add_u32 s12, s6, 0x900000
    s_addc_u32 s13, s7, 0
    s_mov_b32 s14, 0x240000
    s_mov_b32 s15, 0x00020000
    s_add_u32 s16, s64, 0xfc0000
    s_addc_u32 s17, s65, 0
    s_mov_b32 s18, 0x240000
    s_mov_b32 s19, 0x00020000
    s_add_u32 s20, s66, 0xd80000
    s_addc_u32 s21, s67, 0
    s_mov_b32 s22, 0x240000
    s_mov_b32 s23, 0x00020000
    v_lshrrev_b32 v4, 3, v1
    v_and_b32 v5, 7, v1
    v_xor_b32 v5, v5, v4
    v_lshlrev_b32 v5, 4, v5
    s_mov_b32 s28, 1152
    v_mul_lo_u32 v2, v4, s28
    v_add_u32 v2, v2, v5
    s_mov_b32 s28, 1152
    v_mul_lo_u32 v3, v4, s28
    v_add_u32 v3, v3, v5
    s_add_u32 s28, s24, 0
    s_lshl_b32 s29, s28, 3
    s_mul_i32 s30, s26, 96
    s_add_u32 s29, s29, s30
    s_mul_i32 s29, s29, 1152
    s_mov_b32 s32, s29
    s_add_u32 s28, s24, 4
    s_lshl_b32 s29, s28, 3
    s_mul_i32 s30, s26, 96
    s_add_u32 s29, s29, s30
    s_mul_i32 s29, s29, 1152
    s_mov_b32 s33, s29
    s_add_u32 s28, s24, 8
    s_lshl_b32 s29, s28, 3
    s_mul_i32 s30, s26, 96
    s_add_u32 s29, s29, s30
    s_mul_i32 s29, s29, 1152
    s_mov_b32 s34, s29
    s_add_u32 s28, s24, 0
    s_lshl_b32 s29, s28, 3
    s_mul_i32 s30, s27, 64
    s_add_u32 s29, s29, s30
    s_mul_i32 s29, s29, 1152
    s_mov_b32 s48, s29
    s_add_u32 s28, s24, 4
    s_lshl_b32 s29, s28, 3
    s_mul_i32 s30, s27, 64
    s_add_u32 s29, s29, s30
    s_mul_i32 s29, s29, 1152
    s_mov_b32 s49, s29
    s_and_b32 s28, s24, 1
    s_lshr_b32 s29, s24, 1
    s_mul_i32 s28, s28, 6144
    s_mul_i32 s29, s29, 4096
    v_and_b32 v4, 15, v1
    v_lshlrev_b32 v4, 7, v4
    v_lshrrev_b32 v5, 4, v1
    v_and_b32 v6, 7, v1
    v_xor_b32 v5, v5, v6
    v_lshl_add_u32 v4, v5, 4, v4
    v_add_u32 v6, s28, v4
    v_xor_b32 v7, 64, v6
    v_add_u32 v8, 0x10000, v6
    v_add_u32 v9, 0x10000, v7
    v_add_u32 v10, s29, v4
    v_xor_b32 v11, 64, v10
    v_add_u32 v12, 0x10000, v10
    v_add_u32 v13, 0x10000, v11
    v_mov_b32 v16, 0
    v_mov_b32 v17, 0
    v_mov_b32 v18, 0
    v_mov_b32 v19, 0
    v_mov_b32 v20, 0
    v_mov_b32 v21, 0
    v_mov_b32 v22, 0
    v_mov_b32 v23, 0
    v_mov_b32 v24, 0
    v_mov_b32 v25, 0
    v_mov_b32 v26, 0
    v_mov_b32 v27, 0
    v_mov_b32 v28, 0
    v_mov_b32 v29, 0
    v_mov_b32 v30, 0
    v_mov_b32 v31, 0
    v_mov_b32 v32, 0
    v_mov_b32 v33, 0
    v_mov_b32 v34, 0
    v_mov_b32 v35, 0
    v_mov_b32 v36, 0
    v_mov_b32 v37, 0
    v_mov_b32 v38, 0
    v_mov_b32 v39, 0
    s_add_u32 m0, s25, 0
    s_nop 0
    buffer_load_dwordx4 v2, s[8:11], s32 offen lds
    s_add_u32 m0, s25, 4096
    s_nop 0
    buffer_load_dwordx4 v2, s[8:11], s33 offen lds
    s_add_u32 m0, s25, 8192
    s_nop 0
    buffer_load_dwordx4 v2, s[8:11], s34 offen lds
    s_add_u32 m0, s25, 12288
    s_nop 0
    buffer_load_dwordx4 v3, s[12:15], s48 offen lds
    s_add_u32 m0, s25, 16384
    s_nop 0
    buffer_load_dwordx4 v3, s[12:15], s49 offen lds
    s_add_u32 s8, s8, 128
    s_addc_u32 s9, s9, 0
    s_add_u32 s12, s12, 128
    s_addc_u32 s13, s13, 0
    s_add_u32 m0, s25, 20480
    s_nop 0
    buffer_load_dwordx4 v2, s[8:11], s32 offen lds
    s_add_u32 m0, s25, 24576
    s_nop 0
    buffer_load_dwordx4 v2, s[8:11], s33 offen lds
    s_add_u32 m0, s25, 28672
    s_nop 0
    buffer_load_dwordx4 v2, s[8:11], s34 offen lds
    s_add_u32 m0, s25, 32768
    s_nop 0
    buffer_load_dwordx4 v3, s[12:15], s48 offen lds
    s_add_u32 m0, s25, 36864
    s_nop 0
    buffer_load_dwordx4 v3, s[12:15], s49 offen lds
    s_add_u32 s8, s8, 128
    s_addc_u32 s9, s9, 0
    s_add_u32 s12, s12, 128
    s_addc_u32 s13, s13, 0
    s_add_u32 m0, s25, 40960
    s_nop 0
    buffer_load_dwordx4 v2, s[8:11], s32 offen lds
    s_add_u32 m0, s25, 45056
    s_nop 0
    buffer_load_dwordx4 v2, s[8:11], s33 offen lds
    s_add_u32 m0, s25, 49152
    s_nop 0
    buffer_load_dwordx4 v2, s[8:11], s34 offen lds
    s_add_u32 m0, s25, 53248
    s_nop 0
    buffer_load_dwordx4 v3, s[12:15], s48 offen lds
    s_add_u32 m0, s25, 57344
    s_nop 0
    buffer_load_dwordx4 v3, s[12:15], s49 offen lds
    s_add_u32 s8, s8, 128
    s_addc_u32 s9, s9, 0
    s_add_u32 s12, s12, 128
    s_addc_u32 s13, s13, 0
    s_add_u32 m0, s25, 61440
    s_nop 0
    buffer_load_dwordx4 v2, s[8:11], s32 offen lds
    s_add_u32 m0, s25, 65536
    s_nop 0
    buffer_load_dwordx4 v2, s[8:11], s33 offen lds
    s_add_u32 m0, s25, 69632
    s_nop 0
    buffer_load_dwordx4 v2, s[8:11], s34 offen lds
    s_add_u32 m0, s25, 73728
    s_nop 0
    buffer_load_dwordx4 v3, s[12:15], s48 offen lds
    s_add_u32 m0, s25, 77824
    s_nop 0
    buffer_load_dwordx4 v3, s[12:15], s49 offen lds
    s_add_u32 s8, s8, 128
    s_addc_u32 s9, s9, 0
    s_add_u32 s12, s12, 128
    s_addc_u32 s13, s13, 0
    s_waitcnt vmcnt(15)
    s_barrier
    ds_read_b128 v[40:43], v6 offset:0
    ds_read_b128 v[44:47], v6 offset:2048
    ds_read_b128 v[48:51], v6 offset:4096
    ds_read_b128 v[52:55], v10 offset:12288
    ds_read_b128 v[56:59], v10 offset:14336
    ds_read_b128 v[60:63], v7 offset:0
    ds_read_b128 v[64:67], v7 offset:2048
    ds_read_b128 v[68:71], v7 offset:4096
    ds_read_b128 v[72:75], v11 offset:12288
    ds_read_b128 v[76:79], v11 offset:14336
    s_waitcnt lgkmcnt(5)
    v_mfma_f32_16x16x32_bf16 v[16:19], v[40:43], v[52:55], v[16:19]
    v_mfma_f32_16x16x32_bf16 v[20:23], v[40:43], v[56:59], v[20:23]
    v_mfma_f32_16x16x32_bf16 v[24:27], v[44:47], v[52:55], v[24:27]
    v_mfma_f32_16x16x32_bf16 v[28:31], v[44:47], v[56:59], v[28:31]
    v_mfma_f32_16x16x32_bf16 v[32:35], v[48:51], v[52:55], v[32:35]
    v_mfma_f32_16x16x32_bf16 v[36:39], v[48:51], v[56:59], v[36:39]
    s_waitcnt lgkmcnt(0)
    s_waitcnt vmcnt(10)
    s_barrier
    ds_read_b128 v[40:43], v6 offset:20480
    ds_read_b128 v[44:47], v6 offset:22528
    ds_read_b128 v[48:51], v6 offset:24576
    ds_read_b128 v[52:55], v10 offset:32768
    ds_read_b128 v[56:59], v10 offset:34816
    s_add_u32 m0, s25, 0
    s_nop 0
    buffer_load_dwordx4 v2, s[8:11], s32 offen lds
    v_mfma_f32_16x16x32_bf16 v[16:19], v[60:63], v[72:75], v[16:19]
    s_add_u32 m0, s25, 4096
    s_nop 0
    buffer_load_dwordx4 v2, s[8:11], s33 offen lds
    v_mfma_f32_16x16x32_bf16 v[20:23], v[60:63], v[76:79], v[20:23]
    s_add_u32 m0, s25, 8192
    s_nop 0
    buffer_load_dwordx4 v2, s[8:11], s34 offen lds
    v_mfma_f32_16x16x32_bf16 v[24:27], v[64:67], v[72:75], v[24:27]
    s_add_u32 m0, s25, 12288
    s_nop 0
    buffer_load_dwordx4 v3, s[12:15], s48 offen lds
    v_mfma_f32_16x16x32_bf16 v[28:31], v[64:67], v[76:79], v[28:31]
    s_add_u32 m0, s25, 16384
    s_nop 0
    buffer_load_dwordx4 v3, s[12:15], s49 offen lds
    v_mfma_f32_16x16x32_bf16 v[32:35], v[68:71], v[72:75], v[32:35]
    s_add_u32 s8, s8, 128
    s_addc_u32 s9, s9, 0
    s_add_u32 s12, s12, 128
    s_addc_u32 s13, s13, 0
    v_mfma_f32_16x16x32_bf16 v[36:39], v[68:71], v[76:79], v[36:39]
    ds_read_b128 v[60:63], v7 offset:20480
    ds_read_b128 v[64:67], v7 offset:22528
    ds_read_b128 v[68:71], v7 offset:24576
    ds_read_b128 v[72:75], v11 offset:32768
    ds_read_b128 v[76:79], v11 offset:34816
    s_waitcnt lgkmcnt(5)
    v_mfma_f32_16x16x32_bf16 v[16:19], v[40:43], v[52:55], v[16:19]
    v_mfma_f32_16x16x32_bf16 v[20:23], v[40:43], v[56:59], v[20:23]
    v_mfma_f32_16x16x32_bf16 v[24:27], v[44:47], v[52:55], v[24:27]
    v_mfma_f32_16x16x32_bf16 v[28:31], v[44:47], v[56:59], v[28:31]
    v_mfma_f32_16x16x32_bf16 v[32:35], v[48:51], v[52:55], v[32:35]
    v_mfma_f32_16x16x32_bf16 v[36:39], v[48:51], v[56:59], v[36:39]
    s_waitcnt lgkmcnt(0)
    s_waitcnt vmcnt(10)
    s_barrier
    ds_read_b128 v[40:43], v6 offset:40960
    ds_read_b128 v[44:47], v6 offset:43008
    ds_read_b128 v[48:51], v6 offset:45056
    ds_read_b128 v[52:55], v10 offset:53248
    ds_read_b128 v[56:59], v10 offset:55296
    s_add_u32 m0, s25, 20480
    s_nop 0
    buffer_load_dwordx4 v2, s[8:11], s32 offen lds
    v_mfma_f32_16x16x32_bf16 v[16:19], v[60:63], v[72:75], v[16:19]
    s_add_u32 m0, s25, 24576
    s_nop 0
    buffer_load_dwordx4 v2, s[8:11], s33 offen lds
    v_mfma_f32_16x16x32_bf16 v[20:23], v[60:63], v[76:79], v[20:23]
    s_add_u32 m0, s25, 28672
    s_nop 0
    buffer_load_dwordx4 v2, s[8:11], s34 offen lds
    v_mfma_f32_16x16x32_bf16 v[24:27], v[64:67], v[72:75], v[24:27]
    s_add_u32 m0, s25, 32768
    s_nop 0
    buffer_load_dwordx4 v3, s[12:15], s48 offen lds
    v_mfma_f32_16x16x32_bf16 v[28:31], v[64:67], v[76:79], v[28:31]
    s_add_u32 m0, s25, 36864
    s_nop 0
    buffer_load_dwordx4 v3, s[12:15], s49 offen lds
    v_mfma_f32_16x16x32_bf16 v[32:35], v[68:71], v[72:75], v[32:35]
    s_add_u32 s8, s8, 128
    s_addc_u32 s9, s9, 0
    s_add_u32 s12, s12, 128
    s_addc_u32 s13, s13, 0
    v_mfma_f32_16x16x32_bf16 v[36:39], v[68:71], v[76:79], v[36:39]
    ds_read_b128 v[60:63], v7 offset:40960
    ds_read_b128 v[64:67], v7 offset:43008
    ds_read_b128 v[68:71], v7 offset:45056
    ds_read_b128 v[72:75], v11 offset:53248
    ds_read_b128 v[76:79], v11 offset:55296
    s_waitcnt lgkmcnt(5)
    v_mfma_f32_16x16x32_bf16 v[16:19], v[40:43], v[52:55], v[16:19]
    v_mfma_f32_16x16x32_bf16 v[20:23], v[40:43], v[56:59], v[20:23]
    v_mfma_f32_16x16x32_bf16 v[24:27], v[44:47], v[52:55], v[24:27]
    v_mfma_f32_16x16x32_bf16 v[28:31], v[44:47], v[56:59], v[28:31]
    v_mfma_f32_16x16x32_bf16 v[32:35], v[48:51], v[52:55], v[32:35]
    v_mfma_f32_16x16x32_bf16 v[36:39], v[48:51], v[56:59], v[36:39]
    s_waitcnt lgkmcnt(0)
    s_waitcnt vmcnt(10)
    s_barrier
    ds_read_b128 v[40:43], v6 offset:61440
    ds_read_b128 v[44:47], v6 offset:63488
    ds_read_b128 v[48:51], v8 offset:0
    ds_read_b128 v[52:55], v12 offset:8192
    ds_read_b128 v[56:59], v12 offset:10240
    s_add_u32 m0, s25, 40960
    s_nop 0
    buffer_load_dwordx4 v2, s[8:11], s32 offen lds
    v_mfma_f32_16x16x32_bf16 v[16:19], v[60:63], v[72:75], v[16:19]
    s_add_u32 m0, s25, 45056
    s_nop 0
    buffer_load_dwordx4 v2, s[8:11], s33 offen lds
    v_mfma_f32_16x16x32_bf16 v[20:23], v[60:63], v[76:79], v[20:23]
    s_add_u32 m0, s25, 49152
    s_nop 0
    buffer_load_dwordx4 v2, s[8:11], s34 offen lds
    v_mfma_f32_16x16x32_bf16 v[24:27], v[64:67], v[72:75], v[24:27]
    s_add_u32 m0, s25, 53248
    s_nop 0
    buffer_load_dwordx4 v3, s[12:15], s48 offen lds
    v_mfma_f32_16x16x32_bf16 v[28:31], v[64:67], v[76:79], v[28:31]
    s_add_u32 m0, s25, 57344
    s_nop 0
    buffer_load_dwordx4 v3, s[12:15], s49 offen lds
    v_mfma_f32_16x16x32_bf16 v[32:35], v[68:71], v[72:75], v[32:35]
    s_add_u32 s8, s8, 128
    s_addc_u32 s9, s9, 0
    s_add_u32 s12, s12, 128
    s_addc_u32 s13, s13, 0
    v_mfma_f32_16x16x32_bf16 v[36:39], v[68:71], v[76:79], v[36:39]
    ds_read_b128 v[60:63], v7 offset:61440
    ds_read_b128 v[64:67], v7 offset:63488
    ds_read_b128 v[68:71], v9 offset:0
    ds_read_b128 v[72:75], v13 offset:8192
    ds_read_b128 v[76:79], v13 offset:10240
    s_waitcnt lgkmcnt(5)
    v_mfma_f32_16x16x32_bf16 v[16:19], v[40:43], v[52:55], v[16:19]
    v_mfma_f32_16x16x32_bf16 v[20:23], v[40:43], v[56:59], v[20:23]
    v_mfma_f32_16x16x32_bf16 v[24:27], v[44:47], v[52:55], v[24:27]
    v_mfma_f32_16x16x32_bf16 v[28:31], v[44:47], v[56:59], v[28:31]
    v_mfma_f32_16x16x32_bf16 v[32:35], v[48:51], v[52:55], v[32:35]
    v_mfma_f32_16x16x32_bf16 v[36:39], v[48:51], v[56:59], v[36:39]
    s_waitcnt lgkmcnt(0)
    s_waitcnt vmcnt(10)
    s_barrier
    ds_read_b128 v[40:43], v6 offset:0
    ds_read_b128 v[44:47], v6 offset:2048
    ds_read_b128 v[48:51], v6 offset:4096
    ds_read_b128 v[52:55], v10 offset:12288
    ds_read_b128 v[56:59], v10 offset:14336
    s_add_u32 m0, s25, 61440
    s_nop 0
    buffer_load_dwordx4 v2, s[8:11], s32 offen lds
    v_mfma_f32_16x16x32_bf16 v[16:19], v[60:63], v[72:75], v[16:19]
    s_add_u32 m0, s25, 65536
    s_nop 0
    buffer_load_dwordx4 v2, s[8:11], s33 offen lds
    v_mfma_f32_16x16x32_bf16 v[20:23], v[60:63], v[76:79], v[20:23]
    s_add_u32 m0, s25, 69632
    s_nop 0
    buffer_load_dwordx4 v2, s[8:11], s34 offen lds
    v_mfma_f32_16x16x32_bf16 v[24:27], v[64:67], v[72:75], v[24:27]
    s_add_u32 m0, s25, 73728
    s_nop 0
    buffer_load_dwordx4 v3, s[12:15], s48 offen lds
    v_mfma_f32_16x16x32_bf16 v[28:31], v[64:67], v[76:79], v[28:31]
    s_add_u32 m0, s25, 77824
    s_nop 0
    buffer_load_dwordx4 v3, s[12:15], s49 offen lds
    v_mfma_f32_16x16x32_bf16 v[32:35], v[68:71], v[72:75], v[32:35]
    s_add_u32 s8, s8, 128
    s_addc_u32 s9, s9, 0
    s_add_u32 s12, s12, 128
    s_addc_u32 s13, s13, 0
    v_mfma_f32_16x16x32_bf16 v[36:39], v[68:71], v[76:79], v[36:39]
    ds_read_b128 v[60:63], v7 offset:0
    ds_read_b128 v[64:67], v7 offset:2048
    ds_read_b128 v[68:71], v7 offset:4096
    ds_read_b128 v[72:75], v11 offset:12288
    ds_read_b128 v[76:79], v11 offset:14336
    s_waitcnt lgkmcnt(5)
    v_mfma_f32_16x16x32_bf16 v[16:19], v[40:43], v[52:55], v[16:19]
    v_mfma_f32_16x16x32_bf16 v[20:23], v[40:43], v[56:59], v[20:23]
    v_mfma_f32_16x16x32_bf16 v[24:27], v[44:47], v[52:55], v[24:27]
    v_mfma_f32_16x16x32_bf16 v[28:31], v[44:47], v[56:59], v[28:31]
    v_mfma_f32_16x16x32_bf16 v[32:35], v[48:51], v[52:55], v[32:35]
    v_mfma_f32_16x16x32_bf16 v[36:39], v[48:51], v[56:59], v[36:39]
    s_waitcnt lgkmcnt(0)
    s_waitcnt vmcnt(10)
    s_barrier
    ds_read_b128 v[40:43], v6 offset:20480
    ds_read_b128 v[44:47], v6 offset:22528
    ds_read_b128 v[48:51], v6 offset:24576
    ds_read_b128 v[52:55], v10 offset:32768
    ds_read_b128 v[56:59], v10 offset:34816
    s_add_u32 m0, s25, 0
    s_nop 0
    buffer_load_dwordx4 v2, s[8:11], s32 offen lds
    v_mfma_f32_16x16x32_bf16 v[16:19], v[60:63], v[72:75], v[16:19]
    s_add_u32 m0, s25, 4096
    s_nop 0
    buffer_load_dwordx4 v2, s[8:11], s33 offen lds
    v_mfma_f32_16x16x32_bf16 v[20:23], v[60:63], v[76:79], v[20:23]
    s_add_u32 m0, s25, 8192
    s_nop 0
    buffer_load_dwordx4 v2, s[8:11], s34 offen lds
    v_mfma_f32_16x16x32_bf16 v[24:27], v[64:67], v[72:75], v[24:27]
    s_add_u32 m0, s25, 12288
    s_nop 0
    buffer_load_dwordx4 v3, s[12:15], s48 offen lds
    v_mfma_f32_16x16x32_bf16 v[28:31], v[64:67], v[76:79], v[28:31]
    s_add_u32 m0, s25, 16384
    s_nop 0
    buffer_load_dwordx4 v3, s[12:15], s49 offen lds
    v_mfma_f32_16x16x32_bf16 v[32:35], v[68:71], v[72:75], v[32:35]
    s_add_u32 s8, s8, 128
    s_addc_u32 s9, s9, 0
    s_add_u32 s12, s12, 128
    s_addc_u32 s13, s13, 0
    v_mfma_f32_16x16x32_bf16 v[36:39], v[68:71], v[76:79], v[36:39]
    ds_read_b128 v[60:63], v7 offset:20480
    ds_read_b128 v[64:67], v7 offset:22528
    ds_read_b128 v[68:71], v7 offset:24576
    ds_read_b128 v[72:75], v11 offset:32768
    ds_read_b128 v[76:79], v11 offset:34816
    s_waitcnt lgkmcnt(5)
    v_mfma_f32_16x16x32_bf16 v[16:19], v[40:43], v[52:55], v[16:19]
    v_mfma_f32_16x16x32_bf16 v[20:23], v[40:43], v[56:59], v[20:23]
    v_mfma_f32_16x16x32_bf16 v[24:27], v[44:47], v[52:55], v[24:27]
    v_mfma_f32_16x16x32_bf16 v[28:31], v[44:47], v[56:59], v[28:31]
    v_mfma_f32_16x16x32_bf16 v[32:35], v[48:51], v[52:55], v[32:35]
    v_mfma_f32_16x16x32_bf16 v[36:39], v[48:51], v[56:59], v[36:39]
    s_waitcnt lgkmcnt(0)
    s_waitcnt vmcnt(10)
    s_barrier
    ds_read_b128 v[40:43], v6 offset:40960
    ds_read_b128 v[44:47], v6 offset:43008
    ds_read_b128 v[48:51], v6 offset:45056
    ds_read_b128 v[52:55], v10 offset:53248
    ds_read_b128 v[56:59], v10 offset:55296
    v_mfma_f32_16x16x32_bf16 v[16:19], v[60:63], v[72:75], v[16:19]
    v_mfma_f32_16x16x32_bf16 v[20:23], v[60:63], v[76:79], v[20:23]
    v_mfma_f32_16x16x32_bf16 v[24:27], v[64:67], v[72:75], v[24:27]
    v_mfma_f32_16x16x32_bf16 v[28:31], v[64:67], v[76:79], v[28:31]
    v_mfma_f32_16x16x32_bf16 v[32:35], v[68:71], v[72:75], v[32:35]
    v_mfma_f32_16x16x32_bf16 v[36:39], v[68:71], v[76:79], v[36:39]
    ds_read_b128 v[60:63], v7 offset:40960
    ds_read_b128 v[64:67], v7 offset:43008
    ds_read_b128 v[68:71], v7 offset:45056
    ds_read_b128 v[72:75], v11 offset:53248
    ds_read_b128 v[76:79], v11 offset:55296
    s_waitcnt lgkmcnt(5)
    v_mfma_f32_16x16x32_bf16 v[16:19], v[40:43], v[52:55], v[16:19]
    v_mfma_f32_16x16x32_bf16 v[20:23], v[40:43], v[56:59], v[20:23]
    v_mfma_f32_16x16x32_bf16 v[24:27], v[44:47], v[52:55], v[24:27]
    v_mfma_f32_16x16x32_bf16 v[28:31], v[44:47], v[56:59], v[28:31]
    v_mfma_f32_16x16x32_bf16 v[32:35], v[48:51], v[52:55], v[32:35]
    v_mfma_f32_16x16x32_bf16 v[36:39], v[48:51], v[56:59], v[36:39]
    s_waitcnt lgkmcnt(0)
    s_waitcnt vmcnt(5)
    s_barrier
    ds_read_b128 v[40:43], v6 offset:61440
    ds_read_b128 v[44:47], v6 offset:63488
    ds_read_b128 v[48:51], v8 offset:0
    ds_read_b128 v[52:55], v12 offset:8192
    ds_read_b128 v[56:59], v12 offset:10240
    v_mfma_f32_16x16x32_bf16 v[16:19], v[60:63], v[72:75], v[16:19]
    v_mfma_f32_16x16x32_bf16 v[20:23], v[60:63], v[76:79], v[20:23]
    v_mfma_f32_16x16x32_bf16 v[24:27], v[64:67], v[72:75], v[24:27]
    v_mfma_f32_16x16x32_bf16 v[28:31], v[64:67], v[76:79], v[28:31]
    v_mfma_f32_16x16x32_bf16 v[32:35], v[68:71], v[72:75], v[32:35]
    v_mfma_f32_16x16x32_bf16 v[36:39], v[68:71], v[76:79], v[36:39]
    ds_read_b128 v[60:63], v7 offset:61440
    ds_read_b128 v[64:67], v7 offset:63488
    ds_read_b128 v[68:71], v9 offset:0
    ds_read_b128 v[72:75], v13 offset:8192
    ds_read_b128 v[76:79], v13 offset:10240
    s_waitcnt lgkmcnt(5)
    v_mfma_f32_16x16x32_bf16 v[16:19], v[40:43], v[52:55], v[16:19]
    v_mfma_f32_16x16x32_bf16 v[20:23], v[40:43], v[56:59], v[20:23]
    v_mfma_f32_16x16x32_bf16 v[24:27], v[44:47], v[52:55], v[24:27]
    v_mfma_f32_16x16x32_bf16 v[28:31], v[44:47], v[56:59], v[28:31]
    v_mfma_f32_16x16x32_bf16 v[32:35], v[48:51], v[52:55], v[32:35]
    v_mfma_f32_16x16x32_bf16 v[36:39], v[48:51], v[56:59], v[36:39]
    s_waitcnt lgkmcnt(0)
    s_waitcnt vmcnt(0)
    s_barrier
    ds_read_b128 v[40:43], v6 offset:0
    ds_read_b128 v[44:47], v6 offset:2048
    ds_read_b128 v[48:51], v6 offset:4096
    ds_read_b128 v[52:55], v10 offset:12288
    ds_read_b128 v[56:59], v10 offset:14336
    v_mfma_f32_16x16x32_bf16 v[16:19], v[60:63], v[72:75], v[16:19]
    v_mfma_f32_16x16x32_bf16 v[20:23], v[60:63], v[76:79], v[20:23]
    v_mfma_f32_16x16x32_bf16 v[24:27], v[64:67], v[72:75], v[24:27]
    v_mfma_f32_16x16x32_bf16 v[28:31], v[64:67], v[76:79], v[28:31]
    v_mfma_f32_16x16x32_bf16 v[32:35], v[68:71], v[72:75], v[32:35]
    v_mfma_f32_16x16x32_bf16 v[36:39], v[68:71], v[76:79], v[36:39]
    ds_read_b128 v[60:63], v7 offset:0
    ds_read_b128 v[64:67], v7 offset:2048
    ds_read_b128 v[68:71], v7 offset:4096
    ds_read_b128 v[72:75], v11 offset:12288
    ds_read_b128 v[76:79], v11 offset:14336
    s_waitcnt lgkmcnt(5)
    v_mfma_f32_16x16x32_bf16 v[16:19], v[40:43], v[52:55], v[16:19]
    v_mfma_f32_16x16x32_bf16 v[20:23], v[40:43], v[56:59], v[20:23]
    v_mfma_f32_16x16x32_bf16 v[24:27], v[44:47], v[52:55], v[24:27]
    v_mfma_f32_16x16x32_bf16 v[28:31], v[44:47], v[56:59], v[28:31]
    v_mfma_f32_16x16x32_bf16 v[32:35], v[48:51], v[52:55], v[32:35]
    v_mfma_f32_16x16x32_bf16 v[36:39], v[48:51], v[56:59], v[36:39]
    s_waitcnt lgkmcnt(0)
    v_mfma_f32_16x16x32_bf16 v[16:19], v[60:63], v[72:75], v[16:19]
    v_mfma_f32_16x16x32_bf16 v[20:23], v[60:63], v[76:79], v[20:23]
    v_mfma_f32_16x16x32_bf16 v[24:27], v[64:67], v[72:75], v[24:27]
    v_mfma_f32_16x16x32_bf16 v[28:31], v[64:67], v[76:79], v[28:31]
    v_mfma_f32_16x16x32_bf16 v[32:35], v[68:71], v[72:75], v[32:35]
    v_mfma_f32_16x16x32_bf16 v[36:39], v[68:71], v[76:79], v[36:39]
    s_nop 7
    s_nop 7
    s_mul_i32 s28, s27, 64
    s_lshr_b32 s29, s24, 1
    s_mul_i32 s29, s29, 32
    s_add_u32 s28, s28, s29
    s_mul_i32 s29, s26, 96
    s_and_b32 s30, s24, 1
    s_mul_i32 s30, s30, 48
    s_add_u32 s29, s29, s30
    s_lshl_b32 s29, s29, 1
    v_and_b32 v4, 15, v1
    v_add_u32 v4, s28, v4
    s_mov_b32 s30, 1152
    v_mul_lo_u32 v4, v4, s30
    v_lshrrev_b32 v5, 4, v1
    v_lshlrev_b32 v5, 3, v5
    v_add_u32 v4, v4, v5
    v_add_u32 v4, s29, v4
    s_mov_b32 s31, 0
    v_cvt_pk_bf16_f32 v40, v16, v17
    v_cvt_pk_bf16_f32 v41, v18, v19
    buffer_load_dwordx2 v[42:43], v4, s[20:23], s31 offen
    s_waitcnt vmcnt(0)
    v_lshlrev_b32 v44, 16, v40
    v_and_b32 v45, 0xffff0000, v40
    v_lshlrev_b32 v46, 16, v42
    v_and_b32 v47, 0xffff0000, v42
    v_add_f32 v44, v44, v46
    v_add_f32 v45, v45, v47
    v_cvt_pk_bf16_f32 v40, v44, v45
    v_lshlrev_b32 v44, 16, v41
    v_and_b32 v45, 0xffff0000, v41
    v_lshlrev_b32 v46, 16, v43
    v_and_b32 v47, 0xffff0000, v43
    v_add_f32 v44, v44, v46
    v_add_f32 v45, v45, v47
    v_cvt_pk_bf16_f32 v41, v44, v45
    buffer_store_dwordx2 v[40:41], v4, s[16:19], s31 offen
    s_mov_b32 s31, 32
    v_cvt_pk_bf16_f32 v40, v24, v25
    v_cvt_pk_bf16_f32 v41, v26, v27
    buffer_load_dwordx2 v[42:43], v4, s[20:23], s31 offen
    s_waitcnt vmcnt(0)
    v_lshlrev_b32 v44, 16, v40
    v_and_b32 v45, 0xffff0000, v40
    v_lshlrev_b32 v46, 16, v42
    v_and_b32 v47, 0xffff0000, v42
    v_add_f32 v44, v44, v46
    v_add_f32 v45, v45, v47
    v_cvt_pk_bf16_f32 v40, v44, v45
    v_lshlrev_b32 v44, 16, v41
    v_and_b32 v45, 0xffff0000, v41
    v_lshlrev_b32 v46, 16, v43
    v_and_b32 v47, 0xffff0000, v43
    v_add_f32 v44, v44, v46
    v_add_f32 v45, v45, v47
    v_cvt_pk_bf16_f32 v41, v44, v45
    buffer_store_dwordx2 v[40:41], v4, s[16:19], s31 offen
    s_mov_b32 s31, 64
    v_cvt_pk_bf16_f32 v40, v32, v33
    v_cvt_pk_bf16_f32 v41, v34, v35
    buffer_load_dwordx2 v[42:43], v4, s[20:23], s31 offen
    s_waitcnt vmcnt(0)
    v_lshlrev_b32 v44, 16, v40
    v_and_b32 v45, 0xffff0000, v40
    v_lshlrev_b32 v46, 16, v42
    v_and_b32 v47, 0xffff0000, v42
    v_add_f32 v44, v44, v46
    v_add_f32 v45, v45, v47
    v_cvt_pk_bf16_f32 v40, v44, v45
    v_lshlrev_b32 v44, 16, v41
    v_and_b32 v45, 0xffff0000, v41
    v_lshlrev_b32 v46, 16, v43
    v_and_b32 v47, 0xffff0000, v43
    v_add_f32 v44, v44, v46
    v_add_f32 v45, v45, v47
    v_cvt_pk_bf16_f32 v41, v44, v45
    buffer_store_dwordx2 v[40:41], v4, s[16:19], s31 offen
    s_mov_b32 s31, 18432
    v_cvt_pk_bf16_f32 v40, v20, v21
    v_cvt_pk_bf16_f32 v41, v22, v23
    buffer_load_dwordx2 v[42:43], v4, s[20:23], s31 offen
    s_waitcnt vmcnt(0)
    v_lshlrev_b32 v44, 16, v40
    v_and_b32 v45, 0xffff0000, v40
    v_lshlrev_b32 v46, 16, v42
    v_and_b32 v47, 0xffff0000, v42
    v_add_f32 v44, v44, v46
    v_add_f32 v45, v45, v47
    v_cvt_pk_bf16_f32 v40, v44, v45
    v_lshlrev_b32 v44, 16, v41
    v_and_b32 v45, 0xffff0000, v41
    v_lshlrev_b32 v46, 16, v43
    v_and_b32 v47, 0xffff0000, v43
    v_add_f32 v44, v44, v46
    v_add_f32 v45, v45, v47
    v_cvt_pk_bf16_f32 v41, v44, v45
    buffer_store_dwordx2 v[40:41], v4, s[16:19], s31 offen
    s_mov_b32 s31, 18464
    v_cvt_pk_bf16_f32 v40, v28, v29
    v_cvt_pk_bf16_f32 v41, v30, v31
    buffer_load_dwordx2 v[42:43], v4, s[20:23], s31 offen
    s_waitcnt vmcnt(0)
    v_lshlrev_b32 v44, 16, v40
    v_and_b32 v45, 0xffff0000, v40
    v_lshlrev_b32 v46, 16, v42
    v_and_b32 v47, 0xffff0000, v42
    v_add_f32 v44, v44, v46
    v_add_f32 v45, v45, v47
    v_cvt_pk_bf16_f32 v40, v44, v45
    v_lshlrev_b32 v44, 16, v41
    v_and_b32 v45, 0xffff0000, v41
    v_lshlrev_b32 v46, 16, v43
    v_and_b32 v47, 0xffff0000, v43
    v_add_f32 v44, v44, v46
    v_add_f32 v45, v45, v47
    v_cvt_pk_bf16_f32 v41, v44, v45
    buffer_store_dwordx2 v[40:41], v4, s[16:19], s31 offen
    s_mov_b32 s31, 18496
    v_cvt_pk_bf16_f32 v40, v36, v37
    v_cvt_pk_bf16_f32 v41, v38, v39
    buffer_load_dwordx2 v[42:43], v4, s[20:23], s31 offen
    s_waitcnt vmcnt(0)
    v_lshlrev_b32 v44, 16, v40
    v_and_b32 v45, 0xffff0000, v40
    v_lshlrev_b32 v46, 16, v42
    v_and_b32 v47, 0xffff0000, v42
    v_add_f32 v44, v44, v46
    v_add_f32 v45, v45, v47
    v_cvt_pk_bf16_f32 v40, v44, v45
    v_lshlrev_b32 v44, 16, v41
    v_and_b32 v45, 0xffff0000, v41
    v_lshlrev_b32 v46, 16, v43
    v_and_b32 v47, 0xffff0000, v43
    v_add_f32 v44, v44, v46
    v_add_f32 v45, v45, v47
    v_cvt_pk_bf16_f32 v41, v44, v45
    buffer_store_dwordx2 v[40:41], v4, s[16:19], s31 offen
g2b_kernel_end:
    s_endpgm
.section .rodata,"a"
.p2align 6
.amdhsa_kernel g2b_kernel
  .amdhsa_next_free_vgpr 88
  .amdhsa_next_free_sgpr 102
  .amdhsa_accum_offset 88
  .amdhsa_group_segment_fixed_size 0
  .amdhsa_kernarg_size 96
  .amdhsa_user_sgpr_count 2
  .amdhsa_user_sgpr_kernarg_segment_ptr 1
  .amdhsa_system_sgpr_workgroup_id_x 1
.end_amdhsa_kernel
.text
.globl ln4_kernel
.p2align 8
.type ln4_kernel,@function
ln4_kernel:
    s_load_dwordx2 s[4:5], s[0:1], 0
    s_load_dwordx2 s[6:7], s[0:1], 88
    s_load_dwordx2 s[8:9], s[0:1], 72
    v_lshrrev_b32 v1, 6, v0
    v_and_b32 v2, 63, v0
    s_nop 0
    v_readfirstlane_b32 s3, v1
    s_lshl_b32 s10, s2, 2
    s_add_u32 s10, s10, s3
    s_cmp_ge_u32 s10, 2048
    s_cbranch_scc1 ln4_kernel_end
    s_waitcnt lgkmcnt(0)
    s_add_u32 s12, s6, 0xfc0000
    s_addc_u32 s13, s7, 0
    s_mov_b32 s14, 0x240000
    s_mov_b32 s15, 0x00020000
    s_mov_b32 s16, s6
    s_mov_b32 s17, s7
    s_mov_b32 s18, 0x240000
    s_mov_b32 s19, 0x00020000
    s_mul_i32 s11, s10, 1152
    v_lshlrev_b32 v3, 4, v2
    v_cmp_gt_u32 s[32:33], 8, v2
    v_mov_b32 v12, 0
    v_mov_b32 v13, 0
    v_mov_b32 v14, 0
    v_mov_b32 v15, 0
    v_mov_b32 v16, 0
    v_mov_b32 v17, 0
    v_mov_b32 v18, 0
    v_mov_b32 v19, 0
    buffer_load_dwordx4 v[4:7], v3, s[12:15], s11 offen
    s_mov_b64 exec, s[32:33]
    buffer_load_dwordx4 v[12:15], v3, s[12:15], s11 offen offset:1024
    s_mov_b64 exec, -1
    s_waitcnt vmcnt(0)
    v_lshlrev_b32 v20, 16, v4
    v_and_b32 v21, 0xffff0000, v4
    v_lshlrev_b32 v22, 16, v5
    v_and_b32 v23, 0xffff0000, v5
    v_lshlrev_b32 v24, 16, v6
    v_and_b32 v25, 0xffff0000, v6
    v_lshlrev_b32 v26, 16, v7
    v_and_b32 v27, 0xffff0000, v7
    v_lshlrev_b32 v28, 16, v12
    v_and_b32 v29, 0xffff0000, v12
    v_lshlrev_b32 v30, 16, v13
    v_and_b32 v31, 0xffff0000, v13
    v_lshlrev_b32 v32, 16, v14
    v_and_b32 v33, 0xffff0000, v14
    v_lshlrev_b32 v34, 16, v15
    v_and_b32 v35, 0xffff0000, v15
    v_add_f32 v36, v20, v21
    v_add_f32 v36, v36, v22
    v_add_f32 v36, v36, v23
    v_add_f32 v36, v36, v24
    v_add_f32 v36, v36, v25
    v_add_f32 v36, v36, v26
    v_add_f32 v36, v36, v27
    v_add_f32 v36, v36, v28
    v_add_f32 v36, v36, v29
    v_add_f32 v36, v36, v30
    v_add_f32 v36, v36, v31
    v_add_f32 v36, v36, v32
    v_add_f32 v36, v36, v33
    v_add_f32 v36, v36, v34
    v_add_f32 v36, v36, v35
    s_nop 1
    v_add_f32_dpp v36, v36, v36 row_shr:1 row_mask:0xf bank_mask:0xf
    s_nop 1
    v_add_f32_dpp v36, v36, v36 row_shr:2 row_mask:0xf bank_mask:0xf
    s_nop 1
    v_add_f32_dpp v36, v36, v36 row_shr:4 row_mask:0xf bank_mask:0xf
    s_nop 1
    v_add_f32_dpp v36, v36, v36 row_shr:8 row_mask:0xf bank_mask:0xf
    s_nop 1
    v_add_f32_dpp v36, v36, v36 row_bcast:15 row_mask:0xa bank_mask:0xf
    s_nop 1
    v_add_f32_dpp v36, v36, v36 row_bcast:31 row_mask:0xc bank_mask:0xf
    s_nop 0
    v_readlane_b32 s34, v36, 63
    s_nop 1
    v_mov_b32 v37, s34
    v_mul_f32 v37, 0x3ae38e39, v37
    v_sub_f32 v38, v20, v37
    v_mul_f32 v36, v38, v38
    v_sub_f32 v38, v21, v37
    v_fmac_f32 v36, v38, v38
    v_sub_f32 v38, v22, v37
    v_fmac_f32 v36, v38, v38
    v_sub_f32 v38, v23, v37
    v_fmac_f32 v36, v38, v38
    v_sub_f32 v38, v24, v37
    v_fmac_f32 v36, v38, v38
    v_sub_f32 v38, v25, v37
    v_fmac_f32 v36, v38, v38
    v_sub_f32 v38, v26, v37
    v_fmac_f32 v36, v38, v38
    v_sub_f32 v38, v27, v37
    v_fmac_f32 v36, v38, v38
    s_mov_b64 exec, s[32:33]
    v_sub_f32 v38, v28, v37
    v_fmac_f32 v36, v38, v38
    v_sub_f32 v38, v29, v37
    v_fmac_f32 v36, v38, v38
    v_sub_f32 v38, v30, v37
    v_fmac_f32 v36, v38, v38
    v_sub_f32 v38, v31, v37
    v_fmac_f32 v36, v38, v38
    v_sub_f32 v38, v32, v37
    v_fmac_f32 v36, v38, v38
    v_sub_f32 v38, v33, v37
    v_fmac_f32 v36, v38, v38
    v_sub_f32 v38, v34, v37
    v_fmac_f32 v36, v38, v38
    v_sub_f32 v38, v35, v37
    v_fmac_f32 v36, v38, v38
    s_mov_b64 exec, -1
    s_nop 1
    v_add_f32_dpp v36, v36, v36 row_shr:1 row_mask:0xf bank_mask:0xf
    s_nop 1
    v_add_f32_dpp v36, v36, v36 row_shr:2 row_mask:0xf bank_mask:0xf
    s_nop 1
    v_add_f32_dpp v36, v36, v36 row_shr:4 row_mask:0xf bank_mask:0xf
    s_nop 1
    v_add_f32_dpp v36, v36, v36 row_shr:8 row_mask:0xf bank_mask:0xf
    s_nop 1
    v_add_f32_dpp v36, v36, v36 row_bcast:15 row_mask:0xa bank_mask:0xf
    s_nop 1
    v_add_f32_dpp v36, v36, v36 row_bcast:31 row_mask:0xc bank_mask:0xf
    s_nop 0
    v_readlane_b32 s34, v36, 63
    s_nop 1
    v_mov_b32 v38, s34
    v_mul_f32 v38, 0x3ae38e39, v38
    v_cvt_pk_bf16_f32 v39, v37, v38
    v_lshlrev_b32 v37, 16, v39
    v_and_b32 v38, 0xffff0000, v39
    v_add_f32 v38, 0x3727c5ac, v38
    v_cvt_pk_bf16_f32 v39, v38, v38
    v_lshlrev_b32 v38, 16, v39
    v_sqrt_f32 v38, v38
    s_nop 0
    v_cvt_pk_bf16_f32 v39, v38, v38
    v_lshlrev_b32 v38, 16, v39
    v_rcp_f32 v39, v38
    s_nop 0
    v_sub_f32 v40, v20, v37
    v_sub_f32 v41, v21, v37
    v_cvt_pk_bf16_f32 v42, v40, v41
    v_lshlrev_b32 v40, 16, v42
    v_and_b32 v41, 0xffff0000, v42
    v_mul_f32 v42, v40, v39
    v_mul_f32 v43, v41, v39
    v_fma_f32 v44, -v42, v38, v40
    v_fma_f32 v45, -v43, v38, v41
    v_fma_f32 v42, v44, v39, v42
    v_fma_f32 v43, v45, v39, v43
    v_cvt_pk_bf16_f32 v4, v42, v43
    v_sub_f32 v40, v22, v37
    v_sub_f32 v41, v23, v37
    v_cvt_pk_bf16_f32 v42, v40, v41
    v_lshlrev_b32 v40, 16, v42
    v_and_b32 v41, 0xffff0000, v42
    v_mul_f32 v42, v40, v39
    v_mul_f32 v43, v41, v39
    v_fma_f32 v44, -v42, v38, v40
    v_fma_f32 v45, -v43, v38, v41
    v_fma_f32 v42, v44, v39, v42
    v_fma_f32 v43, v45, v39, v43
    v_cvt_pk_bf16_f32 v5, v42, v43
    v_sub_f32 v40, v24, v37
    v_sub_f32 v41, v25, v37
    v_cvt_pk_bf16_f32 v42, v40, v41
    v_lshlrev_b32 v40, 16, v42
    v_and_b32 v41, 0xffff0000, v42
    v_mul_f32 v42, v40, v39
    v_mul_f32 v43, v41, v39
    v_fma_f32 v44, -v42, v38, v40
    v_fma_f32 v45, -v43, v38, v41
    v_fma_f32 v42, v44, v39, v42
    v_fma_f32 v43, v45, v39, v43
    v_cvt_pk_bf16_f32 v6, v42, v43
    v_sub_f32 v40, v26, v37
    v_sub_f32 v41, v27, v37
    v_cvt_pk_bf16_f32 v42, v40, v41
    v_lshlrev_b32 v40, 16, v42
    v_and_b32 v41, 0xffff0000, v42
    v_mul_f32 v42, v40, v39
    v_mul_f32 v43, v41, v39
    v_fma_f32 v44, -v42, v38, v40
    v_fma_f32 v45, -v43, v38, v41
    v_fma_f32 v42, v44, v39, v42
    v_fma_f32 v43, v45, v39, v43
    v_cvt_pk_bf16_f32 v7, v42, v43
    v_sub_f32 v40, v28, v37
    v_sub_f32 v41, v29, v37
    v_cvt_pk_bf16_f32 v42, v40, v41
    v_lshlrev_b32 v40, 16, v42
    v_and_b32 v41, 0xffff0000, v42
    v_mul_f32 v42, v40, v39
    v_mul_f32 v43, v41, v39
    v_fma_f32 v44, -v42, v38, v40
    v_fma_f32 v45, -v43, v38, v41
    v_fma_f32 v42, v44, v39, v42
    v_fma_f32 v43, v45, v39, v43
    v_cvt_pk_bf16_f32 v12, v42, v43
    v_sub_f32 v40, v30, v37
    v_sub_f32 v41, v31, v37
    v_cvt_pk_bf16_f32 v42, v40, v41
    v_lshlrev_b32 v40, 16, v42
    v_and_b32 v41, 0xffff0000, v42
    v_mul_f32 v42, v40, v39
    v_mul_f32 v43, v41, v39
    v_fma_f32 v44, -v42, v38, v40
    v_fma_f32 v45, -v43, v38, v41
    v_fma_f32 v42, v44, v39, v42
    v_fma_f32 v43, v45, v39, v43
    v_cvt_pk_bf16_f32 v13, v42, v43
    v_sub_f32 v40, v32, v37
    v_sub_f32 v41, v33, v37
    v_cvt_pk_bf16_f32 v42, v40, v41
    v_lshlrev_b32 v40, 16, v42
    v_and_b32 v41, 0xffff0000, v42
    v_mul_f32 v42, v40, v39
    v_mul_f32 v43, v41, v39
    v_fma_f32 v44, -v42, v38, v40
    v_fma_f32 v45, -v43, v38, v41
    v_fma_f32 v42, v44, v39, v42
    v_fma_f32 v43, v45, v39, v43
    v_cvt_pk_bf16_f32 v14, v42, v43
    v_sub_f32 v40, v34, v37
    v_sub_f32 v41, v35, v37
    v_cvt_pk_bf16_f32 v42, v40, v41
    v_lshlrev_b32 v40, 16, v42
    v_and_b32 v41, 0xffff0000, v42
    v_mul_f32 v42, v40, v39
    v_mul_f32 v43, v41, v39
    v_fma_f32 v44, -v42, v38, v40
    v_fma_f32 v45, -v43, v38, v41
    v_fma_f32 v42, v44, v39, v42
    v_fma_f32 v43, v45, v39, v43
    v_cvt_pk_bf16_f32 v15, v42, v43
    buffer_store_dwordx4 v[4:7], v3, s[16:19], s11 offen
    s_mov_b64 exec, s[32:33]
    buffer_store_dwordx4 v[12:15], v3, s[16:19], s11 offen offset:1024
    s_mov_b64 exec, -1
ln4_kernel_end:
    s_endpgm
.section .rodata,"a"
.p2align 6
.amdhsa_kernel ln4_kernel
  .amdhsa_next_free_vgpr 64
  .amdhsa_next_free_sgpr 102
  .amdhsa_accum_offset 64
  .amdhsa_group_segment_fixed_size 0
  .amdhsa_kernarg_size 96
  .amdhsa_user_sgpr_count 2
  .amdhsa_user_sgpr_kernarg_segment_ptr 1
  .amdhsa_system_sgpr_workgroup_id_x 1
.end_amdhsa_kernel
.text
.globl fin_kernel
.p2align 8
.type fin_kernel,@function
fin_kernel:
    s_load_dwordx2 s[4:5], s[0:1], 0
    s_load_dwordx2 s[6:7], s[0:1], 88
    s_load_dwordx2 s[8:9], s[0:1], 72
    v_lshrrev_b32 v1, 6, v0
    v_and_b32 v2, 63, v0
    s_nop 0
    v_readfirstlane_b32 s3, v1
    s_lshl_b32 s10, s2, 2
    s_add_u32 s10, s10, s3
    s_cmp_ge_u32 s10, 2048
    s_cbranch_scc1 fin_kernel_end
    s_waitcnt lgkmcnt(0)
    s_add_u32 s12, s6, 0xfc0000
    s_addc_u32 s13, s7, 0
    s_mov_b32 s14, 0x240000
    s_mov_b32 s15, 0x00020000
    s_mov_b32 s16, s6
    s_mov_b32 s17, s7
    s_mov_b32 s18, 0x240000
    s_mov_b32 s19, 0x00020000
    s_add_u32 s20, s6, 0x1680000
    s_addc_u32 s21, s7, 0
    s_mov_b32 s22, 0x240000
    s_mov_b32 s23, 0x00020000
    s_add_u32 s24, s6, 0x18c0000
    s_addc_u32 s25, s7, 0
    s_mov_b32 s26, 0x240000
    s_mov_b32 s27, 0x00020000
    s_mov_b32 s28, s8
    s_mov_b32 s29, s9
    s_mov_b32 s30, 0x240000
    s_mov_b32 s31, 0x00020000
    s_mul_i32 s11, s10, 1152
    v_lshlrev_b32 v3, 4, v2
    v_cmp_gt_u32 s[32:33], 8, v2
    v_mov_b32 v12, 0
    v_mov_b32 v13, 0
    v_mov_b32 v14, 0
    v_mov_b32 v15, 0
    v_mov_b32 v16, 0
    v_mov_b32 v17, 0
    v_mov_b32 v18, 0
    v_mov_b32 v19, 0
    buffer_load_dwordx4 v[4:7], v3, s[12:15], s11 offen
    s_mov_b64 exec, s[32:33]
    buffer_load_dwordx4 v[12:15], v3, s[12:15], s11 offen offset:1024
    s_mov_b64 exec, -1
    v_mov_b32 v36, 0
    v_mov_b32 v37, 0
    v_mov_b32 v38, 0
    v_mov_b32 v39, 0
    v_mov_b32 v40, 0
    v_mov_b32 v41, 0
    v_mov_b32 v42, 0
    v_mov_b32 v43, 0
    buffer_load_dwordx4 v[8:11], v3, s[20:23], s11 offen
    s_mov_b64 exec, s[32:33]
    buffer_load_dwordx4 v[16:19], v3, s[20:23], s11 offen offset:1024
    s_mov_b64 exec, -1
    buffer_load_dwordx4 v[36:39], v3, s[24:27], s11 offen
    s_mov_b64 exec, s[32:33]
    buffer_load_dwordx4 v[40:43], v3, s[24:27], s11 offen offset:1024
    s_mov_b64 exec, -1
    s_waitcnt vmcnt(0)
    v_lshlrev_b32 v44, 16, v8
    v_and_b32 v45, 0xffff0000, v8
    v_lshlrev_b32 v46, 16, v36
    v_and_b32 v47, 0xffff0000, v36
    v_sub_f32 v44, v44, v46
    v_sub_f32 v45, v45, v47
    v_cvt_pk_bf16_f32 v44, v44, v45
    v_lshlrev_b32 v45, 16, v44
    v_and_b32 v46, 0xffff0000, v44
    v_lshlrev_b32 v47, 16, v4
    v_and_b32 v48, 0xffff0000, v4
    v_add_f32 v45, v45, v47
    v_add_f32 v46, v46, v48
    v_cvt_pk_bf16_f32 v4, v45, v46
    v_lshlrev_b32 v44, 16, v9
    v_and_b32 v45, 0xffff0000, v9
    v_lshlrev_b32 v46, 16, v37
    v_and_b32 v47, 0xffff0000, v37
    v_sub_f32 v44, v44, v46
    v_sub_f32 v45, v45, v47
    v_cvt_pk_bf16_f32 v44, v44, v45
    v_lshlrev_b32 v45, 16, v44
    v_and_b32 v46, 0xffff0000, v44
    v_lshlrev_b32 v47, 16, v5
    v_and_b32 v48, 0xffff0000, v5
    v_add_f32 v45, v45, v47
    v_add_f32 v46, v46, v48
    v_cvt_pk_bf16_f32 v5, v45, v46
    v_lshlrev_b32 v44, 16, v10
    v_and_b32 v45, 0xffff0000, v10
    v_lshlrev_b32 v46, 16, v38
    v_and_b32 v47, 0xffff0000, v38
    v_sub_f32 v44, v44, v46
    v_sub_f32 v45, v45, v47
    v_cvt_pk_bf16_f32 v44, v44, v45
    v_lshlrev_b32 v45, 16, v44
    v_and_b32 v46, 0xffff0000, v44
    v_lshlrev_b32 v47, 16, v6
    v_and_b32 v48, 0xffff0000, v6
    v_add_f32 v45, v45, v47
    v_add_f32 v46, v46, v48
    v_cvt_pk_bf16_f32 v6, v45, v46
    v_lshlrev_b32 v44, 16, v11
    v_and_b32 v45, 0xffff0000, v11
    v_lshlrev_b32 v46, 16, v39
    v_and_b32 v47, 0xffff0000, v39
    v_sub_f32 v44, v44, v46
    v_sub_f32 v45, v45, v47
    v_cvt_pk_bf16_f32 v44, v44, v45
    v_lshlrev_b32 v45, 16, v44
    v_and_b32 v46, 0xffff0000, v44
    v_lshlrev_b32 v47, 16, v7
    v_and_b32 v48, 0xffff0000, v7
    v_add_f32 v45, v45, v47
    v_add_f32 v46, v46, v48
    v_cvt_pk_bf16_f32 v7, v45, v46
    v_lshlrev_b32 v44, 16, v16
    v_and_b32 v45, 0xffff0000, v16
    v_lshlrev_b32 v46, 16, v40
    v_and_b32 v47, 0xffff0000, v40
    v_sub_f32 v44, v44, v46
    v_sub_f32 v45, v45, v47
    v_cvt_pk_bf16_f32 v44, v44, v45
    v_lshlrev_b32 v45, 16, v44
    v_and_b32 v46, 0xffff0000, v44
    v_lshlrev_b32 v47, 16, v12
    v_and_b32 v48, 0xffff0000, v12
    v_add_f32 v45, v45, v47
    v_add_f32 v46, v46, v48
    v_cvt_pk_bf16_f32 v12, v45, v46
    v_lshlrev_b32 v44, 16, v17
    v_and_b32 v45, 0xffff0000, v17
    v_lshlrev_b32 v46, 16, v41
    v_and_b32 v47, 0xffff0000, v41
    v_sub_f32 v44, v44, v46
    v_sub_f32 v45, v45, v47
    v_cvt_pk_bf16_f32 v44, v44, v45
    v_lshlrev_b32 v45, 16, v44
    v_and_b32 v46, 0xffff0000, v44
    v_lshlrev_b32 v47, 16, v13
    v_and_b32 v48, 0xffff0000, v13
    v_add_f32 v45, v45, v47
    v_add_f32 v46, v46, v48
    v_cvt_pk_bf16_f32 v13, v45, v46
    v_lshlrev_b32 v44, 16, v18
    v_and_b32 v45, 0xffff0000, v18
    v_lshlrev_b32 v46, 16, v42
    v_and_b32 v47, 0xffff0000, v42
    v_sub_f32 v44, v44, v46
    v_sub_f32 v45, v45, v47
    v_cvt_pk_bf16_f32 v44, v44, v45
    v_lshlrev_b32 v45, 16, v44
    v_and_b32 v46, 0xffff0000, v44
    v_lshlrev_b32 v47, 16, v14
    v_and_b32 v48, 0xffff0000, v14
    v_add_f32 v45, v45, v47
    v_add_f32 v46, v46, v48
    v_cvt_pk_bf16_f32 v14, v45, v46
    v_lshlrev_b32 v44, 16, v19
    v_and_b32 v45, 0xffff0000, v19
    v_lshlrev_b32 v46, 16, v43
    v_and_b32 v47, 0xffff0000, v43
    v_sub_f32 v44, v44, v46
    v_sub_f32 v45, v45, v47
    v_cvt_pk_bf16_f32 v44, v44, v45
    v_lshlrev_b32 v45, 16, v44
    v_and_b32 v46, 0xffff0000, v44
    v_lshlrev_b32 v47, 16, v15
    v_and_b32 v48, 0xffff0000, v15
    v_add_f32 v45, v45, v47
    v_add_f32 v46, v46, v48
    v_cvt_pk_bf16_f32 v15, v45, v46
    buffer_store_dwordx4 v[4:7], v3, s[28:31], s11 offen
    s_mov_b64 exec, s[32:33]
    buffer_store_dwordx4 v[12:15], v3, s[28:31], s11 offen offset:1024
    s_mov_b64 exec, -1
fin_kernel_end:
    s_endpgm
.section .rodata,"a"
.p2align 6
.amdhsa_kernel fin_kernel
  .amdhsa_next_free_vgpr 64
  .amdhsa_next_free_sgpr 102
  .amdhsa_accum_offset 64
  .amdhsa_group_segment_fixed_size 0
  .amdhsa_kernarg_size 96
  .amdhsa_user_sgpr_count 2
  .amdhsa_user_sgpr_kernarg_segment_ptr 1
  .amdhsa_system_sgpr_workgroup_id_x 1
.end_amdhsa_kernel
```
